```python
import torch

def _softmax(x, axis=-1):
    return torch.softmax(x, dim=axis)

def _gelu(x):
    return torch.nn.functional.gelu(x, approximate='tanh')

def _silu(x):
    return torch.nn.functional.silu(x)

def _sigmoid(x):
    return torch.sigmoid(x)

def _layernorm(x, axis=-1, eps=1e-05):
    m = x.mean(dim=axis, keepdim=True)
    v = x.var(dim=axis, keepdim=True, unbiased=False)
    return (x - m) / torch.sqrt(v + eps)

def _scatter_add(tgt, idx, src, axis=0):
    return tgt.clone().index_add_(axis, idx, src)

def _segment_sum(src, seg, n):
    out = torch.zeros((n,) + src.shape[1:], dtype=src.dtype)
    return out.index_add_(0, seg, src)

def _pad(x, pw):
    flat = tuple((v for pair in reversed(pw) for v in pair))
    return torch.nn.functional.pad(x, flat)
kernel_name = 'adaLN_cond__memory_aug_recurrent_mem_tr__mixer_token_mlp__prompt'

def setup_inputs():

    _w = lambda a: (lambda t: t.to(torch.bfloat16) if t.is_floating_point() else t)(torch.as_tensor(a))

    def _A_setup():
        B, S, Dm = (1, 2048, 640)
        H, Dh = (32, 128)
        M, seg = (8, 32)
        seg = min(seg, S)
        S = S // seg * seg
        return {'x': _w((lambda *s: torch.randn(*s, dtype=torch.bfloat16) * 0.05)(B, S, Dm)), 'mem0': _w((lambda *s: torch.randn(*s, dtype=torch.bfloat16) * 0.8)(B, M, Dm)), 'Wq': _w((lambda *s: torch.randn(*s, dtype=torch.bfloat16) * 1.6)(Dm, H, Dh) * Dm ** (-0.5)), 'Wk': _w((lambda *s: torch.randn(*s, dtype=torch.bfloat16) * 1.6)(Dm, H, Dh) * Dm ** (-0.5)), 'Wv': _w((lambda *s: torch.randn(*s, dtype=torch.bfloat16) * 0.8)(Dm, H, Dh) * Dm ** (-0.5)), 'Wo': _w((lambda *s: torch.randn(*s, dtype=torch.bfloat16) * 0.8)(H, Dh, Dm) * (H * Dh) ** (-0.5)), 'seg_len': seg}
    _A_in = _A_setup()

    def _B_setup():
        B, S, D, F = (1, 2048, 640, 1728)
        return {'x': _w((lambda *s: torch.randn(*s, dtype=torch.bfloat16) * 0.05)(B, S, D)), 'w1': _w((lambda *s: torch.randn(*s, dtype=torch.bfloat16) * 1.6)(S, F) * S ** (-0.5)), 'b1': _w((lambda *s: torch.randn(*s, dtype=torch.bfloat16) * 1.6)(F) * 0.02), 'w2': _w((lambda *s: torch.randn(*s, dtype=torch.bfloat16) * 0.2)(F, S) * F ** (-0.5)), 'b2': _w((lambda *s: torch.randn(*s, dtype=torch.bfloat16) * 0.2)(S) * 0.02)}
    _B_in = _B_setup()
    return {'A_x': _A_in['x'], 'A_mem0': _A_in['mem0'], 'A_Wq': _A_in['Wq'], 'A_Wk': _A_in['Wk'], 'A_Wv': _A_in['Wv'], 'A_Wo': _A_in['Wo'], 'A_seg_len': _A_in['seg_len'], 'B_x': _B_in['x'], 'B_w1': _B_in['w1'], 'B_b1': _B_in['b1'], 'B_w2': _B_in['w2'], 'B_b2': _B_in['b2'], 'c': _w((lambda *s: torch.randn(*s, dtype=torch.bfloat16) * 0.05)(1, 640) * 8.0), 'w_mod': _w((lambda *s: torch.randn(*s, dtype=torch.bfloat16) * 0.05)(640, 6 * 640) * 640 ** (-0.5) * 8.0)}

def reference(A_x, A_mem0, A_Wq, A_Wk, A_Wv, A_Wo, A_seg_len, B_x, B_w1, B_b1, B_w2, B_b2, c, w_mod):

    def _A_ref(x, mem0, Wq, Wk, Wv, Wo, seg_len):
        B, S, Dm = x.shape
        H, Dh = (Wq.shape[1], Wq.shape[2])
        M = mem0.shape[1]
        scale = Dh ** (-0.5)
        n_seg = S // seg_len
        L = M + seg_len
        idx = torch.arange(L)
        mask = (idx[:, None] < M) | (idx[:, None] >= idx[None, :])
        mem = mem0
        outs = []
        for s in range(n_seg):
            xs = x[:, s * seg_len:(s + 1) * seg_len, :].clone()
            h = torch.concatenate([mem, xs], axis=1)
            q = torch.einsum('btd,dhe->bhte', h, Wq)
            k = torch.einsum('btd,dhe->bhte', h, Wk)
            v = torch.einsum('btd,dhe->bhte', h, Wv)
            scores = torch.einsum('bhqe,bhke->bhqk', q, k) * scale
            scores = torch.where(mask[None, None], scores, -1000000000.0)
            p = _softmax(scores, axis=-1)
            o = torch.einsum('bhqk,bhke->bhqe', p, v)
            o = torch.einsum('bhte,hed->btd', o, Wo)
            mem = o[:, :M, :].clone()
            outs.append(o[:, M:, :])
        return torch.concatenate(outs, axis=1)

    def _B_ref(x, w1, b1, w2, b2):
        B, S, D = x.shape
        h = _layernorm(x, axis=-1)
        u = torch.einsum('bsd,sf->bdf', h, w1) + b1
        u = _gelu(u)
        y = torch.einsum('bdf,fs->bds', u, w2) + b2
        return (lambda x, *d: x.permute(*d))(y, 0, 2, 1)
    x = A_x
    mod = (_silu(c) @ w_mod).reshape(c.shape[0], 6, 1, -1)
    sa, ca, ga, sb, cb, gb = (mod[:, 0].clone(), mod[:, 1].clone(), mod[:, 2].clone(), mod[:, 3].clone(), mod[:, 4].clone(), mod[:, 5].clone())
    h = _layernorm(x, axis=-1) * (1 + ca) + sa
    x = x + ga * _A_ref(h, A_mem0, A_Wq, A_Wk, A_Wv, A_Wo, A_seg_len)
    h = _layernorm(x, axis=-1) * (1 + cb) + sb
    x = x + gb * _B_ref(h, B_w1, B_b1, B_w2, B_b2)
    return x
```

```asm
; @launch grid=(256,1,1) block=(256,1,1) lds=163840
.amdgcn_target "amdgcn-amd-amdhsa--gfx950"
.text
.globl adaLN_cond__memory_aug_recurrent_mem_tr__mixer_token_mlp__prompt_kernel
.p2align 8
.type adaLN_cond__memory_aug_recurrent_mem_tr__mixer_token_mlp__prompt_kernel,@function
adaLN_cond__memory_aug_recurrent_mem_tr__mixer_token_mlp__prompt_kernel:
  s_cmp_ge_u32 s2, 256
  s_cbranch_scc1 L_end
  s_load_dwordx2 s[4:5], s[0:1], 128
  s_mov_b32 s6, 0x10000000
  s_mov_b32 s7, 0x00020000
  s_load_dwordx2 s[8:9], s[0:1], 120
  s_mov_b32 s10, 0x100
  s_mov_b32 s11, 0x00020000
  s_getreg_b32 s32, hwreg(HW_REG_XCC_ID)
  s_and_b32 s32, s32, 7
  s_mov_b32 s35, 0
  v_lshrrev_b32 v1, 6, v0
  s_nop 0
  v_readfirstlane_b32 s34, v1
  s_waitcnt lgkmcnt(0)
  s_nop 0
  s_cmp_lg_u32 s34, 0
  s_cbranch_scc1 L_tk_wait
  s_and_b32 s36, s32, 3
  s_lshl_b32 s36, s36, 2
  s_lshr_b32 s37, s32, 2
  s_lshl_b32 s37, s37, 7
  s_add_u32 s36, s36, s37
  v_cmp_eq_u32 vcc, 0, v0
  v_mov_b32 v2, 0x7ffffff0
  v_mov_b32 v3, s36
  v_cndmask_b32 v2, v2, v3, vcc
  v_mov_b32 v3, 1
  buffer_atomic_add v3, v2, s[8:11], 0 offen sc0
  s_waitcnt vmcnt(0)
  v_mov_b32 v2, 0
  v_readfirstlane_b32 s36, v3
  s_nop 1
  v_mov_b32 v3, s36
  ds_write_b32 v2, v3
  s_waitcnt lgkmcnt(0)
L_tk_wait:
  s_barrier
  v_mov_b32 v2, 0
  ds_read_b32 v3, v2
  s_waitcnt lgkmcnt(0)
  v_readfirstlane_b32 s33, v3
  s_nop 1
  s_and_b32 s33, s33, 31
  s_barrier
  s_cmp_lt_u32 s32, 2
  s_cbranch_scc1 L_chain
  s_cmp_lt_u32 s32, 4
  s_cbranch_scc1 L_kv
  s_sub_u32 s52, s32, 4
  s_lshl_b32 s52, s52, 5
  s_add_u32 s52, s52, s33
  s_load_dwordx2 s[12:13], s[0:1], 0
  s_mov_b32 s14, 0x280000
  s_mov_b32 s15, 0x00020000
  v_and_b32 v4, 15, v0
  v_mov_b32 v28, 0x0
  s_mov_b32 s36, 0x500
  v_mad_i32_i24 v28, v4, s36, v28
  v_bfe_u32 v4, v0, 4, 2
  v_mad_i32_i24 v28, v4, 16, v28
  v_lshrrev_b32 v4, 6, v0
  s_mov_b32 s36, 0x140
  v_mad_i32_i24 v28, v4, s36, v28
  s_mul_i32 s40, s52, 20480
  s_waitcnt lgkmcnt(0)
  buffer_load_dwordx4 v[8:11], v28, s[12:15], s40 offen offset:0
  buffer_load_dwordx4 v[12:15], v28, s[12:15], s40 offen offset:64
  buffer_load_dwordx4 v[16:19], v28, s[12:15], s40 offen offset:128
  buffer_load_dwordx4 v[20:23], v28, s[12:15], s40 offen offset:192
  buffer_load_dwordx4 v[24:27], v28, s[12:15], s40 offen offset:256
  s_waitcnt vmcnt(0)
  v_lshlrev_b32 v32, 16, v8
  v_and_b32 v33, 0xffff0000, v8
  v_lshlrev_b32 v34, 16, v9
  v_and_b32 v35, 0xffff0000, v9
  v_lshlrev_b32 v36, 16, v10
  v_and_b32 v37, 0xffff0000, v10
  v_lshlrev_b32 v38, 16, v11
  v_and_b32 v39, 0xffff0000, v11
  v_lshlrev_b32 v40, 16, v12
  v_and_b32 v41, 0xffff0000, v12
  v_lshlrev_b32 v42, 16, v13
  v_and_b32 v43, 0xffff0000, v13
  v_lshlrev_b32 v44, 16, v14
  v_and_b32 v45, 0xffff0000, v14
  v_lshlrev_b32 v46, 16, v15
  v_and_b32 v47, 0xffff0000, v15
  v_lshlrev_b32 v48, 16, v16
  v_and_b32 v49, 0xffff0000, v16
  v_lshlrev_b32 v50, 16, v17
  v_and_b32 v51, 0xffff0000, v17
  v_lshlrev_b32 v52, 16, v18
  v_and_b32 v53, 0xffff0000, v18
  v_lshlrev_b32 v54, 16, v19
  v_and_b32 v55, 0xffff0000, v19
  v_lshlrev_b32 v56, 16, v20
  v_and_b32 v57, 0xffff0000, v20
  v_lshlrev_b32 v58, 16, v21
  v_and_b32 v59, 0xffff0000, v21
  v_lshlrev_b32 v60, 16, v22
  v_and_b32 v61, 0xffff0000, v22
  v_lshlrev_b32 v62, 16, v23
  v_and_b32 v63, 0xffff0000, v23
  v_lshlrev_b32 v64, 16, v24
  v_and_b32 v65, 0xffff0000, v24
  v_lshlrev_b32 v66, 16, v25
  v_and_b32 v67, 0xffff0000, v25
  v_lshlrev_b32 v68, 16, v26
  v_and_b32 v69, 0xffff0000, v26
  v_lshlrev_b32 v70, 16, v27
  v_and_b32 v71, 0xffff0000, v27
  v_add_f32 v4, v32, v33
  v_add_f32 v4, v4, v34
  v_add_f32 v4, v4, v35
  v_add_f32 v4, v4, v36
  v_add_f32 v4, v4, v37
  v_add_f32 v4, v4, v38
  v_add_f32 v4, v4, v39
  v_add_f32 v4, v4, v40
  v_add_f32 v4, v4, v41
  v_add_f32 v4, v4, v42
  v_add_f32 v4, v4, v43
  v_add_f32 v4, v4, v44
  v_add_f32 v4, v4, v45
  v_add_f32 v4, v4, v46
  v_add_f32 v4, v4, v47
  v_add_f32 v4, v4, v48
  v_add_f32 v4, v4, v49
  v_add_f32 v4, v4, v50
  v_add_f32 v4, v4, v51
  v_add_f32 v4, v4, v52
  v_add_f32 v4, v4, v53
  v_add_f32 v4, v4, v54
  v_add_f32 v4, v4, v55
  v_add_f32 v4, v4, v56
  v_add_f32 v4, v4, v57
  v_add_f32 v4, v4, v58
  v_add_f32 v4, v4, v59
  v_add_f32 v4, v4, v60
  v_add_f32 v4, v4, v61
  v_add_f32 v4, v4, v62
  v_add_f32 v4, v4, v63
  v_add_f32 v4, v4, v64
  v_add_f32 v4, v4, v65
  v_add_f32 v4, v4, v66
  v_add_f32 v4, v4, v67
  v_add_f32 v4, v4, v68
  v_add_f32 v4, v4, v69
  v_add_f32 v4, v4, v70
  v_add_f32 v4, v4, v71
  v_mov_b32 v5, v4
  s_nop 1
  v_permlane16_swap_b32 v4, v5
  v_add_f32 v4, v4, v5
  v_mov_b32 v5, v4
  s_nop 1
  v_permlane32_swap_b32 v4, v5
  v_add_f32 v4, v4, v5
  v_and_b32 v6, 15, v0
  v_mov_b32 v5, 0x27c00
  v_mad_i32_i24 v5, v6, 4, v5
  v_lshrrev_b32 v6, 6, v0
  v_mad_i32_i24 v5, v6, 64, v5
  ds_write_b32 v5, v4
  s_waitcnt lgkmcnt(0)
  s_barrier
  v_and_b32 v6, 15, v0
  v_mov_b32 v5, 0x27c00
  v_mad_i32_i24 v5, v6, 4, v5
  ds_read_b32 v4, v5
  ds_read_b32 v6, v5 offset:64
  ds_read_b32 v7, v5 offset:128
  ds_read_b32 v5, v5 offset:192
  s_waitcnt lgkmcnt(0)
  v_add_f32 v4, v4, v6
  v_add_f32 v5, v5, v7
  v_add_f32 v4, v4, v5
  v_mul_f32 v4, 0x3acccccd, v4
  v_sub_f32 v32, v32, v4
  v_sub_f32 v33, v33, v4
  v_sub_f32 v34, v34, v4
  v_sub_f32 v35, v35, v4
  v_sub_f32 v36, v36, v4
  v_sub_f32 v37, v37, v4
  v_sub_f32 v38, v38, v4
  v_sub_f32 v39, v39, v4
  v_sub_f32 v40, v40, v4
  v_sub_f32 v41, v41, v4
  v_sub_f32 v42, v42, v4
  v_sub_f32 v43, v43, v4
  v_sub_f32 v44, v44, v4
  v_sub_f32 v45, v45, v4
  v_sub_f32 v46, v46, v4
  v_sub_f32 v47, v47, v4
  v_sub_f32 v48, v48, v4
  v_sub_f32 v49, v49, v4
  v_sub_f32 v50, v50, v4
  v_sub_f32 v51, v51, v4
  v_sub_f32 v52, v52, v4
  v_sub_f32 v53, v53, v4
  v_sub_f32 v54, v54, v4
  v_sub_f32 v55, v55, v4
  v_sub_f32 v56, v56, v4
  v_sub_f32 v57, v57, v4
  v_sub_f32 v58, v58, v4
  v_sub_f32 v59, v59, v4
  v_sub_f32 v60, v60, v4
  v_sub_f32 v61, v61, v4
  v_sub_f32 v62, v62, v4
  v_sub_f32 v63, v63, v4
  v_sub_f32 v64, v64, v4
  v_sub_f32 v65, v65, v4
  v_sub_f32 v66, v66, v4
  v_sub_f32 v67, v67, v4
  v_sub_f32 v68, v68, v4
  v_sub_f32 v69, v69, v4
  v_sub_f32 v70, v70, v4
  v_sub_f32 v71, v71, v4
  v_mul_f32 v4, v32, v32
  v_fmac_f32 v4, v33, v33
  v_fmac_f32 v4, v34, v34
  v_fmac_f32 v4, v35, v35
  v_fmac_f32 v4, v36, v36
  v_fmac_f32 v4, v37, v37
  v_fmac_f32 v4, v38, v38
  v_fmac_f32 v4, v39, v39
  v_fmac_f32 v4, v40, v40
  v_fmac_f32 v4, v41, v41
  v_fmac_f32 v4, v42, v42
  v_fmac_f32 v4, v43, v43
  v_fmac_f32 v4, v44, v44
  v_fmac_f32 v4, v45, v45
  v_fmac_f32 v4, v46, v46
  v_fmac_f32 v4, v47, v47
  v_fmac_f32 v4, v48, v48
  v_fmac_f32 v4, v49, v49
  v_fmac_f32 v4, v50, v50
  v_fmac_f32 v4, v51, v51
  v_fmac_f32 v4, v52, v52
  v_fmac_f32 v4, v53, v53
  v_fmac_f32 v4, v54, v54
  v_fmac_f32 v4, v55, v55
  v_fmac_f32 v4, v56, v56
  v_fmac_f32 v4, v57, v57
  v_fmac_f32 v4, v58, v58
  v_fmac_f32 v4, v59, v59
  v_fmac_f32 v4, v60, v60
  v_fmac_f32 v4, v61, v61
  v_fmac_f32 v4, v62, v62
  v_fmac_f32 v4, v63, v63
  v_fmac_f32 v4, v64, v64
  v_fmac_f32 v4, v65, v65
  v_fmac_f32 v4, v66, v66
  v_fmac_f32 v4, v67, v67
  v_fmac_f32 v4, v68, v68
  v_fmac_f32 v4, v69, v69
  v_fmac_f32 v4, v70, v70
  v_fmac_f32 v4, v71, v71
  v_mov_b32 v5, v4
  s_nop 1
  v_permlane16_swap_b32 v4, v5
  v_add_f32 v4, v4, v5
  v_mov_b32 v5, v4
  s_nop 1
  v_permlane32_swap_b32 v4, v5
  v_add_f32 v4, v4, v5
  v_and_b32 v6, 15, v0
  v_mov_b32 v5, 0x27d00
  v_mad_i32_i24 v5, v6, 4, v5
  v_lshrrev_b32 v6, 6, v0
  v_mad_i32_i24 v5, v6, 64, v5
  ds_write_b32 v5, v4
  s_waitcnt lgkmcnt(0)
  s_barrier
  v_and_b32 v6, 15, v0
  v_mov_b32 v5, 0x27d00
  v_mad_i32_i24 v5, v6, 4, v5
  ds_read_b32 v4, v5
  ds_read_b32 v6, v5 offset:64
  ds_read_b32 v7, v5 offset:128
  ds_read_b32 v5, v5 offset:192
  s_waitcnt lgkmcnt(0)
  v_add_f32 v4, v4, v6
  v_add_f32 v5, v5, v7
  v_add_f32 v4, v4, v5
  v_mov_b32 v5, 0x3727c5ac
  v_fmac_f32 v5, 0x3acccccd, v4
  v_rsq_f32 v5, v5
  s_nop 0
  v_mul_f32 v32, v32, v5
  v_mul_f32 v33, v33, v5
  v_mul_f32 v34, v34, v5
  v_mul_f32 v35, v35, v5
  v_mul_f32 v36, v36, v5
  v_mul_f32 v37, v37, v5
  v_mul_f32 v38, v38, v5
  v_mul_f32 v39, v39, v5
  v_mul_f32 v40, v40, v5
  v_mul_f32 v41, v41, v5
  v_mul_f32 v42, v42, v5
  v_mul_f32 v43, v43, v5
  v_mul_f32 v44, v44, v5
  v_mul_f32 v45, v45, v5
  v_mul_f32 v46, v46, v5
  v_mul_f32 v47, v47, v5
  v_mul_f32 v48, v48, v5
  v_mul_f32 v49, v49, v5
  v_mul_f32 v50, v50, v5
  v_mul_f32 v51, v51, v5
  v_mul_f32 v52, v52, v5
  v_mul_f32 v53, v53, v5
  v_mul_f32 v54, v54, v5
  v_mul_f32 v55, v55, v5
  v_mul_f32 v56, v56, v5
  v_mul_f32 v57, v57, v5
  v_mul_f32 v58, v58, v5
  v_mul_f32 v59, v59, v5
  v_mul_f32 v60, v60, v5
  v_mul_f32 v61, v61, v5
  v_mul_f32 v62, v62, v5
  v_mul_f32 v63, v63, v5
  v_mul_f32 v64, v64, v5
  v_mul_f32 v65, v65, v5
  v_mul_f32 v66, v66, v5
  v_mul_f32 v67, v67, v5
  v_mul_f32 v68, v68, v5
  v_mul_f32 v69, v69, v5
  v_mul_f32 v70, v70, v5
  v_mul_f32 v71, v71, v5
  s_cmp_lg_u32 s34, 0
  s_cbranch_scc1 pd_1
  v_mov_b32 v4, 32
poll_2:
  buffer_load_dword v6, v4, s[8:11], 0 offen sc1
  s_waitcnt vmcnt(0)
  v_cmp_gt_u32 vcc, 40, v6
  s_cbranch_vccz polled_3
  s_sleep 3
  s_add_u32 s35, s35, 1
  s_cmp_lt_u32 s35, 300000
  s_cbranch_scc1 poll_2
polled_3:
pd_1:
  s_barrier
  v_bfe_u32 v4, v0, 4, 2
  v_mov_b32 v28, 0x10000
  v_mad_i32_i24 v28, v4, 32, v28
  v_lshrrev_b32 v4, 6, v0
  s_mov_b32 s36, 0x280
  v_mad_i32_i24 v28, v4, s36, v28
  buffer_load_dwordx4 v[112:115], v28, s[4:7], 0 offen offset:0 sc1
  buffer_load_dwordx4 v[72:75], v28, s[4:7], 0 offen offset:2560 sc1
  buffer_load_dwordx4 v[116:119], v28, s[4:7], 0 offen offset:16 sc1
  buffer_load_dwordx4 v[76:79], v28, s[4:7], 0 offen offset:2576 sc1
  buffer_load_dwordx4 v[120:123], v28, s[4:7], 0 offen offset:128 sc1
  buffer_load_dwordx4 v[80:83], v28, s[4:7], 0 offen offset:2688 sc1
  buffer_load_dwordx4 v[124:127], v28, s[4:7], 0 offen offset:144 sc1
  buffer_load_dwordx4 v[84:87], v28, s[4:7], 0 offen offset:2704 sc1
  buffer_load_dwordx4 v[128:131], v28, s[4:7], 0 offen offset:256 sc1
  buffer_load_dwordx4 v[88:91], v28, s[4:7], 0 offen offset:2816 sc1
  buffer_load_dwordx4 v[132:135], v28, s[4:7], 0 offen offset:272 sc1
  buffer_load_dwordx4 v[92:95], v28, s[4:7], 0 offen offset:2832 sc1
  buffer_load_dwordx4 v[136:139], v28, s[4:7], 0 offen offset:384 sc1
  buffer_load_dwordx4 v[96:99], v28, s[4:7], 0 offen offset:2944 sc1
  buffer_load_dwordx4 v[140:143], v28, s[4:7], 0 offen offset:400 sc1
  buffer_load_dwordx4 v[100:103], v28, s[4:7], 0 offen offset:2960 sc1
  buffer_load_dwordx4 v[144:147], v28, s[4:7], 0 offen offset:512 sc1
  buffer_load_dwordx4 v[104:107], v28, s[4:7], 0 offen offset:3072 sc1
  buffer_load_dwordx4 v[148:151], v28, s[4:7], 0 offen offset:528 sc1
  buffer_load_dwordx4 v[108:111], v28, s[4:7], 0 offen offset:3088 sc1
  s_waitcnt vmcnt(0)
  v_fma_f32 v72, v32, v72, v32
  v_add_f32 v72, v72, v112
  v_fma_f32 v73, v33, v73, v33
  v_add_f32 v73, v73, v113
  v_fma_f32 v74, v34, v74, v34
  v_add_f32 v74, v74, v114
  v_fma_f32 v75, v35, v75, v35
  v_add_f32 v75, v75, v115
  v_fma_f32 v76, v36, v76, v36
  v_add_f32 v76, v76, v116
  v_fma_f32 v77, v37, v77, v37
  v_add_f32 v77, v77, v117
  v_fma_f32 v78, v38, v78, v38
  v_add_f32 v78, v78, v118
  v_fma_f32 v79, v39, v79, v39
  v_add_f32 v79, v79, v119
  v_fma_f32 v80, v40, v80, v40
  v_add_f32 v80, v80, v120
  v_fma_f32 v81, v41, v81, v41
  v_add_f32 v81, v81, v121
  v_fma_f32 v82, v42, v82, v42
  v_add_f32 v82, v82, v122
  v_fma_f32 v83, v43, v83, v43
  v_add_f32 v83, v83, v123
  v_fma_f32 v84, v44, v84, v44
  v_add_f32 v84, v84, v124
  v_fma_f32 v85, v45, v85, v45
  v_add_f32 v85, v85, v125
  v_fma_f32 v86, v46, v86, v46
  v_add_f32 v86, v86, v126
  v_fma_f32 v87, v47, v87, v47
  v_add_f32 v87, v87, v127
  v_fma_f32 v88, v48, v88, v48
  v_add_f32 v88, v88, v128
  v_fma_f32 v89, v49, v89, v49
  v_add_f32 v89, v89, v129
  v_fma_f32 v90, v50, v90, v50
  v_add_f32 v90, v90, v130
  v_fma_f32 v91, v51, v91, v51
  v_add_f32 v91, v91, v131
  v_fma_f32 v92, v52, v92, v52
  v_add_f32 v92, v92, v132
  v_fma_f32 v93, v53, v93, v53
  v_add_f32 v93, v93, v133
  v_fma_f32 v94, v54, v94, v54
  v_add_f32 v94, v94, v134
  v_fma_f32 v95, v55, v95, v55
  v_add_f32 v95, v95, v135
  v_fma_f32 v96, v56, v96, v56
  v_add_f32 v96, v96, v136
  v_fma_f32 v97, v57, v97, v57
  v_add_f32 v97, v97, v137
  v_fma_f32 v98, v58, v98, v58
  v_add_f32 v98, v98, v138
  v_fma_f32 v99, v59, v99, v59
  v_add_f32 v99, v99, v139
  v_fma_f32 v100, v60, v100, v60
  v_add_f32 v100, v100, v140
  v_fma_f32 v101, v61, v101, v61
  v_add_f32 v101, v101, v141
  v_fma_f32 v102, v62, v102, v62
  v_add_f32 v102, v102, v142
  v_fma_f32 v103, v63, v103, v63
  v_add_f32 v103, v103, v143
  v_fma_f32 v104, v64, v104, v64
  v_add_f32 v104, v104, v144
  v_fma_f32 v105, v65, v105, v65
  v_add_f32 v105, v105, v145
  v_fma_f32 v106, v66, v106, v66
  v_add_f32 v106, v106, v146
  v_fma_f32 v107, v67, v107, v67
  v_add_f32 v107, v107, v147
  v_fma_f32 v108, v68, v108, v68
  v_add_f32 v108, v108, v148
  v_fma_f32 v109, v69, v109, v69
  v_add_f32 v109, v109, v149
  v_fma_f32 v110, v70, v110, v70
  v_add_f32 v110, v110, v150
  v_fma_f32 v111, v71, v111, v71
  v_add_f32 v111, v111, v151
  v_cvt_pk_bf16_f32 v8, v72, v73
  v_cvt_pk_bf16_f32 v9, v74, v75
  v_cvt_pk_bf16_f32 v10, v76, v77
  v_cvt_pk_bf16_f32 v11, v78, v79
  v_cvt_pk_bf16_f32 v12, v80, v81
  v_cvt_pk_bf16_f32 v13, v82, v83
  v_cvt_pk_bf16_f32 v14, v84, v85
  v_cvt_pk_bf16_f32 v15, v86, v87
  v_cvt_pk_bf16_f32 v16, v88, v89
  v_cvt_pk_bf16_f32 v17, v90, v91
  v_cvt_pk_bf16_f32 v18, v92, v93
  v_cvt_pk_bf16_f32 v19, v94, v95
  v_cvt_pk_bf16_f32 v20, v96, v97
  v_cvt_pk_bf16_f32 v21, v98, v99
  v_cvt_pk_bf16_f32 v22, v100, v101
  v_cvt_pk_bf16_f32 v23, v102, v103
  v_cvt_pk_bf16_f32 v24, v104, v105
  v_cvt_pk_bf16_f32 v25, v106, v107
  v_cvt_pk_bf16_f32 v26, v108, v109
  v_cvt_pk_bf16_f32 v27, v110, v111
  v_and_b32 v4, 63, v0
  v_mov_b32 v28, 0x400000
  v_mad_i32_i24 v28, v4, 16, v28
  v_lshrrev_b32 v4, 6, v0
  s_mov_b32 s36, 0x1400
  v_mad_i32_i24 v28, v4, s36, v28
  s_mul_i32 s40, s52, 20480
  buffer_store_dwordx4 v[8:11], v28, s[4:7], s40 offen offset:0 sc1
  buffer_store_dwordx4 v[12:15], v28, s[4:7], s40 offen offset:1024 sc1
  buffer_store_dwordx4 v[16:19], v28, s[4:7], s40 offen offset:2048 sc1
  buffer_store_dwordx4 v[20:23], v28, s[4:7], s40 offen offset:3072 sc1
  s_add_u32 s40, s40, 4096
  buffer_store_dwordx4 v[24:27], v28, s[4:7], s40 offen offset:0 sc1
  s_waitcnt vmcnt(0)
  s_barrier
  s_cmp_lg_u32 s34, 0
  s_cbranch_scc1 ln1skip_4
  s_lshl_b32 s40, s52, 7
  s_add_u32 s40, s40, 0
  v_and_b32 v4, 63, v0
  v_cmp_eq_u32 vcc, 0, v4
  v_mov_b32 v5, 0x7ffffff0
  s_nop 0
  v_cndmask_b32 v4, v5, 0, vcc
  v_mov_b32 v5, 1
  buffer_store_dword v5, v4, s[4:7], s40 offen sc1
ln1skip_4:
  s_cmp_ge_u32 s52, 80
  s_cbranch_scc1 L_modb_done
  s_add_u32 s53, s52, 40
  s_load_dwordx2 s[12:13], s[0:1], 104
  s_mov_b32 s14, 0x4b0000
  s_mov_b32 s15, 0x00020000
  s_load_dwordx2 s[16:17], s[0:1], 96
  s_mov_b32 s18, 0x500
  s_mov_b32 s19, 0x00020000
  v_and_b32 v152, 3, v0
  v_mov_b32 v150, 0x0
  v_mad_i32_i24 v150, v152, 16, v150
  v_bfe_u32 v152, v0, 2, 4
  s_mov_b32 s36, 0x1e00
  v_mad_i32_i24 v150, v152, s36, v150
  v_lshrrev_b32 v152, 6, v0
  s_mov_b32 s36, 0x12c000
  v_mad_i32_i24 v150, v152, s36, v150
  v_bfe_u32 v152, v0, 2, 4
  v_mov_b32 v151, 0x0
  v_mad_i32_i24 v151, v152, 2, v151
  v_lshrrev_b32 v152, 6, v0
  s_mov_b32 s36, 0x140
  v_mad_i32_i24 v151, v152, s36, v151
  s_lshl_b32 s40, s53, 6
  s_waitcnt lgkmcnt(0)
  buffer_load_ushort v140, v151, s[16:19], 0 offen offset:0
  buffer_load_ushort v141, v151, s[16:19], 0 offen offset:32
  buffer_load_ushort v142, v151, s[16:19], 0 offen offset:64
  buffer_load_ushort v143, v151, s[16:19], 0 offen offset:96
  buffer_load_ushort v144, v151, s[16:19], 0 offen offset:128
  buffer_load_ushort v145, v151, s[16:19], 0 offen offset:160
  buffer_load_ushort v146, v151, s[16:19], 0 offen offset:192
  buffer_load_ushort v147, v151, s[16:19], 0 offen offset:224
  buffer_load_ushort v148, v151, s[16:19], 0 offen offset:256
  buffer_load_ushort v149, v151, s[16:19], 0 offen offset:288
  buffer_load_dwordx4 v[100:103], v150, s[12:15], s40 offen
  s_add_u32 s40, s40, 122880
  buffer_load_dwordx4 v[104:107], v150, s[12:15], s40 offen
  s_add_u32 s40, s40, 122880
  buffer_load_dwordx4 v[108:111], v150, s[12:15], s40 offen
  s_add_u32 s40, s40, 122880
  buffer_load_dwordx4 v[112:115], v150, s[12:15], s40 offen
  s_add_u32 s40, s40, 122880
  buffer_load_dwordx4 v[116:119], v150, s[12:15], s40 offen
  s_add_u32 s40, s40, 122880
  buffer_load_dwordx4 v[120:123], v150, s[12:15], s40 offen
  s_add_u32 s40, s40, 122880
  buffer_load_dwordx4 v[124:127], v150, s[12:15], s40 offen
  s_add_u32 s40, s40, 122880
  buffer_load_dwordx4 v[128:131], v150, s[12:15], s40 offen
  s_add_u32 s40, s40, 122880
  buffer_load_dwordx4 v[132:135], v150, s[12:15], s40 offen
  s_add_u32 s40, s40, 122880
  buffer_load_dwordx4 v[136:139], v150, s[12:15], s40 offen
  s_waitcnt vmcnt(0)
  v_mov_b32 v154, 0
  v_mov_b32 v155, 0
  v_mov_b32 v156, 0
  v_mov_b32 v157, 0
  v_mov_b32 v158, 0
  v_mov_b32 v159, 0
  v_mov_b32 v160, 0
  v_mov_b32 v161, 0
  v_lshlrev_b32 v140, 16, v140
  v_mul_f32 v162, 0xbfb8aa3b, v140
  v_exp_f32 v162, v162
  s_nop 0
  v_add_f32 v162, 1.0, v162
  v_rcp_f32 v162, v162
  s_nop 0
  v_mul_f32 v140, v140, v162
  v_lshlrev_b32 v163, 16, v100
  v_and_b32 v164, 0xffff0000, v100
  v_fmac_f32 v154, v140, v163
  v_fmac_f32 v155, v140, v164
  v_lshlrev_b32 v163, 16, v101
  v_and_b32 v164, 0xffff0000, v101
  v_fmac_f32 v156, v140, v163
  v_fmac_f32 v157, v140, v164
  v_lshlrev_b32 v163, 16, v102
  v_and_b32 v164, 0xffff0000, v102
  v_fmac_f32 v158, v140, v163
  v_fmac_f32 v159, v140, v164
  v_lshlrev_b32 v163, 16, v103
  v_and_b32 v164, 0xffff0000, v103
  v_fmac_f32 v160, v140, v163
  v_fmac_f32 v161, v140, v164
  v_lshlrev_b32 v141, 16, v141
  v_mul_f32 v162, 0xbfb8aa3b, v141
  v_exp_f32 v162, v162
  s_nop 0
  v_add_f32 v162, 1.0, v162
  v_rcp_f32 v162, v162
  s_nop 0
  v_mul_f32 v141, v141, v162
  v_lshlrev_b32 v163, 16, v104
  v_and_b32 v164, 0xffff0000, v104
  v_fmac_f32 v154, v141, v163
  v_fmac_f32 v155, v141, v164
  v_lshlrev_b32 v163, 16, v105
  v_and_b32 v164, 0xffff0000, v105
  v_fmac_f32 v156, v141, v163
  v_fmac_f32 v157, v141, v164
  v_lshlrev_b32 v163, 16, v106
  v_and_b32 v164, 0xffff0000, v106
  v_fmac_f32 v158, v141, v163
  v_fmac_f32 v159, v141, v164
  v_lshlrev_b32 v163, 16, v107
  v_and_b32 v164, 0xffff0000, v107
  v_fmac_f32 v160, v141, v163
  v_fmac_f32 v161, v141, v164
  v_lshlrev_b32 v142, 16, v142
  v_mul_f32 v162, 0xbfb8aa3b, v142
  v_exp_f32 v162, v162
  s_nop 0
  v_add_f32 v162, 1.0, v162
  v_rcp_f32 v162, v162
  s_nop 0
  v_mul_f32 v142, v142, v162
  v_lshlrev_b32 v163, 16, v108
  v_and_b32 v164, 0xffff0000, v108
  v_fmac_f32 v154, v142, v163
  v_fmac_f32 v155, v142, v164
  v_lshlrev_b32 v163, 16, v109
  v_and_b32 v164, 0xffff0000, v109
  v_fmac_f32 v156, v142, v163
  v_fmac_f32 v157, v142, v164
  v_lshlrev_b32 v163, 16, v110
  v_and_b32 v164, 0xffff0000, v110
  v_fmac_f32 v158, v142, v163
  v_fmac_f32 v159, v142, v164
  v_lshlrev_b32 v163, 16, v111
  v_and_b32 v164, 0xffff0000, v111
  v_fmac_f32 v160, v142, v163
  v_fmac_f32 v161, v142, v164
  v_lshlrev_b32 v143, 16, v143
  v_mul_f32 v162, 0xbfb8aa3b, v143
  v_exp_f32 v162, v162
  s_nop 0
  v_add_f32 v162, 1.0, v162
  v_rcp_f32 v162, v162
  s_nop 0
  v_mul_f32 v143, v143, v162
  v_lshlrev_b32 v163, 16, v112
  v_and_b32 v164, 0xffff0000, v112
  v_fmac_f32 v154, v143, v163
  v_fmac_f32 v155, v143, v164
  v_lshlrev_b32 v163, 16, v113
  v_and_b32 v164, 0xffff0000, v113
  v_fmac_f32 v156, v143, v163
  v_fmac_f32 v157, v143, v164
  v_lshlrev_b32 v163, 16, v114
  v_and_b32 v164, 0xffff0000, v114
  v_fmac_f32 v158, v143, v163
  v_fmac_f32 v159, v143, v164
  v_lshlrev_b32 v163, 16, v115
  v_and_b32 v164, 0xffff0000, v115
  v_fmac_f32 v160, v143, v163
  v_fmac_f32 v161, v143, v164
  v_lshlrev_b32 v144, 16, v144
  v_mul_f32 v162, 0xbfb8aa3b, v144
  v_exp_f32 v162, v162
  s_nop 0
  v_add_f32 v162, 1.0, v162
  v_rcp_f32 v162, v162
  s_nop 0
  v_mul_f32 v144, v144, v162
  v_lshlrev_b32 v163, 16, v116
  v_and_b32 v164, 0xffff0000, v116
  v_fmac_f32 v154, v144, v163
  v_fmac_f32 v155, v144, v164
  v_lshlrev_b32 v163, 16, v117
  v_and_b32 v164, 0xffff0000, v117
  v_fmac_f32 v156, v144, v163
  v_fmac_f32 v157, v144, v164
  v_lshlrev_b32 v163, 16, v118
  v_and_b32 v164, 0xffff0000, v118
  v_fmac_f32 v158, v144, v163
  v_fmac_f32 v159, v144, v164
  v_lshlrev_b32 v163, 16, v119
  v_and_b32 v164, 0xffff0000, v119
  v_fmac_f32 v160, v144, v163
  v_fmac_f32 v161, v144, v164
  v_lshlrev_b32 v145, 16, v145
  v_mul_f32 v162, 0xbfb8aa3b, v145
  v_exp_f32 v162, v162
  s_nop 0
  v_add_f32 v162, 1.0, v162
  v_rcp_f32 v162, v162
  s_nop 0
  v_mul_f32 v145, v145, v162
  v_lshlrev_b32 v163, 16, v120
  v_and_b32 v164, 0xffff0000, v120
  v_fmac_f32 v154, v145, v163
  v_fmac_f32 v155, v145, v164
  v_lshlrev_b32 v163, 16, v121
  v_and_b32 v164, 0xffff0000, v121
  v_fmac_f32 v156, v145, v163
  v_fmac_f32 v157, v145, v164
  v_lshlrev_b32 v163, 16, v122
  v_and_b32 v164, 0xffff0000, v122
  v_fmac_f32 v158, v145, v163
  v_fmac_f32 v159, v145, v164
  v_lshlrev_b32 v163, 16, v123
  v_and_b32 v164, 0xffff0000, v123
  v_fmac_f32 v160, v145, v163
  v_fmac_f32 v161, v145, v164
  v_lshlrev_b32 v146, 16, v146
  v_mul_f32 v162, 0xbfb8aa3b, v146
  v_exp_f32 v162, v162
  s_nop 0
  v_add_f32 v162, 1.0, v162
  v_rcp_f32 v162, v162
  s_nop 0
  v_mul_f32 v146, v146, v162
  v_lshlrev_b32 v163, 16, v124
  v_and_b32 v164, 0xffff0000, v124
  v_fmac_f32 v154, v146, v163
  v_fmac_f32 v155, v146, v164
  v_lshlrev_b32 v163, 16, v125
  v_and_b32 v164, 0xffff0000, v125
  v_fmac_f32 v156, v146, v163
  v_fmac_f32 v157, v146, v164
  v_lshlrev_b32 v163, 16, v126
  v_and_b32 v164, 0xffff0000, v126
  v_fmac_f32 v158, v146, v163
  v_fmac_f32 v159, v146, v164
  v_lshlrev_b32 v163, 16, v127
  v_and_b32 v164, 0xffff0000, v127
  v_fmac_f32 v160, v146, v163
  v_fmac_f32 v161, v146, v164
  v_lshlrev_b32 v147, 16, v147
  v_mul_f32 v162, 0xbfb8aa3b, v147
  v_exp_f32 v162, v162
  s_nop 0
  v_add_f32 v162, 1.0, v162
  v_rcp_f32 v162, v162
  s_nop 0
  v_mul_f32 v147, v147, v162
  v_lshlrev_b32 v163, 16, v128
  v_and_b32 v164, 0xffff0000, v128
  v_fmac_f32 v154, v147, v163
  v_fmac_f32 v155, v147, v164
  v_lshlrev_b32 v163, 16, v129
  v_and_b32 v164, 0xffff0000, v129
  v_fmac_f32 v156, v147, v163
  v_fmac_f32 v157, v147, v164
  v_lshlrev_b32 v163, 16, v130
  v_and_b32 v164, 0xffff0000, v130
  v_fmac_f32 v158, v147, v163
  v_fmac_f32 v159, v147, v164
  v_lshlrev_b32 v163, 16, v131
  v_and_b32 v164, 0xffff0000, v131
  v_fmac_f32 v160, v147, v163
  v_fmac_f32 v161, v147, v164
  v_lshlrev_b32 v148, 16, v148
  v_mul_f32 v162, 0xbfb8aa3b, v148
  v_exp_f32 v162, v162
  s_nop 0
  v_add_f32 v162, 1.0, v162
  v_rcp_f32 v162, v162
  s_nop 0
  v_mul_f32 v148, v148, v162
  v_lshlrev_b32 v163, 16, v132
  v_and_b32 v164, 0xffff0000, v132
  v_fmac_f32 v154, v148, v163
  v_fmac_f32 v155, v148, v164
  v_lshlrev_b32 v163, 16, v133
  v_and_b32 v164, 0xffff0000, v133
  v_fmac_f32 v156, v148, v163
  v_fmac_f32 v157, v148, v164
  v_lshlrev_b32 v163, 16, v134
  v_and_b32 v164, 0xffff0000, v134
  v_fmac_f32 v158, v148, v163
  v_fmac_f32 v159, v148, v164
  v_lshlrev_b32 v163, 16, v135
  v_and_b32 v164, 0xffff0000, v135
  v_fmac_f32 v160, v148, v163
  v_fmac_f32 v161, v148, v164
  v_lshlrev_b32 v149, 16, v149
  v_mul_f32 v162, 0xbfb8aa3b, v149
  v_exp_f32 v162, v162
  s_nop 0
  v_add_f32 v162, 1.0, v162
  v_rcp_f32 v162, v162
  s_nop 0
  v_mul_f32 v149, v149, v162
  v_lshlrev_b32 v163, 16, v136
  v_and_b32 v164, 0xffff0000, v136
  v_fmac_f32 v154, v149, v163
  v_fmac_f32 v155, v149, v164
  v_lshlrev_b32 v163, 16, v137
  v_and_b32 v164, 0xffff0000, v137
  v_fmac_f32 v156, v149, v163
  v_fmac_f32 v157, v149, v164
  v_lshlrev_b32 v163, 16, v138
  v_and_b32 v164, 0xffff0000, v138
  v_fmac_f32 v158, v149, v163
  v_fmac_f32 v159, v149, v164
  v_lshlrev_b32 v163, 16, v139
  v_and_b32 v164, 0xffff0000, v139
  v_fmac_f32 v160, v149, v163
  v_fmac_f32 v161, v149, v164
  v_add_f32_dpp v154, v154, v154 row_ror:4 row_mask:0xf bank_mask:0xf
  v_add_f32_dpp v155, v155, v155 row_ror:4 row_mask:0xf bank_mask:0xf
  v_add_f32_dpp v156, v156, v156 row_ror:4 row_mask:0xf bank_mask:0xf
  v_add_f32_dpp v157, v157, v157 row_ror:4 row_mask:0xf bank_mask:0xf
  v_add_f32_dpp v158, v158, v158 row_ror:4 row_mask:0xf bank_mask:0xf
  v_add_f32_dpp v159, v159, v159 row_ror:4 row_mask:0xf bank_mask:0xf
  v_add_f32_dpp v160, v160, v160 row_ror:4 row_mask:0xf bank_mask:0xf
  v_add_f32_dpp v161, v161, v161 row_ror:4 row_mask:0xf bank_mask:0xf
  v_add_f32_dpp v154, v154, v154 row_ror:8 row_mask:0xf bank_mask:0xf
  v_add_f32_dpp v155, v155, v155 row_ror:8 row_mask:0xf bank_mask:0xf
  v_add_f32_dpp v156, v156, v156 row_ror:8 row_mask:0xf bank_mask:0xf
  v_add_f32_dpp v157, v157, v157 row_ror:8 row_mask:0xf bank_mask:0xf
  v_add_f32_dpp v158, v158, v158 row_ror:8 row_mask:0xf bank_mask:0xf
  v_add_f32_dpp v159, v159, v159 row_ror:8 row_mask:0xf bank_mask:0xf
  v_add_f32_dpp v160, v160, v160 row_ror:8 row_mask:0xf bank_mask:0xf
  v_add_f32_dpp v161, v161, v161 row_ror:8 row_mask:0xf bank_mask:0xf
  v_mov_b32 v162, v154
  s_nop 1
  v_permlane16_swap_b32 v154, v162
  v_add_f32 v154, v154, v162
  v_mov_b32 v162, v155
  s_nop 1
  v_permlane16_swap_b32 v155, v162
  v_add_f32 v155, v155, v162
  v_mov_b32 v162, v156
  s_nop 1
  v_permlane16_swap_b32 v156, v162
  v_add_f32 v156, v156, v162
  v_mov_b32 v162, v157
  s_nop 1
  v_permlane16_swap_b32 v157, v162
  v_add_f32 v157, v157, v162
  v_mov_b32 v162, v158
  s_nop 1
  v_permlane16_swap_b32 v158, v162
  v_add_f32 v158, v158, v162
  v_mov_b32 v162, v159
  s_nop 1
  v_permlane16_swap_b32 v159, v162
  v_add_f32 v159, v159, v162
  v_mov_b32 v162, v160
  s_nop 1
  v_permlane16_swap_b32 v160, v162
  v_add_f32 v160, v160, v162
  v_mov_b32 v162, v161
  s_nop 1
  v_permlane16_swap_b32 v161, v162
  v_add_f32 v161, v161, v162
  v_mov_b32 v162, v154
  s_nop 1
  v_permlane32_swap_b32 v154, v162
  v_add_f32 v154, v154, v162
  v_mov_b32 v162, v155
  s_nop 1
  v_permlane32_swap_b32 v155, v162
  v_add_f32 v155, v155, v162
  v_mov_b32 v162, v156
  s_nop 1
  v_permlane32_swap_b32 v156, v162
  v_add_f32 v156, v156, v162
  v_mov_b32 v162, v157
  s_nop 1
  v_permlane32_swap_b32 v157, v162
  v_add_f32 v157, v157, v162
  v_mov_b32 v162, v158
  s_nop 1
  v_permlane32_swap_b32 v158, v162
  v_add_f32 v158, v158, v162
  v_mov_b32 v162, v159
  s_nop 1
  v_permlane32_swap_b32 v159, v162
  v_add_f32 v159, v159, v162
  v_mov_b32 v162, v160
  s_nop 1
  v_permlane32_swap_b32 v160, v162
  v_add_f32 v160, v160, v162
  v_mov_b32 v162, v161
  s_nop 1
  v_permlane32_swap_b32 v161, v162
  v_add_f32 v161, v161, v162
  v_and_b32 v163, 3, v0
  v_mov_b32 v162, 0x27c00
  v_mad_i32_i24 v162, v163, 32, v162
  v_lshrrev_b32 v163, 6, v0
  s_mov_b32 s36, 0x80
  v_mad_i32_i24 v162, v163, s36, v162
  ds_write_b128 v162, v[154:157]
  ds_write_b128 v162, v[158:161] offset:16
  s_waitcnt lgkmcnt(0)
  s_barrier
  v_and_b32 v163, 31, v0
  v_mov_b32 v162, 0x27c00
  v_mad_i32_i24 v162, v163, 4, v162
  ds_read_b32 v154, v162 offset:0
  ds_read_b32 v155, v162 offset:128
  ds_read_b32 v156, v162 offset:256
  ds_read_b32 v157, v162 offset:384
  s_waitcnt lgkmcnt(0)
  v_add_f32 v154, v154, v155
  v_add_f32 v156, v156, v157
  v_add_f32 v154, v154, v156
  s_cmp_lg_u32 s34, 0
  s_cbranch_scc1 modskip_5
  v_and_b32 v163, 31, v0
  v_mov_b32 v162, 0x10000
  v_mad_i32_i24 v162, v163, 4, v162
  s_lshl_b32 s40, s53, 7
  buffer_store_dword v154, v162, s[4:7], s40 offen sc1
  s_waitcnt vmcnt(0)
  v_and_b32 v162, 63, v0
  v_cmp_eq_u32 vcc, 0, v162
  v_mov_b32 v163, 0x7ffffff0
  v_mov_b32 v162, 160
  v_cndmask_b32 v162, v163, v162, vcc
  v_mov_b32 v163, 1
  buffer_atomic_add v163, v162, s[8:11], 0 offen
modskip_5:
  s_barrier
L_modb_done:
  s_mov_b32 s80, 0
  s_cmp_eq_u32 s32, 4
  s_cbranch_scc1 L_q
  s_cmp_eq_u32 s32, 5
  s_cbranch_scc1 L_op5
  s_cmp_eq_u32 s32, 7
  s_cbranch_scc1 L_qp
  s_cmp_lt_u32 s33, 10
  s_cbranch_scc1 L_op6
  s_cmp_ge_u32 s33, 18
  s_cbranch_scc1 L_w2
  s_sub_u32 s54, s33, 10
  s_mov_b32 s80, 2
  s_branch L_w2
L_op6:
  s_mov_b32 s54, 3
  s_mov_b32 s55, s33
  s_branch L_op
L_op5:
  s_cmp_ge_u32 s33, 30
  s_cbranch_scc1 L_w2
  s_mul_i32 s54, s33, 26
  s_lshr_b32 s54, s54, 8
  s_mul_i32 s40, s54, 10
  s_sub_u32 s55, s33, s40
L_op:
  s_load_dwordx2 s[20:21], s[0:1], 40
  s_mov_b32 s22, 0x500000
  s_mov_b32 s23, 0x00020000
  v_and_b32 v13, 7, v0
  v_mov_b32 v8, 0x0
  v_mad_i32_i24 v8, v13, 16, v8
  v_bfe_u32 v13, v0, 4, 2
  v_mov_b32 v9, 0x0
  v_mad_i32_i24 v9, v13, 32, v9
  v_xor_b32 v8, v8, v9
  v_bfe_u32 v13, v0, 3, 3
  v_mov_b32 v9, 0x0
  s_mov_b32 s36, 0x500
  v_mad_i32_i24 v9, v13, s36, v9
  v_add_u32 v8, v8, v9
  v_and_b32 v13, 3, v0
  v_mov_b32 v9, 0x0
  v_mad_i32_i24 v9, v13, 8, v9
  v_bfe_u32 v13, v0, 2, 4
  s_mov_b32 s36, 0x80
  v_mad_i32_i24 v9, v13, s36, v9
  v_lshrrev_b32 v13, 6, v0
  s_mov_b32 s36, 0x8000
  v_mad_i32_i24 v9, v13, s36, v9
  v_bfe_u32 v13, v0, 3, 2
  v_mov_b32 v10, 0x0
  v_mad_i32_i24 v10, v13, 32, v10
  v_add_u32 v9, v9, v10
  v_xor_b32 v10, 32, v9
  v_xor_b32 v11, 64, v9
  v_xor_b32 v12, 96, v9
  s_lshl_b32 s41, s54, 3
  s_lshl_b32 s40, s34, 1
  s_add_u32 s41, s41, s40
  s_mul_i32 s41, s41, 163840
  s_lshl_b32 s40, s55, 7
  s_add_u32 s41, s41, s40
  s_waitcnt lgkmcnt(0)
  s_mul_i32 s42, s34, 32768
  s_mov_b32 m0, s42
  s_nop 0
  buffer_load_dwordx4 v8, s[20:23], s41 offen lds
  s_add_u32 s41, s41, 10240
  s_add_u32 s42, s42, 1024
  s_mov_b32 m0, s42
  s_nop 0
  buffer_load_dwordx4 v8, s[20:23], s41 offen lds
  s_add_u32 s41, s41, 10240
  s_add_u32 s42, s42, 1024
  s_mov_b32 m0, s42
  s_nop 0
  buffer_load_dwordx4 v8, s[20:23], s41 offen lds
  s_add_u32 s41, s41, 10240
  s_add_u32 s42, s42, 1024
  s_mov_b32 m0, s42
  s_nop 0
  buffer_load_dwordx4 v8, s[20:23], s41 offen lds
  s_add_u32 s41, s41, 10240
  s_add_u32 s42, s42, 1024
  s_mov_b32 m0, s42
  s_nop 0
  buffer_load_dwordx4 v8, s[20:23], s41 offen lds
  s_add_u32 s41, s41, 10240
  s_add_u32 s42, s42, 1024
  s_mov_b32 m0, s42
  s_nop 0
  buffer_load_dwordx4 v8, s[20:23], s41 offen lds
  s_add_u32 s41, s41, 10240
  s_add_u32 s42, s42, 1024
  s_mov_b32 m0, s42
  s_nop 0
  buffer_load_dwordx4 v8, s[20:23], s41 offen lds
  s_add_u32 s41, s41, 10240
  s_add_u32 s42, s42, 1024
  s_mov_b32 m0, s42
  s_nop 0
  buffer_load_dwordx4 v8, s[20:23], s41 offen lds
  s_add_u32 s41, s41, 10240
  s_add_u32 s42, s42, 1024
  s_mov_b32 m0, s42
  s_nop 0
  buffer_load_dwordx4 v8, s[20:23], s41 offen lds
  s_add_u32 s41, s41, 10240
  s_add_u32 s42, s42, 1024
  s_mov_b32 m0, s42
  s_nop 0
  buffer_load_dwordx4 v8, s[20:23], s41 offen lds
  s_add_u32 s41, s41, 10240
  s_add_u32 s42, s42, 1024
  s_mov_b32 m0, s42
  s_nop 0
  buffer_load_dwordx4 v8, s[20:23], s41 offen lds
  s_add_u32 s41, s41, 10240
  s_add_u32 s42, s42, 1024
  s_mov_b32 m0, s42
  s_nop 0
  buffer_load_dwordx4 v8, s[20:23], s41 offen lds
  s_add_u32 s41, s41, 10240
  s_add_u32 s42, s42, 1024
  s_mov_b32 m0, s42
  s_nop 0
  buffer_load_dwordx4 v8, s[20:23], s41 offen lds
  s_add_u32 s41, s41, 10240
  s_add_u32 s42, s42, 1024
  s_mov_b32 m0, s42
  s_nop 0
  buffer_load_dwordx4 v8, s[20:23], s41 offen lds
  s_add_u32 s41, s41, 10240
  s_add_u32 s42, s42, 1024
  s_mov_b32 m0, s42
  s_nop 0
  buffer_load_dwordx4 v8, s[20:23], s41 offen lds
  s_add_u32 s41, s41, 10240
  s_add_u32 s42, s42, 1024
  s_mov_b32 m0, s42
  s_nop 0
  buffer_load_dwordx4 v8, s[20:23], s41 offen lds
  s_add_u32 s41, s41, 10240
  s_add_u32 s42, s42, 1024
  s_mov_b32 m0, s42
  s_nop 0
  buffer_load_dwordx4 v8, s[20:23], s41 offen lds
  s_add_u32 s41, s41, 10240
  s_add_u32 s42, s42, 1024
  s_mov_b32 m0, s42
  s_nop 0
  buffer_load_dwordx4 v8, s[20:23], s41 offen lds
  s_add_u32 s41, s41, 10240
  s_add_u32 s42, s42, 1024
  s_mov_b32 m0, s42
  s_nop 0
  buffer_load_dwordx4 v8, s[20:23], s41 offen lds
  s_add_u32 s41, s41, 10240
  s_add_u32 s42, s42, 1024
  s_mov_b32 m0, s42
  s_nop 0
  buffer_load_dwordx4 v8, s[20:23], s41 offen lds
  s_add_u32 s41, s41, 10240
  s_add_u32 s42, s42, 1024
  s_mov_b32 m0, s42
  s_nop 0
  buffer_load_dwordx4 v8, s[20:23], s41 offen lds
  s_add_u32 s41, s41, 10240
  s_add_u32 s42, s42, 1024
  s_mov_b32 m0, s42
  s_nop 0
  buffer_load_dwordx4 v8, s[20:23], s41 offen lds
  s_add_u32 s41, s41, 10240
  s_add_u32 s42, s42, 1024
  s_mov_b32 m0, s42
  s_nop 0
  buffer_load_dwordx4 v8, s[20:23], s41 offen lds
  s_add_u32 s41, s41, 10240
  s_add_u32 s42, s42, 1024
  s_mov_b32 m0, s42
  s_nop 0
  buffer_load_dwordx4 v8, s[20:23], s41 offen lds
  s_add_u32 s41, s41, 10240
  s_add_u32 s42, s42, 1024
  s_mov_b32 m0, s42
  s_nop 0
  buffer_load_dwordx4 v8, s[20:23], s41 offen lds
  s_add_u32 s41, s41, 10240
  s_add_u32 s42, s42, 1024
  s_mov_b32 m0, s42
  s_nop 0
  buffer_load_dwordx4 v8, s[20:23], s41 offen lds
  s_add_u32 s41, s41, 10240
  s_add_u32 s42, s42, 1024
  s_mov_b32 m0, s42
  s_nop 0
  buffer_load_dwordx4 v8, s[20:23], s41 offen lds
  s_add_u32 s41, s41, 10240
  s_add_u32 s42, s42, 1024
  s_mov_b32 m0, s42
  s_nop 0
  buffer_load_dwordx4 v8, s[20:23], s41 offen lds
  s_add_u32 s41, s41, 10240
  s_add_u32 s42, s42, 1024
  s_mov_b32 m0, s42
  s_nop 0
  buffer_load_dwordx4 v8, s[20:23], s41 offen lds
  s_add_u32 s41, s41, 10240
  s_add_u32 s42, s42, 1024
  s_mov_b32 m0, s42
  s_nop 0
  buffer_load_dwordx4 v8, s[20:23], s41 offen lds
  s_add_u32 s41, s41, 10240
  s_add_u32 s42, s42, 1024
  s_mov_b32 m0, s42
  s_nop 0
  buffer_load_dwordx4 v8, s[20:23], s41 offen lds
  s_add_u32 s41, s41, 10240
  s_add_u32 s42, s42, 1024
  s_mov_b32 m0, s42
  s_nop 0
  buffer_load_dwordx4 v8, s[20:23], s41 offen lds
  s_add_u32 s41, s41, 10240
  s_add_u32 s42, s42, 1024
  s_waitcnt vmcnt(0)
  ds_read_b64_tr_b16 v[128:129], v9 offset:0
  ds_read_b64_tr_b16 v[130:131], v9 offset:2048
  ds_read_b64_tr_b16 v[160:161], v10 offset:0
  ds_read_b64_tr_b16 v[162:163], v10 offset:2048
  ds_read_b64_tr_b16 v[192:193], v11 offset:0
  ds_read_b64_tr_b16 v[194:195], v11 offset:2048
  ds_read_b64_tr_b16 v[224:225], v12 offset:0
  ds_read_b64_tr_b16 v[226:227], v12 offset:2048
  ds_read_b64_tr_b16 v[132:133], v9 offset:4096
  ds_read_b64_tr_b16 v[134:135], v9 offset:6144
  ds_read_b64_tr_b16 v[164:165], v10 offset:4096
  ds_read_b64_tr_b16 v[166:167], v10 offset:6144
  ds_read_b64_tr_b16 v[196:197], v11 offset:4096
  ds_read_b64_tr_b16 v[198:199], v11 offset:6144
  ds_read_b64_tr_b16 v[228:229], v12 offset:4096
  ds_read_b64_tr_b16 v[230:231], v12 offset:6144
  ds_read_b64_tr_b16 v[136:137], v9 offset:8192
  ds_read_b64_tr_b16 v[138:139], v9 offset:10240
  ds_read_b64_tr_b16 v[168:169], v10 offset:8192
  ds_read_b64_tr_b16 v[170:171], v10 offset:10240
  ds_read_b64_tr_b16 v[200:201], v11 offset:8192
  ds_read_b64_tr_b16 v[202:203], v11 offset:10240
  ds_read_b64_tr_b16 v[232:233], v12 offset:8192
  ds_read_b64_tr_b16 v[234:235], v12 offset:10240
  ds_read_b64_tr_b16 v[140:141], v9 offset:12288
  ds_read_b64_tr_b16 v[142:143], v9 offset:14336
  ds_read_b64_tr_b16 v[172:173], v10 offset:12288
  ds_read_b64_tr_b16 v[174:175], v10 offset:14336
  ds_read_b64_tr_b16 v[204:205], v11 offset:12288
  ds_read_b64_tr_b16 v[206:207], v11 offset:14336
  ds_read_b64_tr_b16 v[236:237], v12 offset:12288
  ds_read_b64_tr_b16 v[238:239], v12 offset:14336
  ds_read_b64_tr_b16 v[144:145], v9 offset:16384
  ds_read_b64_tr_b16 v[146:147], v9 offset:18432
  ds_read_b64_tr_b16 v[176:177], v10 offset:16384
  ds_read_b64_tr_b16 v[178:179], v10 offset:18432
  ds_read_b64_tr_b16 v[208:209], v11 offset:16384
  ds_read_b64_tr_b16 v[210:211], v11 offset:18432
  ds_read_b64_tr_b16 v[240:241], v12 offset:16384
  ds_read_b64_tr_b16 v[242:243], v12 offset:18432
  ds_read_b64_tr_b16 v[148:149], v9 offset:20480
  ds_read_b64_tr_b16 v[150:151], v9 offset:22528
  ds_read_b64_tr_b16 v[180:181], v10 offset:20480
  ds_read_b64_tr_b16 v[182:183], v10 offset:22528
  ds_read_b64_tr_b16 v[212:213], v11 offset:20480
  ds_read_b64_tr_b16 v[214:215], v11 offset:22528
  ds_read_b64_tr_b16 v[244:245], v12 offset:20480
  ds_read_b64_tr_b16 v[246:247], v12 offset:22528
  ds_read_b64_tr_b16 v[152:153], v9 offset:24576
  ds_read_b64_tr_b16 v[154:155], v9 offset:26624
  ds_read_b64_tr_b16 v[184:185], v10 offset:24576
  ds_read_b64_tr_b16 v[186:187], v10 offset:26624
  ds_read_b64_tr_b16 v[216:217], v11 offset:24576
  ds_read_b64_tr_b16 v[218:219], v11 offset:26624
  ds_read_b64_tr_b16 v[248:249], v12 offset:24576
  ds_read_b64_tr_b16 v[250:251], v12 offset:26624
  ds_read_b64_tr_b16 v[156:157], v9 offset:28672
  ds_read_b64_tr_b16 v[158:159], v9 offset:30720
  ds_read_b64_tr_b16 v[188:189], v10 offset:28672
  ds_read_b64_tr_b16 v[190:191], v10 offset:30720
  ds_read_b64_tr_b16 v[220:221], v11 offset:28672
  ds_read_b64_tr_b16 v[222:223], v11 offset:30720
  ds_read_b64_tr_b16 v[252:253], v12 offset:28672
  ds_read_b64_tr_b16 v[254:255], v12 offset:30720
  s_waitcnt lgkmcnt(0)
  s_barrier
  s_mov_b32 s80, 3
  s_branch L_w2
L_op_loop:
  v_and_b32 v13, 63, v0
  v_mov_b32 v15, 0x0
  v_mad_i32_i24 v15, v13, 16, v15
  v_lshrrev_b32 v13, 6, v0
  s_mov_b32 s36, 0x2000
  v_mad_i32_i24 v15, v13, s36, v15
  v_and_b32 v13, 63, v0
  v_mov_b32 v16, 0x0
  v_mad_i32_i24 v16, v13, 16, v16
  v_lshrrev_b32 v13, 6, v0
  s_mov_b32 s36, 0x800
  v_mad_i32_i24 v16, v13, s36, v16
  v_and_b32 v13, 15, v0
  v_mov_b32 v17, 0x0
  s_mov_b32 s36, 0xa00
  v_mad_i32_i24 v17, v13, s36, v17
  v_lshrrev_b32 v13, 4, v0
  v_mad_i32_i24 v17, v13, 16, v17
  s_lshl_b32 s40, s54, 3
  v_and_b32 v13, 63, v0
  v_min_u32 v13, 7, v13
  v_lshlrev_b32 v13, 7, v13
  v_add_u32 v18, 0x8000, v13
  s_lshl_b32 s40, s40, 7
  v_add_u32 v18, s40, v18
  s_cmp_lg_u32 s34, 0
  s_cbranch_scc1 pd_6
  v_mov_b32 v13, 32
poll_7:
  buffer_load_dword v14, v13, s[8:11], 0 offen sc1
  s_waitcnt vmcnt(0)
  v_cmp_gt_u32 vcc, 40, v14
  s_cbranch_vccz polled_8
  s_sleep 3
  s_add_u32 s35, s35, 1
  s_cmp_lt_u32 s35, 300000
  s_cbranch_scc1 poll_7
polled_8:
pd_6:
  s_barrier
  s_mov_b32 s44, 0
OP_loop:
  s_add_u32 s43, s44, 1
poll_9:
  buffer_load_dword v14, v18, s[4:7], 0 offen sc1
  s_waitcnt vmcnt(0)
  v_cmp_gt_u32 vcc, s43, v14
  s_cbranch_vccz polled_10
  s_sleep 2
  s_add_u32 s35, s35, 1
  s_cmp_lt_u32 s35, 300000
  s_cbranch_scc1 poll_9
polled_10:
  s_lshl_b32 s40, s44, 1
  s_add_u32 s40, s40, 0
  s_lshl_b32 s40, s40, 5
  s_lshl_b32 s41, s54, 3
  s_add_u32 s40, s40, s41
  s_lshl_b32 s40, s40, 12
  s_add_u32 s40, s40, 67108864
  buffer_load_dwordx4 v[32:35], v15, s[4:7], s40 offen offset:0 sc1
  buffer_load_dwordx4 v[36:39], v15, s[4:7], s40 offen offset:1024 sc1
  buffer_load_dwordx4 v[40:43], v15, s[4:7], s40 offen offset:2048 sc1
  buffer_load_dwordx4 v[44:47], v15, s[4:7], s40 offen offset:3072 sc1
  s_add_u32 s40, s40, 4096
  buffer_load_dwordx4 v[48:51], v15, s[4:7], s40 offen offset:0 sc1
  buffer_load_dwordx4 v[52:55], v15, s[4:7], s40 offen offset:1024 sc1
  buffer_load_dwordx4 v[56:59], v15, s[4:7], s40 offen offset:2048 sc1
  buffer_load_dwordx4 v[60:63], v15, s[4:7], s40 offen offset:3072 sc1
  s_lshl_b32 s40, s44, 1
  s_add_u32 s40, s40, 1
  s_lshl_b32 s40, s40, 5
  s_lshl_b32 s41, s54, 3
  s_add_u32 s40, s40, s41
  s_lshl_b32 s40, s40, 12
  s_add_u32 s40, s40, 67108864
  buffer_load_dwordx4 v[64:67], v15, s[4:7], s40 offen offset:0 sc1
  buffer_load_dwordx4 v[68:71], v15, s[4:7], s40 offen offset:1024 sc1
  buffer_load_dwordx4 v[72:75], v15, s[4:7], s40 offen offset:2048 sc1
  buffer_load_dwordx4 v[76:79], v15, s[4:7], s40 offen offset:3072 sc1
  s_add_u32 s40, s40, 4096
  buffer_load_dwordx4 v[80:83], v15, s[4:7], s40 offen offset:0 sc1
  buffer_load_dwordx4 v[84:87], v15, s[4:7], s40 offen offset:1024 sc1
  buffer_load_dwordx4 v[88:91], v15, s[4:7], s40 offen offset:2048 sc1
  buffer_load_dwordx4 v[92:95], v15, s[4:7], s40 offen offset:3072 sc1
  s_waitcnt vmcnt(15)
  v_mfma_f32_16x16x32_bf16 v[96:99], v[128:131], v[32:35], 0
  v_mfma_f32_16x16x32_bf16 v[104:107], v[160:163], v[32:35], 0
  v_mfma_f32_16x16x32_bf16 v[112:115], v[192:195], v[32:35], 0
  v_mfma_f32_16x16x32_bf16 v[120:123], v[224:227], v[32:35], 0
  s_waitcnt vmcnt(14)
  v_mfma_f32_16x16x32_bf16 v[96:99], v[132:135], v[36:39], v[96:99]
  v_mfma_f32_16x16x32_bf16 v[104:107], v[164:167], v[36:39], v[104:107]
  v_mfma_f32_16x16x32_bf16 v[112:115], v[196:199], v[36:39], v[112:115]
  v_mfma_f32_16x16x32_bf16 v[120:123], v[228:231], v[36:39], v[120:123]
  s_waitcnt vmcnt(13)
  v_mfma_f32_16x16x32_bf16 v[96:99], v[136:139], v[40:43], v[96:99]
  v_mfma_f32_16x16x32_bf16 v[104:107], v[168:171], v[40:43], v[104:107]
  v_mfma_f32_16x16x32_bf16 v[112:115], v[200:203], v[40:43], v[112:115]
  v_mfma_f32_16x16x32_bf16 v[120:123], v[232:235], v[40:43], v[120:123]
  s_waitcnt vmcnt(12)
  v_mfma_f32_16x16x32_bf16 v[96:99], v[140:143], v[44:47], v[96:99]
  v_mfma_f32_16x16x32_bf16 v[104:107], v[172:175], v[44:47], v[104:107]
  v_mfma_f32_16x16x32_bf16 v[112:115], v[204:207], v[44:47], v[112:115]
  v_mfma_f32_16x16x32_bf16 v[120:123], v[236:239], v[44:47], v[120:123]
  s_waitcnt vmcnt(11)
  v_mfma_f32_16x16x32_bf16 v[96:99], v[144:147], v[48:51], v[96:99]
  v_mfma_f32_16x16x32_bf16 v[104:107], v[176:179], v[48:51], v[104:107]
  v_mfma_f32_16x16x32_bf16 v[112:115], v[208:211], v[48:51], v[112:115]
  v_mfma_f32_16x16x32_bf16 v[120:123], v[240:243], v[48:51], v[120:123]
  s_waitcnt vmcnt(10)
  v_mfma_f32_16x16x32_bf16 v[96:99], v[148:151], v[52:55], v[96:99]
  v_mfma_f32_16x16x32_bf16 v[104:107], v[180:183], v[52:55], v[104:107]
  v_mfma_f32_16x16x32_bf16 v[112:115], v[212:215], v[52:55], v[112:115]
  v_mfma_f32_16x16x32_bf16 v[120:123], v[244:247], v[52:55], v[120:123]
  s_waitcnt vmcnt(9)
  v_mfma_f32_16x16x32_bf16 v[96:99], v[152:155], v[56:59], v[96:99]
  v_mfma_f32_16x16x32_bf16 v[104:107], v[184:187], v[56:59], v[104:107]
  v_mfma_f32_16x16x32_bf16 v[112:115], v[216:219], v[56:59], v[112:115]
  v_mfma_f32_16x16x32_bf16 v[120:123], v[248:251], v[56:59], v[120:123]
  s_waitcnt vmcnt(8)
  v_mfma_f32_16x16x32_bf16 v[96:99], v[156:159], v[60:63], v[96:99]
  v_mfma_f32_16x16x32_bf16 v[104:107], v[188:191], v[60:63], v[104:107]
  v_mfma_f32_16x16x32_bf16 v[112:115], v[220:223], v[60:63], v[112:115]
  v_mfma_f32_16x16x32_bf16 v[120:123], v[252:255], v[60:63], v[120:123]
  s_waitcnt vmcnt(7)
  v_mfma_f32_16x16x32_bf16 v[100:103], v[128:131], v[64:67], 0
  v_mfma_f32_16x16x32_bf16 v[108:111], v[160:163], v[64:67], 0
  v_mfma_f32_16x16x32_bf16 v[116:119], v[192:195], v[64:67], 0
  v_mfma_f32_16x16x32_bf16 v[124:127], v[224:227], v[64:67], 0
  s_waitcnt vmcnt(6)
  v_mfma_f32_16x16x32_bf16 v[100:103], v[132:135], v[68:71], v[100:103]
  v_mfma_f32_16x16x32_bf16 v[108:111], v[164:167], v[68:71], v[108:111]
  v_mfma_f32_16x16x32_bf16 v[116:119], v[196:199], v[68:71], v[116:119]
  v_mfma_f32_16x16x32_bf16 v[124:127], v[228:231], v[68:71], v[124:127]
  s_waitcnt vmcnt(5)
  v_mfma_f32_16x16x32_bf16 v[100:103], v[136:139], v[72:75], v[100:103]
  v_mfma_f32_16x16x32_bf16 v[108:111], v[168:171], v[72:75], v[108:111]
  v_mfma_f32_16x16x32_bf16 v[116:119], v[200:203], v[72:75], v[116:119]
  v_mfma_f32_16x16x32_bf16 v[124:127], v[232:235], v[72:75], v[124:127]
  s_waitcnt vmcnt(4)
  v_mfma_f32_16x16x32_bf16 v[100:103], v[140:143], v[76:79], v[100:103]
  v_mfma_f32_16x16x32_bf16 v[108:111], v[172:175], v[76:79], v[108:111]
  v_mfma_f32_16x16x32_bf16 v[116:119], v[204:207], v[76:79], v[116:119]
  v_mfma_f32_16x16x32_bf16 v[124:127], v[236:239], v[76:79], v[124:127]
  s_waitcnt vmcnt(3)
  v_mfma_f32_16x16x32_bf16 v[100:103], v[144:147], v[80:83], v[100:103]
  v_mfma_f32_16x16x32_bf16 v[108:111], v[176:179], v[80:83], v[108:111]
  v_mfma_f32_16x16x32_bf16 v[116:119], v[208:211], v[80:83], v[116:119]
  v_mfma_f32_16x16x32_bf16 v[124:127], v[240:243], v[80:83], v[124:127]
  s_waitcnt vmcnt(2)
  v_mfma_f32_16x16x32_bf16 v[100:103], v[148:151], v[84:87], v[100:103]
  v_mfma_f32_16x16x32_bf16 v[108:111], v[180:183], v[84:87], v[108:111]
  v_mfma_f32_16x16x32_bf16 v[116:119], v[212:215], v[84:87], v[116:119]
  v_mfma_f32_16x16x32_bf16 v[124:127], v[244:247], v[84:87], v[124:127]
  s_waitcnt vmcnt(1)
  v_mfma_f32_16x16x32_bf16 v[100:103], v[152:155], v[88:91], v[100:103]
  v_mfma_f32_16x16x32_bf16 v[108:111], v[184:187], v[88:91], v[108:111]
  v_mfma_f32_16x16x32_bf16 v[116:119], v[216:219], v[88:91], v[116:119]
  v_mfma_f32_16x16x32_bf16 v[124:127], v[248:251], v[88:91], v[124:127]
  s_waitcnt vmcnt(0)
  v_mfma_f32_16x16x32_bf16 v[100:103], v[156:159], v[92:95], v[100:103]
  v_mfma_f32_16x16x32_bf16 v[108:111], v[188:191], v[92:95], v[108:111]
  v_mfma_f32_16x16x32_bf16 v[116:119], v[220:223], v[92:95], v[116:119]
  v_mfma_f32_16x16x32_bf16 v[124:127], v[252:255], v[92:95], v[124:127]
  v_and_b32 v14, 63, v0
  v_mov_b32 v13, 0x0
  v_mad_i32_i24 v13, v14, 16, v13
  v_lshrrev_b32 v14, 6, v0
  s_mov_b32 s36, 0x2000
  v_mad_i32_i24 v13, v14, s36, v13
  ds_write_b128 v13, v[96:99] offset:0
  ds_write_b128 v13, v[100:103] offset:1024
  ds_write_b128 v13, v[104:107] offset:2048
  ds_write_b128 v13, v[108:111] offset:3072
  ds_write_b128 v13, v[112:115] offset:4096
  ds_write_b128 v13, v[116:119] offset:5120
  ds_write_b128 v13, v[120:123] offset:6144
  ds_write_b128 v13, v[124:127] offset:7168
  s_waitcnt lgkmcnt(0)
  s_barrier
  ds_read_b128 v[32:35], v16 offset:0
  ds_read_b128 v[36:39], v16 offset:1024
  ds_read_b128 v[40:43], v16 offset:8192
  ds_read_b128 v[44:47], v16 offset:9216
  ds_read_b128 v[48:51], v16 offset:16384
  ds_read_b128 v[52:55], v16 offset:17408
  ds_read_b128 v[56:59], v16 offset:24576
  ds_read_b128 v[60:63], v16 offset:25600
  s_waitcnt lgkmcnt(0)
  v_add_f32 v32, v32, v40
  v_add_f32 v48, v48, v56
  v_add_f32 v32, v32, v48
  v_add_f32 v33, v33, v41
  v_add_f32 v49, v49, v57
  v_add_f32 v33, v33, v49
  v_add_f32 v34, v34, v42
  v_add_f32 v50, v50, v58
  v_add_f32 v34, v34, v50
  v_add_f32 v35, v35, v43
  v_add_f32 v51, v51, v59
  v_add_f32 v35, v35, v51
  v_add_f32 v36, v36, v44
  v_add_f32 v52, v52, v60
  v_add_f32 v36, v36, v52
  v_add_f32 v37, v37, v45
  v_add_f32 v53, v53, v61
  v_add_f32 v37, v37, v53
  v_add_f32 v38, v38, v46
  v_add_f32 v54, v54, v62
  v_add_f32 v38, v38, v54
  v_add_f32 v39, v39, v47
  v_add_f32 v55, v55, v63
  v_add_f32 v39, v39, v55
  s_lshl_b32 s40, s44, 2
  s_add_u32 s40, s40, s54
  s_mul_i32 s40, s40, 81920
  s_lshl_b32 s41, s55, 8
  s_add_u32 s40, s40, s41
  s_add_u32 s40, s40, 117440512
  buffer_store_dwordx4 v[32:35], v17, s[4:7], s40 offen sc1
  s_add_u32 s40, s40, 40960
  buffer_store_dwordx4 v[36:39], v17, s[4:7], s40 offen sc1
  s_waitcnt vmcnt(0)
  s_barrier
  s_cmp_lg_u32 s34, 0
  s_cbranch_scc1 pub_11
  s_mul_i32 s40, s54, 10
  s_add_u32 s40, s40, s55
  s_lshl_b32 s40, s40, 7
  s_add_u32 s40, s40, 36864
  v_and_b32 v13, 63, v0
  v_cmp_eq_u32 vcc, 0, v13
  v_mov_b32 v14, 0x7ffffff0
  s_nop 0
  v_cndmask_b32 v13, v14, 0, vcc
  v_mov_b32 v14, s43
  buffer_store_dword v14, v13, s[4:7], s40 offen sc1
pub_11:
  s_add_u32 s44, s44, 1
  s_cmp_lt_u32 s44, 64
  s_cbranch_scc1 OP_loop
  s_branch L_g2
L_q:
  s_cmp_lg_u32 s34, 0
  s_cbranch_scc1 pd_12
  v_mov_b32 v8, 32
poll_13:
  buffer_load_dword v9, v8, s[8:11], 0 offen sc1
  s_waitcnt vmcnt(0)
  v_cmp_gt_u32 vcc, 40, v9
  s_cbranch_vccz polled_14
  s_sleep 3
  s_add_u32 s35, s35, 1
  s_cmp_lt_u32 s35, 300000
  s_cbranch_scc1 poll_13
polled_14:
pd_12:
  s_barrier
  s_mov_b32 s80, 4
  s_branch L_w2
L_attn:
  s_and_b32 s47, s34, 1
  v_and_b32 v11, 63, v0
  v_mov_b32 v9, 0x0
  v_mad_i32_i24 v9, v11, 16, v9
  v_and_b32 v11, 63, v0
  v_mov_b32 v18, 0x0
  v_mad_i32_i24 v18, v11, 16, v18
  v_bfe_u32 v11, v0, 6, 1
  s_mov_b32 s36, 0x1000
  v_mad_i32_i24 v18, v11, s36, v18
  v_and_b32 v11, 63, v0
  v_mov_b32 v15, 0x0
  v_mad_i32_i24 v15, v11, 16, v15
  v_lshrrev_b32 v11, 7, v0
  s_mov_b32 s36, 0x1000
  v_mad_i32_i24 v15, v11, s36, v15
  v_and_b32 v11, 63, v0
  v_mov_b32 v17, 0x0
  v_mad_i32_i24 v17, v11, 8, v17
  v_lshrrev_b32 v11, 7, v0
  s_mov_b32 s36, 0x800
  v_mad_i32_i24 v17, v11, s36, v17
  v_and_b32 v11, 63, v0
  v_mov_b32 v19, 0x0
  v_mad_i32_i24 v19, v11, 16, v19
  v_bfe_u32 v11, v0, 6, 1
  s_mov_b32 s36, 0x20000
  v_mad_i32_i24 v19, v11, s36, v19
  v_lshrrev_b32 v11, 7, v0
  s_mov_b32 s36, 0x800
  v_mad_i32_i24 v19, v11, s36, v19
  v_and_b32 v12, 63, v0
  s_lshl_b32 s40, s33, 7
  s_add_u32 s41, s40, 16384
  v_mov_b32 v21, s41
  s_add_u32 s41, s40, 20480
  v_mov_b32 v11, s41
  v_cmp_eq_u32 vcc, 1, v12
  s_nop 1
  v_cndmask_b32 v21, v21, v11, vcc
  s_add_u32 s41, s40, 58880
  v_mov_b32 v11, s41
  v_cmp_eq_u32 vcc, 2, v12
  s_nop 1
  v_cndmask_b32 v21, v21, v11, vcc
  s_lshl_b32 s40, s33, 8
  s_add_u32 s41, s40, 24576
  v_mov_b32 v11, s41
  v_cmp_eq_u32 vcc, 3, v12
  s_nop 1
  v_cndmask_b32 v21, v21, v11, vcc
  s_add_u32 s41, s41, 128
  v_mov_b32 v11, s41
  v_cmp_le_u32 vcc, 4, v12
  s_nop 1
  v_cndmask_b32 v21, v21, v11, vcc
  v_bfe_u32 v11, v0, 4, 2
  v_lshlrev_b32 v11, 2, v11
  v_and_b32 v12, 15, v0
  v_sub_u32 v20, v12, v11
  s_mov_b32 s44, 0
Q_loop:
  s_add_u32 s43, s44, 1
  s_mov_b32 exec_lo, 7
  s_mov_b32 exec_hi, 0
poll_15:
  buffer_load_dword v12, v21, s[4:7], 0 offen sc1
  s_waitcnt vmcnt(0)
  v_cmp_gt_u32 vcc, s43, v12
  s_cbranch_vccz polled_16
  s_sleep 2
  s_add_u32 s35, s35, 1
  s_cmp_lt_u32 s35, 300000
  s_cbranch_scc1 poll_15
polled_16:
  s_mov_b64 exec, -1
  s_lshl_b32 s40, s44, 5
  s_add_u32 s40, s40, s33
  s_lshl_b32 s41, s40, 13
  s_add_u32 s42, s41, 184549376
  buffer_load_dwordx4 v[96:99], v18, s[4:7], s42 offen offset:0 sc1
  buffer_load_dwordx4 v[100:103], v18, s[4:7], s42 offen offset:1024 sc1
  buffer_load_dwordx4 v[104:107], v18, s[4:7], s42 offen offset:2048 sc1
  buffer_load_dwordx4 v[108:111], v18, s[4:7], s42 offen offset:3072 sc1
  s_add_u32 s42, s41, 33554432
  buffer_load_dwordx4 v[112:115], v9, s[4:7], s42 offen offset:0 sc1
  buffer_load_dwordx4 v[116:119], v9, s[4:7], s42 offen offset:1024 sc1
  buffer_load_dwordx4 v[120:123], v9, s[4:7], s42 offen offset:2048 sc1
  buffer_load_dwordx4 v[124:127], v9, s[4:7], s42 offen offset:3072 sc1
  s_cmp_eq_u32 s47, 0
  s_cbranch_scc1 nk1_17
  s_add_u32 s42, s42, 4096
  buffer_load_dwordx4 v[128:131], v9, s[4:7], s42 offen offset:0 sc1
  buffer_load_dwordx4 v[132:135], v9, s[4:7], s42 offen offset:1024 sc1
  buffer_load_dwordx4 v[136:139], v9, s[4:7], s42 offen offset:2048 sc1
  buffer_load_dwordx4 v[140:143], v9, s[4:7], s42 offen offset:3072 sc1
nk1_17:
  s_add_u32 s42, s41, 50331648
  buffer_load_dwordx4 v[160:163], v15, s[4:7], s42 offen offset:0 sc1
  buffer_load_dwordx4 v[164:167], v15, s[4:7], s42 offen offset:1024 sc1
  buffer_load_dwordx4 v[168:171], v15, s[4:7], s42 offen offset:2048 sc1
  buffer_load_dwordx4 v[172:175], v15, s[4:7], s42 offen offset:3072 sc1
poll_18:
  buffer_load_dword v12, v21, s[4:7], 0 offen sc1
  s_waitcnt vmcnt(0)
  v_cmp_gt_u32 vcc, s43, v12
  s_cbranch_vccz polled_19
  s_sleep 1
  s_add_u32 s35, s35, 1
  s_cmp_lt_u32 s35, 300000
  s_cbranch_scc1 poll_18
polled_19:
  s_lshl_b32 s41, s40, 12
  s_add_u32 s42, s41, 83886080
  buffer_load_dwordx4 v[144:147], v9, s[4:7], s42 offen offset:0 sc1
  buffer_load_dwordx4 v[148:151], v9, s[4:7], s42 offen offset:1024 sc1
  buffer_load_dwordx4 v[152:155], v9, s[4:7], s42 offen offset:2048 sc1
  buffer_load_dwordx4 v[156:159], v9, s[4:7], s42 offen offset:3072 sc1
  s_add_u32 s42, s41, 100663296
  buffer_load_dwordx2 v[176:177], v17, s[4:7], s42 offen offset:0 sc1
  buffer_load_dwordx2 v[178:179], v17, s[4:7], s42 offen offset:512 sc1
  buffer_load_dwordx2 v[180:181], v17, s[4:7], s42 offen offset:1024 sc1
  buffer_load_dwordx2 v[182:183], v17, s[4:7], s42 offen offset:1536 sc1
  v_mfma_f32_16x16x32_bf16 v[188:191], v[112:115], v[96:99], 0
  v_mfma_f32_16x16x32_bf16 v[192:195], v[128:131], v[96:99], 0
  v_mfma_f32_16x16x32_bf16 v[188:191], v[116:119], v[100:103], v[188:191]
  v_mfma_f32_16x16x32_bf16 v[192:195], v[132:135], v[100:103], v[192:195]
  v_mfma_f32_16x16x32_bf16 v[188:191], v[120:123], v[104:107], v[188:191]
  v_mfma_f32_16x16x32_bf16 v[192:195], v[136:139], v[104:107], v[192:195]
  v_mfma_f32_16x16x32_bf16 v[188:191], v[124:127], v[108:111], v[188:191]
  v_mfma_f32_16x16x32_bf16 v[192:195], v[140:143], v[108:111], v[192:195]
  s_waitcnt vmcnt(7)
  v_mfma_f32_16x16x32_bf16 v[184:187], v[144:147], v[96:99], 0
  s_waitcnt vmcnt(6)
  v_mfma_f32_16x16x32_bf16 v[184:187], v[148:151], v[100:103], v[184:187]
  s_waitcnt vmcnt(5)
  v_mfma_f32_16x16x32_bf16 v[184:187], v[152:155], v[104:107], v[184:187]
  s_waitcnt vmcnt(4)
  v_mfma_f32_16x16x32_bf16 v[184:187], v[156:159], v[108:111], v[184:187]
  v_mov_b32 v13, 0xff800000
  s_cmp_eq_u32 s47, 1
  s_cbranch_scc1 t1_20
  v_cmp_le_i32 vcc, 0, v20
  s_nop 1
  v_cndmask_b32 v188, v13, v188, vcc
  v_mov_b32 v192, v13
  v_cmp_le_i32 vcc, 1, v20
  s_nop 1
  v_cndmask_b32 v189, v13, v189, vcc
  v_mov_b32 v193, v13
  v_cmp_le_i32 vcc, 2, v20
  s_nop 1
  v_cndmask_b32 v190, v13, v190, vcc
  v_mov_b32 v194, v13
  v_cmp_le_i32 vcc, 3, v20
  s_nop 1
  v_cndmask_b32 v191, v13, v191, vcc
  v_mov_b32 v195, v13
  s_branch tb_21
t1_20:
  v_cmp_le_i32 vcc, 0, v20
  s_nop 1
  v_cndmask_b32 v192, v13, v192, vcc
  v_cmp_le_i32 vcc, 1, v20
  s_nop 1
  v_cndmask_b32 v193, v13, v193, vcc
  v_cmp_le_i32 vcc, 2, v20
  s_nop 1
  v_cndmask_b32 v194, v13, v194, vcc
  v_cmp_le_i32 vcc, 3, v20
  s_nop 1
  v_cndmask_b32 v195, v13, v195, vcc
tb_21:
  v_max3_f32 v11, v184, v185, v186
  v_max3_f32 v11, v11, v187, v188
  v_max3_f32 v11, v11, v189, v190
  v_max3_f32 v11, v11, v191, v192
  v_max3_f32 v11, v11, v193, v194
  v_max_f32 v11, v11, v195
  v_mov_b32 v12, v11
  s_nop 1
  v_permlane16_swap_b32 v11, v12
  v_max_f32 v11, v11, v12
  v_mov_b32 v12, v11
  s_nop 1
  v_permlane32_swap_b32 v11, v12
  v_max_f32 v11, v11, v12
  s_mov_b32 s40, 0x3e0293ee
  v_mul_f32 v11, s40, v11
  v_fma_f32 v184, v184, s40, -v11
  v_fma_f32 v185, v185, s40, -v11
  v_fma_f32 v186, v186, s40, -v11
  v_fma_f32 v187, v187, s40, -v11
  v_fma_f32 v188, v188, s40, -v11
  v_fma_f32 v189, v189, s40, -v11
  v_fma_f32 v190, v190, s40, -v11
  v_fma_f32 v191, v191, s40, -v11
  v_fma_f32 v192, v192, s40, -v11
  v_fma_f32 v193, v193, s40, -v11
  v_fma_f32 v194, v194, s40, -v11
  v_fma_f32 v195, v195, s40, -v11
  v_exp_f32 v184, v184
  v_exp_f32 v185, v185
  v_exp_f32 v186, v186
  v_exp_f32 v187, v187
  v_exp_f32 v188, v188
  v_exp_f32 v189, v189
  v_exp_f32 v190, v190
  v_exp_f32 v191, v191
  v_exp_f32 v192, v192
  v_exp_f32 v193, v193
  v_exp_f32 v194, v194
  v_exp_f32 v195, v195
  v_add_f32 v11, v184, v185
  v_add_f32 v12, v186, v187
  v_add_f32 v11, v11, v12
  v_mul_f32 v11, 0.5, v11
  v_add_f32 v11, v11, v188
  v_add_f32 v11, v11, v189
  v_add_f32 v11, v11, v190
  v_add_f32 v11, v11, v191
  v_add_f32 v11, v11, v192
  v_add_f32 v11, v11, v193
  v_add_f32 v11, v11, v194
  v_add_f32 v11, v11, v195
  v_mov_b32 v12, v11
  s_nop 1
  v_permlane16_swap_b32 v11, v12
  v_add_f32 v11, v11, v12
  v_mov_b32 v12, v11
  s_nop 1
  v_permlane32_swap_b32 v11, v12
  v_add_f32 v11, v11, v12
  v_rcp_f32 v13, v11
  v_cvt_pk_bf16_f32 v204, v184, v185
  v_cvt_pk_bf16_f32 v205, v186, v187
  v_cvt_pk_bf16_f32 v196, v188, v189
  v_cvt_pk_bf16_f32 v197, v190, v191
  v_cvt_pk_bf16_f32 v198, v192, v193
  v_cvt_pk_bf16_f32 v199, v194, v195
  s_waitcnt vmcnt(0)
  v_mfma_f32_16x16x16_bf16 v[208:211], v[176:177], v[204:205], 0
  v_mfma_f32_16x16x16_bf16 v[212:215], v[178:179], v[204:205], 0
  v_mfma_f32_16x16x16_bf16 v[216:219], v[180:181], v[204:205], 0
  v_mfma_f32_16x16x16_bf16 v[220:223], v[182:183], v[204:205], 0
  s_nop 2
  v_mfma_f32_16x16x32_bf16 v[208:211], v[160:163], v[196:199], v[208:211]
  v_mfma_f32_16x16x32_bf16 v[212:215], v[164:167], v[196:199], v[212:215]
  v_mfma_f32_16x16x32_bf16 v[216:219], v[168:171], v[196:199], v[216:219]
  v_mfma_f32_16x16x32_bf16 v[220:223], v[172:175], v[196:199], v[220:223]
  v_mul_f32 v208, v208, v13
  v_mul_f32 v209, v209, v13
  v_mul_f32 v210, v210, v13
  v_mul_f32 v211, v211, v13
  v_mul_f32 v212, v212, v13
  v_mul_f32 v213, v213, v13
  v_mul_f32 v214, v214, v13
  v_mul_f32 v215, v215, v13
  v_mul_f32 v216, v216, v13
  v_mul_f32 v217, v217, v13
  v_mul_f32 v218, v218, v13
  v_mul_f32 v219, v219, v13
  v_mul_f32 v220, v220, v13
  v_mul_f32 v221, v221, v13
  v_mul_f32 v222, v222, v13
  v_mul_f32 v223, v223, v13
  s_lshl_b32 s40, s44, 6
  s_add_u32 s40, s40, s33
  s_lshl_b32 s40, s40, 12
  s_add_u32 s40, s40, 67108864
  v_cvt_pk_bf16_f32 v80, v208, v209
  v_cvt_pk_bf16_f32 v81, v210, v211
  v_cvt_pk_bf16_f32 v82, v212, v213
  v_cvt_pk_bf16_f32 v83, v214, v215
  buffer_store_dwordx4 v[80:83], v19, s[4:7], s40 offen offset:0 sc1
  v_cvt_pk_bf16_f32 v84, v216, v217
  v_cvt_pk_bf16_f32 v85, v218, v219
  v_cvt_pk_bf16_f32 v86, v220, v221
  v_cvt_pk_bf16_f32 v87, v222, v223
  buffer_store_dwordx4 v[84:87], v19, s[4:7], s40 offen offset:1024 sc1
  s_waitcnt vmcnt(0)
  s_barrier
  s_cmp_lg_u32 s34, 0
  s_cbranch_scc1 pub_22
  s_lshl_b32 s42, s33, 7
  s_add_u32 s42, s42, 32768
  v_and_b32 v11, 63, v0
  v_cmp_eq_u32 vcc, 0, v11
  v_mov_b32 v12, 0x7ffffff0
  s_nop 0
  v_cndmask_b32 v11, v12, 0, vcc
  v_mov_b32 v12, s43
  buffer_store_dword v12, v11, s[4:7], s42 offen sc1
pub_22:
  s_add_u32 s44, s44, 1
  s_cmp_lt_u32 s44, 64
  s_cbranch_scc1 Q_loop
  s_branch L_g2
L_qp:
  s_load_dwordx2 s[20:21], s[0:1], 16
  s_mov_b32 s22, 0x500000
  s_mov_b32 s23, 0x00020000
  s_waitcnt lgkmcnt(0)
  v_bfe_u32 v14, v0, 4, 2
  v_mov_b32 v8, 0x0
  s_mov_b32 s36, 0x2000
  v_mad_i32_i24 v8, v14, s36, v8
  v_and_b32 v14, 15, v0
  v_mov_b32 v9, 0x0
  v_mad_i32_i24 v9, v14, 16, v9
  v_bfe_u32 v15, v0, 4, 2
  v_mov_b32 v14, 0x0
  v_mad_i32_i24 v14, v15, 32, v14
  v_xor_b32 v9, v9, v14
  v_add_u32 v8, v8, v9
  v_xor_b32 v9, 128, v8
  s_lshl_b32 s41, s33, 8
  s_mul_i32 s42, s34, 262144
  s_add_u32 s41, s41, s42
  s_add_u32 s41, s41, 0
  s_lshl_b32 s42, s34, 13
  s_add_u32 s42, s42, 0
  s_mov_b32 m0, s42
  s_nop 0
  buffer_load_dwordx4 v8, s[20:23], s41 offen lds
  s_add_u32 s41, s41, 32768
  s_add_u32 s42, s42, 1024
  s_mov_b32 m0, s42
  s_nop 0
  buffer_load_dwordx4 v8, s[20:23], s41 offen lds
  s_add_u32 s41, s41, 32768
  s_add_u32 s42, s42, 1024
  s_mov_b32 m0, s42
  s_nop 0
  buffer_load_dwordx4 v9, s[20:23], s41 offen lds
  s_add_u32 s41, s41, 32768
  s_add_u32 s42, s42, 1024
  s_mov_b32 m0, s42
  s_nop 0
  buffer_load_dwordx4 v9, s[20:23], s41 offen lds
  s_add_u32 s41, s41, 32768
  s_add_u32 s42, s42, 1024
  s_mov_b32 m0, s42
  s_nop 0
  buffer_load_dwordx4 v8, s[20:23], s41 offen lds
  s_add_u32 s41, s41, 32768
  s_add_u32 s42, s42, 1024
  s_mov_b32 m0, s42
  s_nop 0
  buffer_load_dwordx4 v8, s[20:23], s41 offen lds
  s_add_u32 s41, s41, 32768
  s_add_u32 s42, s42, 1024
  s_mov_b32 m0, s42
  s_nop 0
  buffer_load_dwordx4 v9, s[20:23], s41 offen lds
  s_add_u32 s41, s41, 32768
  s_add_u32 s42, s42, 1024
  s_mov_b32 m0, s42
  s_nop 0
  buffer_load_dwordx4 v9, s[20:23], s41 offen lds
  s_lshl_b32 s41, s33, 8
  s_mul_i32 s42, s34, 262144
  s_add_u32 s41, s41, s42
  s_add_u32 s41, s41, 1048576
  s_lshl_b32 s42, s34, 13
  s_add_u32 s42, s42, 32768
  s_mov_b32 m0, s42
  s_nop 0
  buffer_load_dwordx4 v8, s[20:23], s41 offen lds
  s_add_u32 s41, s41, 32768
  s_add_u32 s42, s42, 1024
  s_mov_b32 m0, s42
  s_nop 0
  buffer_load_dwordx4 v8, s[20:23], s41 offen lds
  s_add_u32 s41, s41, 32768
  s_add_u32 s42, s42, 1024
  s_mov_b32 m0, s42
  s_nop 0
  buffer_load_dwordx4 v9, s[20:23], s41 offen lds
  s_add_u32 s41, s41, 32768
  s_add_u32 s42, s42, 1024
  s_mov_b32 m0, s42
  s_nop 0
  buffer_load_dwordx4 v9, s[20:23], s41 offen lds
  s_add_u32 s41, s41, 32768
  s_add_u32 s42, s42, 1024
  s_mov_b32 m0, s42
  s_nop 0
  buffer_load_dwordx4 v8, s[20:23], s41 offen lds
  s_add_u32 s41, s41, 32768
  s_add_u32 s42, s42, 1024
  s_mov_b32 m0, s42
  s_nop 0
  buffer_load_dwordx4 v8, s[20:23], s41 offen lds
  s_add_u32 s41, s41, 32768
  s_add_u32 s42, s42, 1024
  s_mov_b32 m0, s42
  s_nop 0
  buffer_load_dwordx4 v9, s[20:23], s41 offen lds
  s_add_u32 s41, s41, 32768
  s_add_u32 s42, s42, 1024
  s_mov_b32 m0, s42
  s_nop 0
  buffer_load_dwordx4 v9, s[20:23], s41 offen lds
  s_lshl_b32 s41, s33, 8
  s_mul_i32 s42, s34, 262144
  s_add_u32 s41, s41, s42
  s_add_u32 s41, s41, 2097152
  s_lshl_b32 s42, s34, 13
  s_add_u32 s42, s42, 65536
  s_mov_b32 m0, s42
  s_nop 0
  buffer_load_dwordx4 v8, s[20:23], s41 offen lds
  s_add_u32 s41, s41, 32768
  s_add_u32 s42, s42, 1024
  s_mov_b32 m0, s42
  s_nop 0
  buffer_load_dwordx4 v8, s[20:23], s41 offen lds
  s_add_u32 s41, s41, 32768
  s_add_u32 s42, s42, 1024
  s_mov_b32 m0, s42
  s_nop 0
  buffer_load_dwordx4 v9, s[20:23], s41 offen lds
  s_add_u32 s41, s41, 32768
  s_add_u32 s42, s42, 1024
  s_mov_b32 m0, s42
  s_nop 0
  buffer_load_dwordx4 v9, s[20:23], s41 offen lds
  s_add_u32 s41, s41, 32768
  s_add_u32 s42, s42, 1024
  s_mov_b32 m0, s42
  s_nop 0
  buffer_load_dwordx4 v8, s[20:23], s41 offen lds
  s_add_u32 s41, s41, 32768
  s_add_u32 s42, s42, 1024
  s_mov_b32 m0, s42
  s_nop 0
  buffer_load_dwordx4 v8, s[20:23], s41 offen lds
  s_add_u32 s41, s41, 32768
  s_add_u32 s42, s42, 1024
  s_mov_b32 m0, s42
  s_nop 0
  buffer_load_dwordx4 v9, s[20:23], s41 offen lds
  s_add_u32 s41, s41, 32768
  s_add_u32 s42, s42, 1024
  s_mov_b32 m0, s42
  s_nop 0
  buffer_load_dwordx4 v9, s[20:23], s41 offen lds
  s_lshl_b32 s41, s33, 8
  s_mul_i32 s42, s34, 262144
  s_add_u32 s41, s41, s42
  s_add_u32 s41, s41, 3145728
  s_lshl_b32 s42, s34, 13
  s_add_u32 s42, s42, 98304
  s_mov_b32 m0, s42
  s_nop 0
  buffer_load_dwordx4 v8, s[20:23], s41 offen lds
  s_add_u32 s41, s41, 32768
  s_add_u32 s42, s42, 1024
  s_mov_b32 m0, s42
  s_nop 0
  buffer_load_dwordx4 v8, s[20:23], s41 offen lds
  s_add_u32 s41, s41, 32768
  s_add_u32 s42, s42, 1024
  s_mov_b32 m0, s42
  s_nop 0
  buffer_load_dwordx4 v9, s[20:23], s41 offen lds
  s_add_u32 s41, s41, 32768
  s_add_u32 s42, s42, 1024
  s_mov_b32 m0, s42
  s_nop 0
  buffer_load_dwordx4 v9, s[20:23], s41 offen lds
  s_add_u32 s41, s41, 32768
  s_add_u32 s42, s42, 1024
  s_mov_b32 m0, s42
  s_nop 0
  buffer_load_dwordx4 v8, s[20:23], s41 offen lds
  s_add_u32 s41, s41, 32768
  s_add_u32 s42, s42, 1024
  s_mov_b32 m0, s42
  s_nop 0
  buffer_load_dwordx4 v8, s[20:23], s41 offen lds
  s_add_u32 s41, s41, 32768
  s_add_u32 s42, s42, 1024
  s_mov_b32 m0, s42
  s_nop 0
  buffer_load_dwordx4 v9, s[20:23], s41 offen lds
  s_add_u32 s41, s41, 32768
  s_add_u32 s42, s42, 1024
  s_mov_b32 m0, s42
  s_nop 0
  buffer_load_dwordx4 v9, s[20:23], s41 offen lds
  v_bfe_u32 v14, v0, 1, 1
  v_mov_b32 v10, 0x0
  v_mad_i32_i24 v10, v14, 1, v10
  v_lshrrev_b32 v14, 6, v0
  v_mad_i32_i24 v10, v14, 4, v10
  v_bfe_u32 v14, v0, 2, 3
  v_mov_b32 v11, 0x0
  v_mad_i32_i24 v11, v14, 2, v11
  v_xor_b32 v10, v10, v11
  v_lshlrev_b32 v10, 4, v10
  v_and_b32 v14, 1, v0
  v_mov_b32 v11, 0x0
  v_mad_i32_i24 v11, v14, 8, v11
  v_bfe_u32 v14, v0, 2, 2
  s_mov_b32 s36, 0x100
  v_mad_i32_i24 v11, v14, s36, v11
  v_bfe_u32 v14, v0, 4, 2
  s_mov_b32 s36, 0x800
  v_mad_i32_i24 v11, v14, s36, v11
  v_add_u32 v10, v10, v11
  v_xor_b32 v11, 32, v10
  v_add_u32 v12, 0x10000, v10
  v_add_u32 v13, 0x10000, v11
  s_waitcnt vmcnt(24)
  s_barrier
  ds_read_b64_tr_b16 a[0:1], v10 offset:0
  ds_read_b64_tr_b16 a[2:3], v10 offset:1024
  ds_read_b64_tr_b16 a[80:81], v11 offset:0
  ds_read_b64_tr_b16 a[82:83], v11 offset:1024
  ds_read_b64_tr_b16 a[4:5], v10 offset:8192
  ds_read_b64_tr_b16 a[6:7], v10 offset:9216
  ds_read_b64_tr_b16 a[84:85], v11 offset:8192
  ds_read_b64_tr_b16 a[86:87], v11 offset:9216
  ds_read_b64_tr_b16 a[8:9], v10 offset:16384
  ds_read_b64_tr_b16 a[10:11], v10 offset:17408
  ds_read_b64_tr_b16 a[88:89], v11 offset:16384
  ds_read_b64_tr_b16 a[90:91], v11 offset:17408
  ds_read_b64_tr_b16 a[12:13], v10 offset:24576
  ds_read_b64_tr_b16 a[14:15], v10 offset:25600
  ds_read_b64_tr_b16 a[92:93], v11 offset:24576
  ds_read_b64_tr_b16 a[94:95], v11 offset:25600
  s_waitcnt lgkmcnt(0)
  s_barrier
  s_lshl_b32 s41, s33, 8
  s_mul_i32 s42, s34, 262144
  s_add_u32 s41, s41, s42
  s_add_u32 s41, s41, 4194304
  s_lshl_b32 s42, s34, 13
  s_add_u32 s42, s42, 0
  s_mov_b32 m0, s42
  s_nop 0
  buffer_load_dwordx4 v8, s[20:23], s41 offen lds
  s_add_u32 s41, s41, 32768
  s_add_u32 s42, s42, 1024
  s_mov_b32 m0, s42
  s_nop 0
  buffer_load_dwordx4 v8, s[20:23], s41 offen lds
  s_add_u32 s41, s41, 32768
  s_add_u32 s42, s42, 1024
  s_mov_b32 m0, s42
  s_nop 0
  buffer_load_dwordx4 v9, s[20:23], s41 offen lds
  s_add_u32 s41, s41, 32768
  s_add_u32 s42, s42, 1024
  s_mov_b32 m0, s42
  s_nop 0
  buffer_load_dwordx4 v9, s[20:23], s41 offen lds
  s_add_u32 s41, s41, 32768
  s_add_u32 s42, s42, 1024
  s_mov_b32 m0, s42
  s_nop 0
  buffer_load_dwordx4 v8, s[20:23], s41 offen lds
  s_add_u32 s41, s41, 32768
  s_add_u32 s42, s42, 1024
  s_mov_b32 m0, s42
  s_nop 0
  buffer_load_dwordx4 v8, s[20:23], s41 offen lds
  s_add_u32 s41, s41, 32768
  s_add_u32 s42, s42, 1024
  s_mov_b32 m0, s42
  s_nop 0
  buffer_load_dwordx4 v9, s[20:23], s41 offen lds
  s_add_u32 s41, s41, 32768
  s_add_u32 s42, s42, 1024
  s_mov_b32 m0, s42
  s_nop 0
  buffer_load_dwordx4 v9, s[20:23], s41 offen lds
  s_waitcnt vmcnt(24)
  s_barrier
  ds_read_b64_tr_b16 a[16:17], v10 offset:32768
  ds_read_b64_tr_b16 a[18:19], v10 offset:33792
  ds_read_b64_tr_b16 a[96:97], v11 offset:32768
  ds_read_b64_tr_b16 a[98:99], v11 offset:33792
  ds_read_b64_tr_b16 a[20:21], v10 offset:40960
  ds_read_b64_tr_b16 a[22:23], v10 offset:41984
  ds_read_b64_tr_b16 a[100:101], v11 offset:40960
  ds_read_b64_tr_b16 a[102:103], v11 offset:41984
  ds_read_b64_tr_b16 a[24:25], v10 offset:49152
  ds_read_b64_tr_b16 a[26:27], v10 offset:50176
  ds_read_b64_tr_b16 a[104:105], v11 offset:49152
  ds_read_b64_tr_b16 a[106:107], v11 offset:50176
  ds_read_b64_tr_b16 a[28:29], v10 offset:57344
  ds_read_b64_tr_b16 a[30:31], v10 offset:58368
  ds_read_b64_tr_b16 a[108:109], v11 offset:57344
  ds_read_b64_tr_b16 a[110:111], v11 offset:58368
  s_waitcnt vmcnt(16)
  s_barrier
  ds_read_b64_tr_b16 a[32:33], v12 offset:0
  ds_read_b64_tr_b16 a[34:35], v12 offset:1024
  ds_read_b64_tr_b16 a[112:113], v13 offset:0
  ds_read_b64_tr_b16 a[114:115], v13 offset:1024
  ds_read_b64_tr_b16 a[36:37], v12 offset:8192
  ds_read_b64_tr_b16 a[38:39], v12 offset:9216
  ds_read_b64_tr_b16 a[116:117], v13 offset:8192
  ds_read_b64_tr_b16 a[118:119], v13 offset:9216
  ds_read_b64_tr_b16 a[40:41], v12 offset:16384
  ds_read_b64_tr_b16 a[42:43], v12 offset:17408
  ds_read_b64_tr_b16 a[120:121], v13 offset:16384
  ds_read_b64_tr_b16 a[122:123], v13 offset:17408
  ds_read_b64_tr_b16 a[44:45], v12 offset:24576
  ds_read_b64_tr_b16 a[46:47], v12 offset:25600
  ds_read_b64_tr_b16 a[124:125], v13 offset:24576
  ds_read_b64_tr_b16 a[126:127], v13 offset:25600
  s_waitcnt vmcnt(8)
  s_barrier
  ds_read_b64_tr_b16 a[48:49], v12 offset:32768
  ds_read_b64_tr_b16 a[50:51], v12 offset:33792
  ds_read_b64_tr_b16 a[128:129], v13 offset:32768
  ds_read_b64_tr_b16 a[130:131], v13 offset:33792
  ds_read_b64_tr_b16 a[52:53], v12 offset:40960
  ds_read_b64_tr_b16 a[54:55], v12 offset:41984
  ds_read_b64_tr_b16 a[132:133], v13 offset:40960
  ds_read_b64_tr_b16 a[134:135], v13 offset:41984
  ds_read_b64_tr_b16 a[56:57], v12 offset:49152
  ds_read_b64_tr_b16 a[58:59], v12 offset:50176
  ds_read_b64_tr_b16 a[136:137], v13 offset:49152
  ds_read_b64_tr_b16 a[138:139], v13 offset:50176
  ds_read_b64_tr_b16 a[60:61], v12 offset:57344
  ds_read_b64_tr_b16 a[62:63], v12 offset:58368
  ds_read_b64_tr_b16 a[140:141], v13 offset:57344
  ds_read_b64_tr_b16 a[142:143], v13 offset:58368
  s_waitcnt vmcnt(0)
  s_barrier
  ds_read_b64_tr_b16 a[64:65], v10 offset:0
  ds_read_b64_tr_b16 a[66:67], v10 offset:1024
  ds_read_b64_tr_b16 a[144:145], v11 offset:0
  ds_read_b64_tr_b16 a[146:147], v11 offset:1024
  ds_read_b64_tr_b16 a[68:69], v10 offset:8192
  ds_read_b64_tr_b16 a[70:71], v10 offset:9216
  ds_read_b64_tr_b16 a[148:149], v11 offset:8192
  ds_read_b64_tr_b16 a[150:151], v11 offset:9216
  ds_read_b64_tr_b16 a[72:73], v10 offset:16384
  ds_read_b64_tr_b16 a[74:75], v10 offset:17408
  ds_read_b64_tr_b16 a[152:153], v11 offset:16384
  ds_read_b64_tr_b16 a[154:155], v11 offset:17408
  ds_read_b64_tr_b16 a[76:77], v10 offset:24576
  ds_read_b64_tr_b16 a[78:79], v10 offset:25600
  ds_read_b64_tr_b16 a[156:157], v11 offset:24576
  ds_read_b64_tr_b16 a[158:159], v11 offset:25600
  s_waitcnt lgkmcnt(0)
  s_barrier
  s_cmp_lg_u32 s34, 0
  s_cbranch_scc1 pd_23
  v_mov_b32 v8, 32
poll_24:
  buffer_load_dword v9, v8, s[8:11], 0 offen sc1
  s_waitcnt vmcnt(0)
  v_cmp_gt_u32 vcc, 40, v9
  s_cbranch_vccz polled_25
  s_sleep 3
  s_add_u32 s35, s35, 1
  s_cmp_lt_u32 s35, 300000
  s_cbranch_scc1 poll_24
polled_25:
pd_23:
  s_barrier
  v_and_b32 v12, 63, v0
  v_min_u32 v12, 63, v12
  v_lshlrev_b32 v12, 7, v12
  v_add_u32 v11, 0x0, v12
  s_cmp_lg_u32 s34, 0
  s_cbranch_scc1 pw_26
poll_27:
  buffer_load_dword v12, v11, s[4:7], 0 offen sc1
  s_waitcnt vmcnt(0)
  v_cmp_gt_u32 vcc, 1, v12
  s_cbranch_vccz polled_28
  s_sleep 3
  s_add_u32 s35, s35, 1
  s_cmp_lt_u32 s35, 300000
  s_cbranch_scc1 poll_27
polled_28:
pw_26:
  s_barrier
  v_and_b32 v12, 63, v0
  v_min_u32 v12, 63, v12
  v_lshlrev_b32 v12, 7, v12
  v_add_u32 v11, 0x2000, v12
  s_cmp_lg_u32 s34, 0
  s_cbranch_scc1 pw_29
poll_30:
  buffer_load_dword v12, v11, s[4:7], 0 offen sc1
  s_waitcnt vmcnt(0)
  v_cmp_gt_u32 vcc, 1, v12
  s_cbranch_vccz polled_31
  s_sleep 3
  s_add_u32 s35, s35, 1
  s_cmp_lt_u32 s35, 300000
  s_cbranch_scc1 poll_30
polled_31:
pw_29:
  s_barrier
  v_and_b32 v11, 63, v0
  v_mov_b32 v9, 0x0
  v_mad_i32_i24 v9, v11, 16, v9
  v_lshrrev_b32 v11, 0, v0
  v_mov_b32 v10, 0x0
  v_mad_i32_i24 v10, v11, 16, v10
  s_mov_b32 s44, 0
  s_mov_b32 s45, 0
  s_mul_i32 s41, s44, 40960
  s_mul_i32 s42, s34, 10240
  s_add_u32 s41, s41, s42
  s_add_u32 s41, s41, 4194304
  s_add_u32 s42, s42, s45
  s_mov_b32 m0, s42
  s_nop 0
  buffer_load_dwordx4 v9, s[4:7], s41 offen offset:0 sc1 lds
  buffer_load_dwordx4 v9, s[4:7], s41 offen offset:1024 sc1 lds
  buffer_load_dwordx4 v9, s[4:7], s41 offen offset:2048 sc1 lds
  buffer_load_dwordx4 v9, s[4:7], s41 offen offset:3072 sc1 lds
  s_add_u32 s41, s41, 4096
  s_add_u32 s42, s42, 4096
  s_mov_b32 m0, s42
  s_nop 0
  buffer_load_dwordx4 v9, s[4:7], s41 offen offset:0 sc1 lds
  buffer_load_dwordx4 v9, s[4:7], s41 offen offset:1024 sc1 lds
  buffer_load_dwordx4 v9, s[4:7], s41 offen offset:2048 sc1 lds
  buffer_load_dwordx4 v9, s[4:7], s41 offen offset:3072 sc1 lds
  s_add_u32 s41, s41, 4096
  s_add_u32 s42, s42, 4096
  s_mov_b32 m0, s42
  s_nop 0
  buffer_load_dwordx4 v9, s[4:7], s41 offen offset:0 sc1 lds
  buffer_load_dwordx4 v9, s[4:7], s41 offen offset:1024 sc1 lds
QP_loop:
  s_waitcnt vmcnt(0)
  s_barrier
  s_cmp_lg_u32 s34, 0
  s_cbranch_scc1 pub_32
  s_lshl_b32 s40, s33, 7
  s_add_u32 s40, s40, 58880
  v_and_b32 v11, 63, v0
  v_cmp_eq_u32 vcc, 0, v11
  v_mov_b32 v12, 0x7ffffff0
  s_nop 0
  v_cndmask_b32 v11, v12, 0, vcc
  v_mov_b32 v12, s44
  buffer_store_dword v12, v11, s[4:7], s40 offen sc1
pub_32:
  v_add_u32 v8, s45, v9
  s_xor_b32 s45, s45, 40960
  s_add_u32 s46, s44, 1
  s_cmp_ge_u32 s46, 64
  s_cbranch_scc1 nonext_33
  s_mul_i32 s41, s46, 40960
  s_mul_i32 s42, s34, 10240
  s_add_u32 s41, s41, s42
  s_add_u32 s41, s41, 4194304
  s_add_u32 s42, s42, s45
  s_mov_b32 m0, s42
  s_nop 0
  buffer_load_dwordx4 v9, s[4:7], s41 offen offset:0 sc1 lds
  buffer_load_dwordx4 v9, s[4:7], s41 offen offset:1024 sc1 lds
  buffer_load_dwordx4 v9, s[4:7], s41 offen offset:2048 sc1 lds
  buffer_load_dwordx4 v9, s[4:7], s41 offen offset:3072 sc1 lds
  s_add_u32 s41, s41, 4096
  s_add_u32 s42, s42, 4096
  s_mov_b32 m0, s42
  s_nop 0
  buffer_load_dwordx4 v9, s[4:7], s41 offen offset:0 sc1 lds
  buffer_load_dwordx4 v9, s[4:7], s41 offen offset:1024 sc1 lds
  buffer_load_dwordx4 v9, s[4:7], s41 offen offset:2048 sc1 lds
  buffer_load_dwordx4 v9, s[4:7], s41 offen offset:3072 sc1 lds
  s_add_u32 s41, s41, 4096
  s_add_u32 s42, s42, 4096
  s_mov_b32 m0, s42
  s_nop 0
  buffer_load_dwordx4 v9, s[4:7], s41 offen offset:0 sc1 lds
  buffer_load_dwordx4 v9, s[4:7], s41 offen offset:1024 sc1 lds
nonext_33:
  ds_read_b128 v[48:51], v8 offset:0
  ds_read_b128 v[52:55], v8 offset:20480
  ds_read_b128 v[56:59], v8 offset:1024
  ds_read_b128 v[60:63], v8 offset:21504
  ds_read_b128 v[64:67], v8 offset:2048
  s_waitcnt lgkmcnt(4)
  v_mfma_f32_16x16x32_bf16 v[32:35], a[0:3], v[48:51], 0
  ds_read_b128 v[68:71], v8 offset:22528
  v_mfma_f32_16x16x32_bf16 v[40:43], a[80:83], v[48:51], 0
  s_waitcnt lgkmcnt(4)
  v_mfma_f32_16x16x32_bf16 v[36:39], a[0:3], v[52:55], 0
  ds_read_b128 v[48:51], v8 offset:3072
  v_mfma_f32_16x16x32_bf16 v[44:47], a[80:83], v[52:55], 0
  s_waitcnt lgkmcnt(4)
  v_mfma_f32_16x16x32_bf16 v[32:35], a[4:7], v[56:59], v[32:35]
  ds_read_b128 v[52:55], v8 offset:23552
  v_mfma_f32_16x16x32_bf16 v[40:43], a[84:87], v[56:59], v[40:43]
  s_waitcnt lgkmcnt(4)
  v_mfma_f32_16x16x32_bf16 v[36:39], a[4:7], v[60:63], v[36:39]
  ds_read_b128 v[56:59], v8 offset:4096
  v_mfma_f32_16x16x32_bf16 v[44:47], a[84:87], v[60:63], v[44:47]
  s_waitcnt lgkmcnt(4)
  v_mfma_f32_16x16x32_bf16 v[32:35], a[8:11], v[64:67], v[32:35]
  ds_read_b128 v[60:63], v8 offset:24576
  v_mfma_f32_16x16x32_bf16 v[40:43], a[88:91], v[64:67], v[40:43]
  s_waitcnt lgkmcnt(4)
  v_mfma_f32_16x16x32_bf16 v[36:39], a[8:11], v[68:71], v[36:39]
  ds_read_b128 v[64:67], v8 offset:5120
  v_mfma_f32_16x16x32_bf16 v[44:47], a[88:91], v[68:71], v[44:47]
  s_waitcnt lgkmcnt(4)
  v_mfma_f32_16x16x32_bf16 v[32:35], a[12:15], v[48:51], v[32:35]
  ds_read_b128 v[68:71], v8 offset:25600
  v_mfma_f32_16x16x32_bf16 v[40:43], a[92:95], v[48:51], v[40:43]
  s_waitcnt lgkmcnt(4)
  v_mfma_f32_16x16x32_bf16 v[36:39], a[12:15], v[52:55], v[36:39]
  ds_read_b128 v[48:51], v8 offset:6144
  v_mfma_f32_16x16x32_bf16 v[44:47], a[92:95], v[52:55], v[44:47]
  s_waitcnt lgkmcnt(4)
  v_mfma_f32_16x16x32_bf16 v[32:35], a[16:19], v[56:59], v[32:35]
  ds_read_b128 v[52:55], v8 offset:26624
  v_mfma_f32_16x16x32_bf16 v[40:43], a[96:99], v[56:59], v[40:43]
  s_waitcnt lgkmcnt(4)
  v_mfma_f32_16x16x32_bf16 v[36:39], a[16:19], v[60:63], v[36:39]
  ds_read_b128 v[56:59], v8 offset:7168
  v_mfma_f32_16x16x32_bf16 v[44:47], a[96:99], v[60:63], v[44:47]
  s_waitcnt lgkmcnt(4)
  v_mfma_f32_16x16x32_bf16 v[32:35], a[20:23], v[64:67], v[32:35]
  ds_read_b128 v[60:63], v8 offset:27648
  v_mfma_f32_16x16x32_bf16 v[40:43], a[100:103], v[64:67], v[40:43]
  s_waitcnt lgkmcnt(4)
  v_mfma_f32_16x16x32_bf16 v[36:39], a[20:23], v[68:71], v[36:39]
  ds_read_b128 v[64:67], v8 offset:8192
  v_mfma_f32_16x16x32_bf16 v[44:47], a[100:103], v[68:71], v[44:47]
  s_waitcnt lgkmcnt(4)
  v_mfma_f32_16x16x32_bf16 v[32:35], a[24:27], v[48:51], v[32:35]
  ds_read_b128 v[68:71], v8 offset:28672
  v_mfma_f32_16x16x32_bf16 v[40:43], a[104:107], v[48:51], v[40:43]
  s_waitcnt lgkmcnt(4)
  v_mfma_f32_16x16x32_bf16 v[36:39], a[24:27], v[52:55], v[36:39]
  ds_read_b128 v[48:51], v8 offset:9216
  v_mfma_f32_16x16x32_bf16 v[44:47], a[104:107], v[52:55], v[44:47]
  s_waitcnt lgkmcnt(4)
  v_mfma_f32_16x16x32_bf16 v[32:35], a[28:31], v[56:59], v[32:35]
  ds_read_b128 v[52:55], v8 offset:29696
  v_mfma_f32_16x16x32_bf16 v[40:43], a[108:111], v[56:59], v[40:43]
  s_waitcnt lgkmcnt(4)
  v_mfma_f32_16x16x32_bf16 v[36:39], a[28:31], v[60:63], v[36:39]
  ds_read_b128 v[56:59], v8 offset:10240
  v_mfma_f32_16x16x32_bf16 v[44:47], a[108:111], v[60:63], v[44:47]
  s_waitcnt lgkmcnt(4)
  v_mfma_f32_16x16x32_bf16 v[32:35], a[32:35], v[64:67], v[32:35]
  ds_read_b128 v[60:63], v8 offset:30720
  v_mfma_f32_16x16x32_bf16 v[40:43], a[112:115], v[64:67], v[40:43]
  s_waitcnt lgkmcnt(4)
  v_mfma_f32_16x16x32_bf16 v[36:39], a[32:35], v[68:71], v[36:39]
  ds_read_b128 v[64:67], v8 offset:11264
  v_mfma_f32_16x16x32_bf16 v[44:47], a[112:115], v[68:71], v[44:47]
  s_waitcnt lgkmcnt(4)
  v_mfma_f32_16x16x32_bf16 v[32:35], a[36:39], v[48:51], v[32:35]
  ds_read_b128 v[68:71], v8 offset:31744
  v_mfma_f32_16x16x32_bf16 v[40:43], a[116:119], v[48:51], v[40:43]
  s_waitcnt lgkmcnt(4)
  v_mfma_f32_16x16x32_bf16 v[36:39], a[36:39], v[52:55], v[36:39]
  ds_read_b128 v[48:51], v8 offset:12288
  v_mfma_f32_16x16x32_bf16 v[44:47], a[116:119], v[52:55], v[44:47]
  s_waitcnt lgkmcnt(4)
  v_mfma_f32_16x16x32_bf16 v[32:35], a[40:43], v[56:59], v[32:35]
  ds_read_b128 v[52:55], v8 offset:32768
  v_mfma_f32_16x16x32_bf16 v[40:43], a[120:123], v[56:59], v[40:43]
  s_waitcnt lgkmcnt(4)
  v_mfma_f32_16x16x32_bf16 v[36:39], a[40:43], v[60:63], v[36:39]
  ds_read_b128 v[56:59], v8 offset:13312
  v_mfma_f32_16x16x32_bf16 v[44:47], a[120:123], v[60:63], v[44:47]
  s_waitcnt lgkmcnt(4)
  v_mfma_f32_16x16x32_bf16 v[32:35], a[44:47], v[64:67], v[32:35]
  ds_read_b128 v[60:63], v8 offset:33792
  v_mfma_f32_16x16x32_bf16 v[40:43], a[124:127], v[64:67], v[40:43]
  s_waitcnt lgkmcnt(4)
  v_mfma_f32_16x16x32_bf16 v[36:39], a[44:47], v[68:71], v[36:39]
  ds_read_b128 v[64:67], v8 offset:14336
  v_mfma_f32_16x16x32_bf16 v[44:47], a[124:127], v[68:71], v[44:47]
  s_waitcnt lgkmcnt(4)
  v_mfma_f32_16x16x32_bf16 v[32:35], a[48:51], v[48:51], v[32:35]
  ds_read_b128 v[68:71], v8 offset:34816
  v_mfma_f32_16x16x32_bf16 v[40:43], a[128:131], v[48:51], v[40:43]
  s_waitcnt lgkmcnt(4)
  v_mfma_f32_16x16x32_bf16 v[36:39], a[48:51], v[52:55], v[36:39]
  ds_read_b128 v[48:51], v8 offset:15360
  v_mfma_f32_16x16x32_bf16 v[44:47], a[128:131], v[52:55], v[44:47]
  s_waitcnt lgkmcnt(4)
  v_mfma_f32_16x16x32_bf16 v[32:35], a[52:55], v[56:59], v[32:35]
  ds_read_b128 v[52:55], v8 offset:35840
  v_mfma_f32_16x16x32_bf16 v[40:43], a[132:135], v[56:59], v[40:43]
  s_waitcnt lgkmcnt(4)
  v_mfma_f32_16x16x32_bf16 v[36:39], a[52:55], v[60:63], v[36:39]
  ds_read_b128 v[56:59], v8 offset:16384
  v_mfma_f32_16x16x32_bf16 v[44:47], a[132:135], v[60:63], v[44:47]
  s_waitcnt lgkmcnt(4)
  v_mfma_f32_16x16x32_bf16 v[32:35], a[56:59], v[64:67], v[32:35]
  ds_read_b128 v[60:63], v8 offset:36864
  v_mfma_f32_16x16x32_bf16 v[40:43], a[136:139], v[64:67], v[40:43]
  s_waitcnt lgkmcnt(4)
  v_mfma_f32_16x16x32_bf16 v[36:39], a[56:59], v[68:71], v[36:39]
  ds_read_b128 v[64:67], v8 offset:17408
  v_mfma_f32_16x16x32_bf16 v[44:47], a[136:139], v[68:71], v[44:47]
  s_waitcnt lgkmcnt(4)
  v_mfma_f32_16x16x32_bf16 v[32:35], a[60:63], v[48:51], v[32:35]
  ds_read_b128 v[68:71], v8 offset:37888
  v_mfma_f32_16x16x32_bf16 v[40:43], a[140:143], v[48:51], v[40:43]
  s_waitcnt lgkmcnt(4)
  v_mfma_f32_16x16x32_bf16 v[36:39], a[60:63], v[52:55], v[36:39]
  ds_read_b128 v[48:51], v8 offset:18432
  v_mfma_f32_16x16x32_bf16 v[44:47], a[140:143], v[52:55], v[44:47]
  s_waitcnt lgkmcnt(4)
  v_mfma_f32_16x16x32_bf16 v[32:35], a[64:67], v[56:59], v[32:35]
  ds_read_b128 v[52:55], v8 offset:38912
  v_mfma_f32_16x16x32_bf16 v[40:43], a[144:147], v[56:59], v[40:43]
  s_waitcnt lgkmcnt(4)
  v_mfma_f32_16x16x32_bf16 v[36:39], a[64:67], v[60:63], v[36:39]
  ds_read_b128 v[56:59], v8 offset:19456
  v_mfma_f32_16x16x32_bf16 v[44:47], a[144:147], v[60:63], v[44:47]
  s_waitcnt lgkmcnt(4)
  v_mfma_f32_16x16x32_bf16 v[32:35], a[68:71], v[64:67], v[32:35]
  ds_read_b128 v[60:63], v8 offset:39936
  v_mfma_f32_16x16x32_bf16 v[40:43], a[148:151], v[64:67], v[40:43]
  s_waitcnt lgkmcnt(4)
  v_mfma_f32_16x16x32_bf16 v[36:39], a[68:71], v[68:71], v[36:39]
  v_mfma_f32_16x16x32_bf16 v[44:47], a[148:151], v[68:71], v[44:47]
  s_waitcnt lgkmcnt(3)
  v_mfma_f32_16x16x32_bf16 v[32:35], a[72:75], v[48:51], v[32:35]
  v_mfma_f32_16x16x32_bf16 v[40:43], a[152:155], v[48:51], v[40:43]
  s_waitcnt lgkmcnt(2)
  v_mfma_f32_16x16x32_bf16 v[36:39], a[72:75], v[52:55], v[36:39]
  v_mfma_f32_16x16x32_bf16 v[44:47], a[152:155], v[52:55], v[44:47]
  s_waitcnt lgkmcnt(1)
  v_mfma_f32_16x16x32_bf16 v[32:35], a[76:79], v[56:59], v[32:35]
  v_mfma_f32_16x16x32_bf16 v[40:43], a[156:159], v[56:59], v[40:43]
  s_waitcnt lgkmcnt(0)
  v_mfma_f32_16x16x32_bf16 v[36:39], a[76:79], v[60:63], v[36:39]
  v_mfma_f32_16x16x32_bf16 v[44:47], a[156:159], v[60:63], v[44:47]
  s_lshl_b32 s40, s44, 5
  s_add_u32 s40, s40, s33
  s_lshl_b32 s40, s40, 13
  s_add_u32 s40, s40, 184549376
  v_cvt_pk_bf16_f32 v80, v32, v33
  v_cvt_pk_bf16_f32 v81, v34, v35
  v_cvt_pk_bf16_f32 v82, v40, v41
  v_cvt_pk_bf16_f32 v83, v42, v43
  buffer_store_dwordx4 v[80:83], v10, s[4:7], s40 offen offset:0 sc1
  v_cvt_pk_bf16_f32 v84, v36, v37
  v_cvt_pk_bf16_f32 v85, v38, v39
  v_cvt_pk_bf16_f32 v86, v44, v45
  v_cvt_pk_bf16_f32 v87, v46, v47
  s_add_u32 s40, s40, 4096
  buffer_store_dwordx4 v[84:87], v10, s[4:7], s40 offen offset:0 sc1
  s_add_u32 s44, s44, 1
  s_cmp_lt_u32 s44, 64
  s_cbranch_scc1 QP_loop
  s_waitcnt vmcnt(0)
  s_barrier
  s_cmp_lg_u32 s34, 0
  s_cbranch_scc1 pub_34
  s_lshl_b32 s40, s33, 7
  s_add_u32 s40, s40, 58880
  v_and_b32 v11, 63, v0
  v_cmp_eq_u32 vcc, 0, v11
  v_mov_b32 v12, 0x7ffffff0
  s_nop 0
  v_cndmask_b32 v11, v12, 0, vcc
  v_mov_b32 v12, 64
  buffer_store_dword v12, v11, s[4:7], s40 offen sc1
pub_34:
  s_add_u32 s54, s33, 64
  s_branch L_kvdone2
L_kv:
  s_cmp_lg_u32 s32, 2
  s_cbranch_scc1 L_nozero
  s_cmp_ge_u32 s33, 16
  s_cbranch_scc1 L_nozero
  v_mov_b32 v8, 0
  v_mov_b32 v9, 0
  v_mov_b32 v10, 0
  v_mov_b32 v11, 0
  v_lshrrev_b32 v13, 0, v0
  v_mov_b32 v12, 0x0
  v_mad_i32_i24 v12, v13, 16, v12
  s_lshl_b32 s40, s33, 12
  buffer_store_dwordx4 v[8:11], v12, s[4:7], s40 offen sc1
L_nozero:
  s_cmp_ge_u32 s33, 20
  s_cbranch_scc1 L_nomoda
  s_sub_u32 s53, s32, 2
  s_mul_i32 s53, s53, 20
  s_add_u32 s53, s53, s33
  s_load_dwordx2 s[12:13], s[0:1], 104
  s_mov_b32 s14, 0x4b0000
  s_mov_b32 s15, 0x00020000
  s_load_dwordx2 s[16:17], s[0:1], 96
  s_mov_b32 s18, 0x500
  s_mov_b32 s19, 0x00020000
  v_and_b32 v152, 3, v0
  v_mov_b32 v150, 0x0
  v_mad_i32_i24 v150, v152, 16, v150
  v_bfe_u32 v152, v0, 2, 4
  s_mov_b32 s36, 0x1e00
  v_mad_i32_i24 v150, v152, s36, v150
  v_lshrrev_b32 v152, 6, v0
  s_mov_b32 s36, 0x12c000
  v_mad_i32_i24 v150, v152, s36, v150
  v_bfe_u32 v152, v0, 2, 4
  v_mov_b32 v151, 0x0
  v_mad_i32_i24 v151, v152, 2, v151
  v_lshrrev_b32 v152, 6, v0
  s_mov_b32 s36, 0x140
  v_mad_i32_i24 v151, v152, s36, v151
  s_lshl_b32 s40, s53, 6
  s_waitcnt lgkmcnt(0)
  buffer_load_ushort v140, v151, s[16:19], 0 offen offset:0
  buffer_load_ushort v141, v151, s[16:19], 0 offen offset:32
  buffer_load_ushort v142, v151, s[16:19], 0 offen offset:64
  buffer_load_ushort v143, v151, s[16:19], 0 offen offset:96
  buffer_load_ushort v144, v151, s[16:19], 0 offen offset:128
  buffer_load_ushort v145, v151, s[16:19], 0 offen offset:160
  buffer_load_ushort v146, v151, s[16:19], 0 offen offset:192
  buffer_load_ushort v147, v151, s[16:19], 0 offen offset:224
  buffer_load_ushort v148, v151, s[16:19], 0 offen offset:256
  buffer_load_ushort v149, v151, s[16:19], 0 offen offset:288
  buffer_load_dwordx4 v[100:103], v150, s[12:15], s40 offen
  s_add_u32 s40, s40, 122880
  buffer_load_dwordx4 v[104:107], v150, s[12:15], s40 offen
  s_add_u32 s40, s40, 122880
  buffer_load_dwordx4 v[108:111], v150, s[12:15], s40 offen
  s_add_u32 s40, s40, 122880
  buffer_load_dwordx4 v[112:115], v150, s[12:15], s40 offen
  s_add_u32 s40, s40, 122880
  buffer_load_dwordx4 v[116:119], v150, s[12:15], s40 offen
  s_add_u32 s40, s40, 122880
  buffer_load_dwordx4 v[120:123], v150, s[12:15], s40 offen
  s_add_u32 s40, s40, 122880
  buffer_load_dwordx4 v[124:127], v150, s[12:15], s40 offen
  s_add_u32 s40, s40, 122880
  buffer_load_dwordx4 v[128:131], v150, s[12:15], s40 offen
  s_add_u32 s40, s40, 122880
  buffer_load_dwordx4 v[132:135], v150, s[12:15], s40 offen
  s_add_u32 s40, s40, 122880
  buffer_load_dwordx4 v[136:139], v150, s[12:15], s40 offen
  s_waitcnt vmcnt(0)
  v_mov_b32 v154, 0
  v_mov_b32 v155, 0
  v_mov_b32 v156, 0
  v_mov_b32 v157, 0
  v_mov_b32 v158, 0
  v_mov_b32 v159, 0
  v_mov_b32 v160, 0
  v_mov_b32 v161, 0
  v_lshlrev_b32 v140, 16, v140
  v_mul_f32 v162, 0xbfb8aa3b, v140
  v_exp_f32 v162, v162
  s_nop 0
  v_add_f32 v162, 1.0, v162
  v_rcp_f32 v162, v162
  s_nop 0
  v_mul_f32 v140, v140, v162
  v_lshlrev_b32 v163, 16, v100
  v_and_b32 v164, 0xffff0000, v100
  v_fmac_f32 v154, v140, v163
  v_fmac_f32 v155, v140, v164
  v_lshlrev_b32 v163, 16, v101
  v_and_b32 v164, 0xffff0000, v101
  v_fmac_f32 v156, v140, v163
  v_fmac_f32 v157, v140, v164
  v_lshlrev_b32 v163, 16, v102
  v_and_b32 v164, 0xffff0000, v102
  v_fmac_f32 v158, v140, v163
  v_fmac_f32 v159, v140, v164
  v_lshlrev_b32 v163, 16, v103
  v_and_b32 v164, 0xffff0000, v103
  v_fmac_f32 v160, v140, v163
  v_fmac_f32 v161, v140, v164
  v_lshlrev_b32 v141, 16, v141
  v_mul_f32 v162, 0xbfb8aa3b, v141
  v_exp_f32 v162, v162
  s_nop 0
  v_add_f32 v162, 1.0, v162
  v_rcp_f32 v162, v162
  s_nop 0
  v_mul_f32 v141, v141, v162
  v_lshlrev_b32 v163, 16, v104
  v_and_b32 v164, 0xffff0000, v104
  v_fmac_f32 v154, v141, v163
  v_fmac_f32 v155, v141, v164
  v_lshlrev_b32 v163, 16, v105
  v_and_b32 v164, 0xffff0000, v105
  v_fmac_f32 v156, v141, v163
  v_fmac_f32 v157, v141, v164
  v_lshlrev_b32 v163, 16, v106
  v_and_b32 v164, 0xffff0000, v106
  v_fmac_f32 v158, v141, v163
  v_fmac_f32 v159, v141, v164
  v_lshlrev_b32 v163, 16, v107
  v_and_b32 v164, 0xffff0000, v107
  v_fmac_f32 v160, v141, v163
  v_fmac_f32 v161, v141, v164
  v_lshlrev_b32 v142, 16, v142
  v_mul_f32 v162, 0xbfb8aa3b, v142
  v_exp_f32 v162, v162
  s_nop 0
  v_add_f32 v162, 1.0, v162
  v_rcp_f32 v162, v162
  s_nop 0
  v_mul_f32 v142, v142, v162
  v_lshlrev_b32 v163, 16, v108
  v_and_b32 v164, 0xffff0000, v108
  v_fmac_f32 v154, v142, v163
  v_fmac_f32 v155, v142, v164
  v_lshlrev_b32 v163, 16, v109
  v_and_b32 v164, 0xffff0000, v109
  v_fmac_f32 v156, v142, v163
  v_fmac_f32 v157, v142, v164
  v_lshlrev_b32 v163, 16, v110
  v_and_b32 v164, 0xffff0000, v110
  v_fmac_f32 v158, v142, v163
  v_fmac_f32 v159, v142, v164
  v_lshlrev_b32 v163, 16, v111
  v_and_b32 v164, 0xffff0000, v111
  v_fmac_f32 v160, v142, v163
  v_fmac_f32 v161, v142, v164
  v_lshlrev_b32 v143, 16, v143
  v_mul_f32 v162, 0xbfb8aa3b, v143
  v_exp_f32 v162, v162
  s_nop 0
  v_add_f32 v162, 1.0, v162
  v_rcp_f32 v162, v162
  s_nop 0
  v_mul_f32 v143, v143, v162
  v_lshlrev_b32 v163, 16, v112
  v_and_b32 v164, 0xffff0000, v112
  v_fmac_f32 v154, v143, v163
  v_fmac_f32 v155, v143, v164
  v_lshlrev_b32 v163, 16, v113
  v_and_b32 v164, 0xffff0000, v113
  v_fmac_f32 v156, v143, v163
  v_fmac_f32 v157, v143, v164
  v_lshlrev_b32 v163, 16, v114
  v_and_b32 v164, 0xffff0000, v114
  v_fmac_f32 v158, v143, v163
  v_fmac_f32 v159, v143, v164
  v_lshlrev_b32 v163, 16, v115
  v_and_b32 v164, 0xffff0000, v115
  v_fmac_f32 v160, v143, v163
  v_fmac_f32 v161, v143, v164
  v_lshlrev_b32 v144, 16, v144
  v_mul_f32 v162, 0xbfb8aa3b, v144
  v_exp_f32 v162, v162
  s_nop 0
  v_add_f32 v162, 1.0, v162
  v_rcp_f32 v162, v162
  s_nop 0
  v_mul_f32 v144, v144, v162
  v_lshlrev_b32 v163, 16, v116
  v_and_b32 v164, 0xffff0000, v116
  v_fmac_f32 v154, v144, v163
  v_fmac_f32 v155, v144, v164
  v_lshlrev_b32 v163, 16, v117
  v_and_b32 v164, 0xffff0000, v117
  v_fmac_f32 v156, v144, v163
  v_fmac_f32 v157, v144, v164
  v_lshlrev_b32 v163, 16, v118
  v_and_b32 v164, 0xffff0000, v118
  v_fmac_f32 v158, v144, v163
  v_fmac_f32 v159, v144, v164
  v_lshlrev_b32 v163, 16, v119
  v_and_b32 v164, 0xffff0000, v119
  v_fmac_f32 v160, v144, v163
  v_fmac_f32 v161, v144, v164
  v_lshlrev_b32 v145, 16, v145
  v_mul_f32 v162, 0xbfb8aa3b, v145
  v_exp_f32 v162, v162
  s_nop 0
  v_add_f32 v162, 1.0, v162
  v_rcp_f32 v162, v162
  s_nop 0
  v_mul_f32 v145, v145, v162
  v_lshlrev_b32 v163, 16, v120
  v_and_b32 v164, 0xffff0000, v120
  v_fmac_f32 v154, v145, v163
  v_fmac_f32 v155, v145, v164
  v_lshlrev_b32 v163, 16, v121
  v_and_b32 v164, 0xffff0000, v121
  v_fmac_f32 v156, v145, v163
  v_fmac_f32 v157, v145, v164
  v_lshlrev_b32 v163, 16, v122
  v_and_b32 v164, 0xffff0000, v122
  v_fmac_f32 v158, v145, v163
  v_fmac_f32 v159, v145, v164
  v_lshlrev_b32 v163, 16, v123
  v_and_b32 v164, 0xffff0000, v123
  v_fmac_f32 v160, v145, v163
  v_fmac_f32 v161, v145, v164
  v_lshlrev_b32 v146, 16, v146
  v_mul_f32 v162, 0xbfb8aa3b, v146
  v_exp_f32 v162, v162
  s_nop 0
  v_add_f32 v162, 1.0, v162
  v_rcp_f32 v162, v162
  s_nop 0
  v_mul_f32 v146, v146, v162
  v_lshlrev_b32 v163, 16, v124
  v_and_b32 v164, 0xffff0000, v124
  v_fmac_f32 v154, v146, v163
  v_fmac_f32 v155, v146, v164
  v_lshlrev_b32 v163, 16, v125
  v_and_b32 v164, 0xffff0000, v125
  v_fmac_f32 v156, v146, v163
  v_fmac_f32 v157, v146, v164
  v_lshlrev_b32 v163, 16, v126
  v_and_b32 v164, 0xffff0000, v126
  v_fmac_f32 v158, v146, v163
  v_fmac_f32 v159, v146, v164
  v_lshlrev_b32 v163, 16, v127
  v_and_b32 v164, 0xffff0000, v127
  v_fmac_f32 v160, v146, v163
  v_fmac_f32 v161, v146, v164
  v_lshlrev_b32 v147, 16, v147
  v_mul_f32 v162, 0xbfb8aa3b, v147
  v_exp_f32 v162, v162
  s_nop 0
  v_add_f32 v162, 1.0, v162
  v_rcp_f32 v162, v162
  s_nop 0
  v_mul_f32 v147, v147, v162
  v_lshlrev_b32 v163, 16, v128
  v_and_b32 v164, 0xffff0000, v128
  v_fmac_f32 v154, v147, v163
  v_fmac_f32 v155, v147, v164
  v_lshlrev_b32 v163, 16, v129
  v_and_b32 v164, 0xffff0000, v129
  v_fmac_f32 v156, v147, v163
  v_fmac_f32 v157, v147, v164
  v_lshlrev_b32 v163, 16, v130
  v_and_b32 v164, 0xffff0000, v130
  v_fmac_f32 v158, v147, v163
  v_fmac_f32 v159, v147, v164
  v_lshlrev_b32 v163, 16, v131
  v_and_b32 v164, 0xffff0000, v131
  v_fmac_f32 v160, v147, v163
  v_fmac_f32 v161, v147, v164
  v_lshlrev_b32 v148, 16, v148
  v_mul_f32 v162, 0xbfb8aa3b, v148
  v_exp_f32 v162, v162
  s_nop 0
  v_add_f32 v162, 1.0, v162
  v_rcp_f32 v162, v162
  s_nop 0
  v_mul_f32 v148, v148, v162
  v_lshlrev_b32 v163, 16, v132
  v_and_b32 v164, 0xffff0000, v132
  v_fmac_f32 v154, v148, v163
  v_fmac_f32 v155, v148, v164
  v_lshlrev_b32 v163, 16, v133
  v_and_b32 v164, 0xffff0000, v133
  v_fmac_f32 v156, v148, v163
  v_fmac_f32 v157, v148, v164
  v_lshlrev_b32 v163, 16, v134
  v_and_b32 v164, 0xffff0000, v134
  v_fmac_f32 v158, v148, v163
  v_fmac_f32 v159, v148, v164
  v_lshlrev_b32 v163, 16, v135
  v_and_b32 v164, 0xffff0000, v135
  v_fmac_f32 v160, v148, v163
  v_fmac_f32 v161, v148, v164
  v_lshlrev_b32 v149, 16, v149
  v_mul_f32 v162, 0xbfb8aa3b, v149
  v_exp_f32 v162, v162
  s_nop 0
  v_add_f32 v162, 1.0, v162
  v_rcp_f32 v162, v162
  s_nop 0
  v_mul_f32 v149, v149, v162
  v_lshlrev_b32 v163, 16, v136
  v_and_b32 v164, 0xffff0000, v136
  v_fmac_f32 v154, v149, v163
  v_fmac_f32 v155, v149, v164
  v_lshlrev_b32 v163, 16, v137
  v_and_b32 v164, 0xffff0000, v137
  v_fmac_f32 v156, v149, v163
  v_fmac_f32 v157, v149, v164
  v_lshlrev_b32 v163, 16, v138
  v_and_b32 v164, 0xffff0000, v138
  v_fmac_f32 v158, v149, v163
  v_fmac_f32 v159, v149, v164
  v_lshlrev_b32 v163, 16, v139
  v_and_b32 v164, 0xffff0000, v139
  v_fmac_f32 v160, v149, v163
  v_fmac_f32 v161, v149, v164
  v_add_f32_dpp v154, v154, v154 row_ror:4 row_mask:0xf bank_mask:0xf
  v_add_f32_dpp v155, v155, v155 row_ror:4 row_mask:0xf bank_mask:0xf
  v_add_f32_dpp v156, v156, v156 row_ror:4 row_mask:0xf bank_mask:0xf
  v_add_f32_dpp v157, v157, v157 row_ror:4 row_mask:0xf bank_mask:0xf
  v_add_f32_dpp v158, v158, v158 row_ror:4 row_mask:0xf bank_mask:0xf
  v_add_f32_dpp v159, v159, v159 row_ror:4 row_mask:0xf bank_mask:0xf
  v_add_f32_dpp v160, v160, v160 row_ror:4 row_mask:0xf bank_mask:0xf
  v_add_f32_dpp v161, v161, v161 row_ror:4 row_mask:0xf bank_mask:0xf
  v_add_f32_dpp v154, v154, v154 row_ror:8 row_mask:0xf bank_mask:0xf
  v_add_f32_dpp v155, v155, v155 row_ror:8 row_mask:0xf bank_mask:0xf
  v_add_f32_dpp v156, v156, v156 row_ror:8 row_mask:0xf bank_mask:0xf
  v_add_f32_dpp v157, v157, v157 row_ror:8 row_mask:0xf bank_mask:0xf
  v_add_f32_dpp v158, v158, v158 row_ror:8 row_mask:0xf bank_mask:0xf
  v_add_f32_dpp v159, v159, v159 row_ror:8 row_mask:0xf bank_mask:0xf
  v_add_f32_dpp v160, v160, v160 row_ror:8 row_mask:0xf bank_mask:0xf
  v_add_f32_dpp v161, v161, v161 row_ror:8 row_mask:0xf bank_mask:0xf
  v_mov_b32 v162, v154
  s_nop 1
  v_permlane16_swap_b32 v154, v162
  v_add_f32 v154, v154, v162
  v_mov_b32 v162, v155
  s_nop 1
  v_permlane16_swap_b32 v155, v162
  v_add_f32 v155, v155, v162
  v_mov_b32 v162, v156
  s_nop 1
  v_permlane16_swap_b32 v156, v162
  v_add_f32 v156, v156, v162
  v_mov_b32 v162, v157
  s_nop 1
  v_permlane16_swap_b32 v157, v162
  v_add_f32 v157, v157, v162
  v_mov_b32 v162, v158
  s_nop 1
  v_permlane16_swap_b32 v158, v162
  v_add_f32 v158, v158, v162
  v_mov_b32 v162, v159
  s_nop 1
  v_permlane16_swap_b32 v159, v162
  v_add_f32 v159, v159, v162
  v_mov_b32 v162, v160
  s_nop 1
  v_permlane16_swap_b32 v160, v162
  v_add_f32 v160, v160, v162
  v_mov_b32 v162, v161
  s_nop 1
  v_permlane16_swap_b32 v161, v162
  v_add_f32 v161, v161, v162
  v_mov_b32 v162, v154
  s_nop 1
  v_permlane32_swap_b32 v154, v162
  v_add_f32 v154, v154, v162
  v_mov_b32 v162, v155
  s_nop 1
  v_permlane32_swap_b32 v155, v162
  v_add_f32 v155, v155, v162
  v_mov_b32 v162, v156
  s_nop 1
  v_permlane32_swap_b32 v156, v162
  v_add_f32 v156, v156, v162
  v_mov_b32 v162, v157
  s_nop 1
  v_permlane32_swap_b32 v157, v162
  v_add_f32 v157, v157, v162
  v_mov_b32 v162, v158
  s_nop 1
  v_permlane32_swap_b32 v158, v162
  v_add_f32 v158, v158, v162
  v_mov_b32 v162, v159
  s_nop 1
  v_permlane32_swap_b32 v159, v162
  v_add_f32 v159, v159, v162
  v_mov_b32 v162, v160
  s_nop 1
  v_permlane32_swap_b32 v160, v162
  v_add_f32 v160, v160, v162
  v_mov_b32 v162, v161
  s_nop 1
  v_permlane32_swap_b32 v161, v162
  v_add_f32 v161, v161, v162
  v_and_b32 v163, 3, v0
  v_mov_b32 v162, 0x27c00
  v_mad_i32_i24 v162, v163, 32, v162
  v_lshrrev_b32 v163, 6, v0
  s_mov_b32 s36, 0x80
  v_mad_i32_i24 v162, v163, s36, v162
  ds_write_b128 v162, v[154:157]
  ds_write_b128 v162, v[158:161] offset:16
  s_waitcnt lgkmcnt(0)
  s_barrier
  v_and_b32 v163, 31, v0
  v_mov_b32 v162, 0x27c00
  v_mad_i32_i24 v162, v163, 4, v162
  ds_read_b32 v154, v162 offset:0
  ds_read_b32 v155, v162 offset:128
  ds_read_b32 v156, v162 offset:256
  ds_read_b32 v157, v162 offset:384
  s_waitcnt lgkmcnt(0)
  v_add_f32 v154, v154, v155
  v_add_f32 v156, v156, v157
  v_add_f32 v154, v154, v156
  s_cmp_lg_u32 s34, 0
  s_cbranch_scc1 modskip_35
  v_and_b32 v163, 31, v0
  v_mov_b32 v162, 0x10000
  v_mad_i32_i24 v162, v163, 4, v162
  s_lshl_b32 s40, s53, 7
  buffer_store_dword v154, v162, s[4:7], s40 offen sc1
  s_waitcnt vmcnt(0)
  v_and_b32 v162, 63, v0
  v_cmp_eq_u32 vcc, 0, v162
  v_mov_b32 v163, 0x7ffffff0
  v_mov_b32 v162, 32
  v_cndmask_b32 v162, v163, v162, vcc
  v_mov_b32 v163, 1
  buffer_atomic_add v163, v162, s[8:11], 0 offen
modskip_35:
  s_barrier
L_nomoda:
  s_cmp_eq_u32 s32, 3
  s_cbranch_scc1 L_v
  s_load_dwordx2 s[20:21], s[0:1], 24
  s_mov_b32 s22, 0x500000
  s_mov_b32 s23, 0x00020000
  s_waitcnt lgkmcnt(0)
  v_bfe_u32 v14, v0, 4, 2
  v_mov_b32 v8, 0x0
  s_mov_b32 s36, 0x2000
  v_mad_i32_i24 v8, v14, s36, v8
  v_and_b32 v14, 15, v0
  v_mov_b32 v9, 0x0
  v_mad_i32_i24 v9, v14, 16, v9
  v_bfe_u32 v15, v0, 4, 2
  v_mov_b32 v14, 0x0
  v_mad_i32_i24 v14, v15, 32, v14
  v_xor_b32 v9, v9, v14
  v_add_u32 v8, v8, v9
  v_xor_b32 v9, 128, v8
  s_lshl_b32 s41, s33, 8
  s_mul_i32 s42, s34, 262144
  s_add_u32 s41, s41, s42
  s_add_u32 s41, s41, 0
  s_lshl_b32 s42, s34, 13
  s_add_u32 s42, s42, 0
  s_mov_b32 m0, s42
  s_nop 0
  buffer_load_dwordx4 v8, s[20:23], s41 offen lds
  s_add_u32 s41, s41, 32768
  s_add_u32 s42, s42, 1024
  s_mov_b32 m0, s42
  s_nop 0
  buffer_load_dwordx4 v8, s[20:23], s41 offen lds
  s_add_u32 s41, s41, 32768
  s_add_u32 s42, s42, 1024
  s_mov_b32 m0, s42
  s_nop 0
  buffer_load_dwordx4 v9, s[20:23], s41 offen lds
  s_add_u32 s41, s41, 32768
  s_add_u32 s42, s42, 1024
  s_mov_b32 m0, s42
  s_nop 0
  buffer_load_dwordx4 v9, s[20:23], s41 offen lds
  s_add_u32 s41, s41, 32768
  s_add_u32 s42, s42, 1024
  s_mov_b32 m0, s42
  s_nop 0
  buffer_load_dwordx4 v8, s[20:23], s41 offen lds
  s_add_u32 s41, s41, 32768
  s_add_u32 s42, s42, 1024
  s_mov_b32 m0, s42
  s_nop 0
  buffer_load_dwordx4 v8, s[20:23], s41 offen lds
  s_add_u32 s41, s41, 32768
  s_add_u32 s42, s42, 1024
  s_mov_b32 m0, s42
  s_nop 0
  buffer_load_dwordx4 v9, s[20:23], s41 offen lds
  s_add_u32 s41, s41, 32768
  s_add_u32 s42, s42, 1024
  s_mov_b32 m0, s42
  s_nop 0
  buffer_load_dwordx4 v9, s[20:23], s41 offen lds
  s_lshl_b32 s41, s33, 8
  s_mul_i32 s42, s34, 262144
  s_add_u32 s41, s41, s42
  s_add_u32 s41, s41, 1048576
  s_lshl_b32 s42, s34, 13
  s_add_u32 s42, s42, 32768
  s_mov_b32 m0, s42
  s_nop 0
  buffer_load_dwordx4 v8, s[20:23], s41 offen lds
  s_add_u32 s41, s41, 32768
  s_add_u32 s42, s42, 1024
  s_mov_b32 m0, s42
  s_nop 0
  buffer_load_dwordx4 v8, s[20:23], s41 offen lds
  s_add_u32 s41, s41, 32768
  s_add_u32 s42, s42, 1024
  s_mov_b32 m0, s42
  s_nop 0
  buffer_load_dwordx4 v9, s[20:23], s41 offen lds
  s_add_u32 s41, s41, 32768
  s_add_u32 s42, s42, 1024
  s_mov_b32 m0, s42
  s_nop 0
  buffer_load_dwordx4 v9, s[20:23], s41 offen lds
  s_add_u32 s41, s41, 32768
  s_add_u32 s42, s42, 1024
  s_mov_b32 m0, s42
  s_nop 0
  buffer_load_dwordx4 v8, s[20:23], s41 offen lds
  s_add_u32 s41, s41, 32768
  s_add_u32 s42, s42, 1024
  s_mov_b32 m0, s42
  s_nop 0
  buffer_load_dwordx4 v8, s[20:23], s41 offen lds
  s_add_u32 s41, s41, 32768
  s_add_u32 s42, s42, 1024
  s_mov_b32 m0, s42
  s_nop 0
  buffer_load_dwordx4 v9, s[20:23], s41 offen lds
  s_add_u32 s41, s41, 32768
  s_add_u32 s42, s42, 1024
  s_mov_b32 m0, s42
  s_nop 0
  buffer_load_dwordx4 v9, s[20:23], s41 offen lds
  s_lshl_b32 s41, s33, 8
  s_mul_i32 s42, s34, 262144
  s_add_u32 s41, s41, s42
  s_add_u32 s41, s41, 2097152
  s_lshl_b32 s42, s34, 13
  s_add_u32 s42, s42, 65536
  s_mov_b32 m0, s42
  s_nop 0
  buffer_load_dwordx4 v8, s[20:23], s41 offen lds
  s_add_u32 s41, s41, 32768
  s_add_u32 s42, s42, 1024
  s_mov_b32 m0, s42
  s_nop 0
  buffer_load_dwordx4 v8, s[20:23], s41 offen lds
  s_add_u32 s41, s41, 32768
  s_add_u32 s42, s42, 1024
  s_mov_b32 m0, s42
  s_nop 0
  buffer_load_dwordx4 v9, s[20:23], s41 offen lds
  s_add_u32 s41, s41, 32768
  s_add_u32 s42, s42, 1024
  s_mov_b32 m0, s42
  s_nop 0
  buffer_load_dwordx4 v9, s[20:23], s41 offen lds
  s_add_u32 s41, s41, 32768
  s_add_u32 s42, s42, 1024
  s_mov_b32 m0, s42
  s_nop 0
  buffer_load_dwordx4 v8, s[20:23], s41 offen lds
  s_add_u32 s41, s41, 32768
  s_add_u32 s42, s42, 1024
  s_mov_b32 m0, s42
  s_nop 0
  buffer_load_dwordx4 v8, s[20:23], s41 offen lds
  s_add_u32 s41, s41, 32768
  s_add_u32 s42, s42, 1024
  s_mov_b32 m0, s42
  s_nop 0
  buffer_load_dwordx4 v9, s[20:23], s41 offen lds
  s_add_u32 s41, s41, 32768
  s_add_u32 s42, s42, 1024
  s_mov_b32 m0, s42
  s_nop 0
  buffer_load_dwordx4 v9, s[20:23], s41 offen lds
  s_lshl_b32 s41, s33, 8
  s_mul_i32 s42, s34, 262144
  s_add_u32 s41, s41, s42
  s_add_u32 s41, s41, 3145728
  s_lshl_b32 s42, s34, 13
  s_add_u32 s42, s42, 98304
  s_mov_b32 m0, s42
  s_nop 0
  buffer_load_dwordx4 v8, s[20:23], s41 offen lds
  s_add_u32 s41, s41, 32768
  s_add_u32 s42, s42, 1024
  s_mov_b32 m0, s42
  s_nop 0
  buffer_load_dwordx4 v8, s[20:23], s41 offen lds
  s_add_u32 s41, s41, 32768
  s_add_u32 s42, s42, 1024
  s_mov_b32 m0, s42
  s_nop 0
  buffer_load_dwordx4 v9, s[20:23], s41 offen lds
  s_add_u32 s41, s41, 32768
  s_add_u32 s42, s42, 1024
  s_mov_b32 m0, s42
  s_nop 0
  buffer_load_dwordx4 v9, s[20:23], s41 offen lds
  s_add_u32 s41, s41, 32768
  s_add_u32 s42, s42, 1024
  s_mov_b32 m0, s42
  s_nop 0
  buffer_load_dwordx4 v8, s[20:23], s41 offen lds
  s_add_u32 s41, s41, 32768
  s_add_u32 s42, s42, 1024
  s_mov_b32 m0, s42
  s_nop 0
  buffer_load_dwordx4 v8, s[20:23], s41 offen lds
  s_add_u32 s41, s41, 32768
  s_add_u32 s42, s42, 1024
  s_mov_b32 m0, s42
  s_nop 0
  buffer_load_dwordx4 v9, s[20:23], s41 offen lds
  s_add_u32 s41, s41, 32768
  s_add_u32 s42, s42, 1024
  s_mov_b32 m0, s42
  s_nop 0
  buffer_load_dwordx4 v9, s[20:23], s41 offen lds
  v_bfe_u32 v14, v0, 1, 1
  v_mov_b32 v10, 0x0
  v_mad_i32_i24 v10, v14, 1, v10
  v_lshrrev_b32 v14, 6, v0
  v_mad_i32_i24 v10, v14, 4, v10
  v_bfe_u32 v14, v0, 2, 3
  v_mov_b32 v11, 0x0
  v_mad_i32_i24 v11, v14, 2, v11
  v_xor_b32 v10, v10, v11
  v_lshlrev_b32 v10, 4, v10
  v_and_b32 v14, 1, v0
  v_mov_b32 v11, 0x0
  v_mad_i32_i24 v11, v14, 8, v11
  v_bfe_u32 v14, v0, 2, 2
  s_mov_b32 s36, 0x100
  v_mad_i32_i24 v11, v14, s36, v11
  v_bfe_u32 v14, v0, 4, 2
  s_mov_b32 s36, 0x800
  v_mad_i32_i24 v11, v14, s36, v11
  v_add_u32 v10, v10, v11
  v_xor_b32 v11, 32, v10
  v_add_u32 v12, 0x10000, v10
  v_add_u32 v13, 0x10000, v11
  s_waitcnt vmcnt(24)
  s_barrier
  ds_read_b64_tr_b16 a[0:1], v10 offset:0
  ds_read_b64_tr_b16 a[2:3], v10 offset:1024
  ds_read_b64_tr_b16 a[80:81], v11 offset:0
  ds_read_b64_tr_b16 a[82:83], v11 offset:1024
  ds_read_b64_tr_b16 a[4:5], v10 offset:8192
  ds_read_b64_tr_b16 a[6:7], v10 offset:9216
  ds_read_b64_tr_b16 a[84:85], v11 offset:8192
  ds_read_b64_tr_b16 a[86:87], v11 offset:9216
  ds_read_b64_tr_b16 a[8:9], v10 offset:16384
  ds_read_b64_tr_b16 a[10:11], v10 offset:17408
  ds_read_b64_tr_b16 a[88:89], v11 offset:16384
  ds_read_b64_tr_b16 a[90:91], v11 offset:17408
  ds_read_b64_tr_b16 a[12:13], v10 offset:24576
  ds_read_b64_tr_b16 a[14:15], v10 offset:25600
  ds_read_b64_tr_b16 a[92:93], v11 offset:24576
  ds_read_b64_tr_b16 a[94:95], v11 offset:25600
  s_waitcnt lgkmcnt(0)
  s_barrier
  s_lshl_b32 s41, s33, 8
  s_mul_i32 s42, s34, 262144
  s_add_u32 s41, s41, s42
  s_add_u32 s41, s41, 4194304
  s_lshl_b32 s42, s34, 13
  s_add_u32 s42, s42, 0
  s_mov_b32 m0, s42
  s_nop 0
  buffer_load_dwordx4 v8, s[20:23], s41 offen lds
  s_add_u32 s41, s41, 32768
  s_add_u32 s42, s42, 1024
  s_mov_b32 m0, s42
  s_nop 0
  buffer_load_dwordx4 v8, s[20:23], s41 offen lds
  s_add_u32 s41, s41, 32768
  s_add_u32 s42, s42, 1024
  s_mov_b32 m0, s42
  s_nop 0
  buffer_load_dwordx4 v9, s[20:23], s41 offen lds
  s_add_u32 s41, s41, 32768
  s_add_u32 s42, s42, 1024
  s_mov_b32 m0, s42
  s_nop 0
  buffer_load_dwordx4 v9, s[20:23], s41 offen lds
  s_add_u32 s41, s41, 32768
  s_add_u32 s42, s42, 1024
  s_mov_b32 m0, s42
  s_nop 0
  buffer_load_dwordx4 v8, s[20:23], s41 offen lds
  s_add_u32 s41, s41, 32768
  s_add_u32 s42, s42, 1024
  s_mov_b32 m0, s42
  s_nop 0
  buffer_load_dwordx4 v8, s[20:23], s41 offen lds
  s_add_u32 s41, s41, 32768
  s_add_u32 s42, s42, 1024
  s_mov_b32 m0, s42
  s_nop 0
  buffer_load_dwordx4 v9, s[20:23], s41 offen lds
  s_add_u32 s41, s41, 32768
  s_add_u32 s42, s42, 1024
  s_mov_b32 m0, s42
  s_nop 0
  buffer_load_dwordx4 v9, s[20:23], s41 offen lds
  s_waitcnt vmcnt(24)
  s_barrier
  ds_read_b64_tr_b16 a[16:17], v10 offset:32768
  ds_read_b64_tr_b16 a[18:19], v10 offset:33792
  ds_read_b64_tr_b16 a[96:97], v11 offset:32768
  ds_read_b64_tr_b16 a[98:99], v11 offset:33792
  ds_read_b64_tr_b16 a[20:21], v10 offset:40960
  ds_read_b64_tr_b16 a[22:23], v10 offset:41984
  ds_read_b64_tr_b16 a[100:101], v11 offset:40960
  ds_read_b64_tr_b16 a[102:103], v11 offset:41984
  ds_read_b64_tr_b16 a[24:25], v10 offset:49152
  ds_read_b64_tr_b16 a[26:27], v10 offset:50176
  ds_read_b64_tr_b16 a[104:105], v11 offset:49152
  ds_read_b64_tr_b16 a[106:107], v11 offset:50176
  ds_read_b64_tr_b16 a[28:29], v10 offset:57344
  ds_read_b64_tr_b16 a[30:31], v10 offset:58368
  ds_read_b64_tr_b16 a[108:109], v11 offset:57344
  ds_read_b64_tr_b16 a[110:111], v11 offset:58368
  s_waitcnt vmcnt(16)
  s_barrier
  ds_read_b64_tr_b16 a[32:33], v12 offset:0
  ds_read_b64_tr_b16 a[34:35], v12 offset:1024
  ds_read_b64_tr_b16 a[112:113], v13 offset:0
  ds_read_b64_tr_b16 a[114:115], v13 offset:1024
  ds_read_b64_tr_b16 a[36:37], v12 offset:8192
  ds_read_b64_tr_b16 a[38:39], v12 offset:9216
  ds_read_b64_tr_b16 a[116:117], v13 offset:8192
  ds_read_b64_tr_b16 a[118:119], v13 offset:9216
  ds_read_b64_tr_b16 a[40:41], v12 offset:16384
  ds_read_b64_tr_b16 a[42:43], v12 offset:17408
  ds_read_b64_tr_b16 a[120:121], v13 offset:16384
  ds_read_b64_tr_b16 a[122:123], v13 offset:17408
  ds_read_b64_tr_b16 a[44:45], v12 offset:24576
  ds_read_b64_tr_b16 a[46:47], v12 offset:25600
  ds_read_b64_tr_b16 a[124:125], v13 offset:24576
  ds_read_b64_tr_b16 a[126:127], v13 offset:25600
  s_waitcnt vmcnt(8)
  s_barrier
  ds_read_b64_tr_b16 a[48:49], v12 offset:32768
  ds_read_b64_tr_b16 a[50:51], v12 offset:33792
  ds_read_b64_tr_b16 a[128:129], v13 offset:32768
  ds_read_b64_tr_b16 a[130:131], v13 offset:33792
  ds_read_b64_tr_b16 a[52:53], v12 offset:40960
  ds_read_b64_tr_b16 a[54:55], v12 offset:41984
  ds_read_b64_tr_b16 a[132:133], v13 offset:40960
  ds_read_b64_tr_b16 a[134:135], v13 offset:41984
  ds_read_b64_tr_b16 a[56:57], v12 offset:49152
  ds_read_b64_tr_b16 a[58:59], v12 offset:50176
  ds_read_b64_tr_b16 a[136:137], v13 offset:49152
  ds_read_b64_tr_b16 a[138:139], v13 offset:50176
  ds_read_b64_tr_b16 a[60:61], v12 offset:57344
  ds_read_b64_tr_b16 a[62:63], v12 offset:58368
  ds_read_b64_tr_b16 a[140:141], v13 offset:57344
  ds_read_b64_tr_b16 a[142:143], v13 offset:58368
  s_waitcnt vmcnt(0)
  s_barrier
  ds_read_b64_tr_b16 a[64:65], v10 offset:0
  ds_read_b64_tr_b16 a[66:67], v10 offset:1024
  ds_read_b64_tr_b16 a[144:145], v11 offset:0
  ds_read_b64_tr_b16 a[146:147], v11 offset:1024
  ds_read_b64_tr_b16 a[68:69], v10 offset:8192
  ds_read_b64_tr_b16 a[70:71], v10 offset:9216
  ds_read_b64_tr_b16 a[148:149], v11 offset:8192
  ds_read_b64_tr_b16 a[150:151], v11 offset:9216
  ds_read_b64_tr_b16 a[72:73], v10 offset:16384
  ds_read_b64_tr_b16 a[74:75], v10 offset:17408
  ds_read_b64_tr_b16 a[152:153], v11 offset:16384
  ds_read_b64_tr_b16 a[154:155], v11 offset:17408
  ds_read_b64_tr_b16 a[76:77], v10 offset:24576
  ds_read_b64_tr_b16 a[78:79], v10 offset:25600
  ds_read_b64_tr_b16 a[156:157], v11 offset:24576
  ds_read_b64_tr_b16 a[158:159], v11 offset:25600
  s_waitcnt lgkmcnt(0)
  s_barrier
  s_cmp_lg_u32 s34, 0
  s_cbranch_scc1 pd_36
  v_mov_b32 v8, 32
poll_37:
  buffer_load_dword v9, v8, s[8:11], 0 offen sc1
  s_waitcnt vmcnt(0)
  v_cmp_gt_u32 vcc, 40, v9
  s_cbranch_vccz polled_38
  s_sleep 3
  s_add_u32 s35, s35, 1
  s_cmp_lt_u32 s35, 300000
  s_cbranch_scc1 poll_37
polled_38:
pd_36:
  s_barrier
  v_and_b32 v12, 63, v0
  v_min_u32 v12, 63, v12
  v_lshlrev_b32 v12, 7, v12
  v_add_u32 v11, 0x0, v12
  s_cmp_lg_u32 s34, 0
  s_cbranch_scc1 pw_39
poll_40:
  buffer_load_dword v12, v11, s[4:7], 0 offen sc1
  s_waitcnt vmcnt(0)
  v_cmp_gt_u32 vcc, 1, v12
  s_cbranch_vccz polled_41
  s_sleep 3
  s_add_u32 s35, s35, 1
  s_cmp_lt_u32 s35, 300000
  s_cbranch_scc1 poll_40
polled_41:
pw_39:
  s_barrier
  v_and_b32 v12, 63, v0
  v_min_u32 v12, 63, v12
  v_lshlrev_b32 v12, 7, v12
  v_add_u32 v11, 0x2000, v12
  s_cmp_lg_u32 s34, 0
  s_cbranch_scc1 pw_42
poll_43:
  buffer_load_dword v12, v11, s[4:7], 0 offen sc1
  s_waitcnt vmcnt(0)
  v_cmp_gt_u32 vcc, 1, v12
  s_cbranch_vccz polled_44
  s_sleep 3
  s_add_u32 s35, s35, 1
  s_cmp_lt_u32 s35, 300000
  s_cbranch_scc1 poll_43
polled_44:
pw_42:
  s_barrier
  v_and_b32 v11, 63, v0
  v_mov_b32 v9, 0x0
  v_mad_i32_i24 v9, v11, 16, v9
  v_lshrrev_b32 v11, 0, v0
  v_mov_b32 v10, 0x0
  v_mad_i32_i24 v10, v11, 16, v10
  s_mov_b32 s44, 0
  s_mov_b32 s45, 0
  s_mul_i32 s41, s44, 40960
  s_mul_i32 s42, s34, 10240
  s_add_u32 s41, s41, s42
  s_add_u32 s41, s41, 4194304
  s_add_u32 s42, s42, s45
  s_mov_b32 m0, s42
  s_nop 0
  buffer_load_dwordx4 v9, s[4:7], s41 offen offset:0 sc1 lds
  buffer_load_dwordx4 v9, s[4:7], s41 offen offset:1024 sc1 lds
  buffer_load_dwordx4 v9, s[4:7], s41 offen offset:2048 sc1 lds
  buffer_load_dwordx4 v9, s[4:7], s41 offen offset:3072 sc1 lds
  s_add_u32 s41, s41, 4096
  s_add_u32 s42, s42, 4096
  s_mov_b32 m0, s42
  s_nop 0
  buffer_load_dwordx4 v9, s[4:7], s41 offen offset:0 sc1 lds
  buffer_load_dwordx4 v9, s[4:7], s41 offen offset:1024 sc1 lds
  buffer_load_dwordx4 v9, s[4:7], s41 offen offset:2048 sc1 lds
  buffer_load_dwordx4 v9, s[4:7], s41 offen offset:3072 sc1 lds
  s_add_u32 s41, s41, 4096
  s_add_u32 s42, s42, 4096
  s_mov_b32 m0, s42
  s_nop 0
  buffer_load_dwordx4 v9, s[4:7], s41 offen offset:0 sc1 lds
  buffer_load_dwordx4 v9, s[4:7], s41 offen offset:1024 sc1 lds
K_loop:
  s_waitcnt vmcnt(0)
  s_barrier
  s_cmp_lg_u32 s34, 0
  s_cbranch_scc1 pub_45
  s_lshl_b32 s40, s33, 7
  s_add_u32 s40, s40, 16384
  v_and_b32 v11, 63, v0
  v_cmp_eq_u32 vcc, 0, v11
  v_mov_b32 v12, 0x7ffffff0
  s_nop 0
  v_cndmask_b32 v11, v12, 0, vcc
  v_mov_b32 v12, s44
  buffer_store_dword v12, v11, s[4:7], s40 offen sc1
pub_45:
  v_add_u32 v8, s45, v9
  s_xor_b32 s45, s45, 40960
  s_add_u32 s46, s44, 1
  s_cmp_ge_u32 s46, 64
  s_cbranch_scc1 nonext_46
  s_mul_i32 s41, s46, 40960
  s_mul_i32 s42, s34, 10240
  s_add_u32 s41, s41, s42
  s_add_u32 s41, s41, 4194304
  s_add_u32 s42, s42, s45
  s_mov_b32 m0, s42
  s_nop 0
  buffer_load_dwordx4 v9, s[4:7], s41 offen offset:0 sc1 lds
  buffer_load_dwordx4 v9, s[4:7], s41 offen offset:1024 sc1 lds
  buffer_load_dwordx4 v9, s[4:7], s41 offen offset:2048 sc1 lds
  buffer_load_dwordx4 v9, s[4:7], s41 offen offset:3072 sc1 lds
  s_add_u32 s41, s41, 4096
  s_add_u32 s42, s42, 4096
  s_mov_b32 m0, s42
  s_nop 0
  buffer_load_dwordx4 v9, s[4:7], s41 offen offset:0 sc1 lds
  buffer_load_dwordx4 v9, s[4:7], s41 offen offset:1024 sc1 lds
  buffer_load_dwordx4 v9, s[4:7], s41 offen offset:2048 sc1 lds
  buffer_load_dwordx4 v9, s[4:7], s41 offen offset:3072 sc1 lds
  s_add_u32 s41, s41, 4096
  s_add_u32 s42, s42, 4096
  s_mov_b32 m0, s42
  s_nop 0
  buffer_load_dwordx4 v9, s[4:7], s41 offen offset:0 sc1 lds
  buffer_load_dwordx4 v9, s[4:7], s41 offen offset:1024 sc1 lds
nonext_46:
  ds_read_b128 v[48:51], v8 offset:0
  ds_read_b128 v[52:55], v8 offset:20480
  ds_read_b128 v[56:59], v8 offset:1024
  ds_read_b128 v[60:63], v8 offset:21504
  ds_read_b128 v[64:67], v8 offset:2048
  s_waitcnt lgkmcnt(4)
  v_mfma_f32_16x16x32_bf16 v[32:35], a[0:3], v[48:51], 0
  ds_read_b128 v[68:71], v8 offset:22528
  v_mfma_f32_16x16x32_bf16 v[40:43], a[80:83], v[48:51], 0
  s_waitcnt lgkmcnt(4)
  v_mfma_f32_16x16x32_bf16 v[36:39], a[0:3], v[52:55], 0
  ds_read_b128 v[48:51], v8 offset:3072
  v_mfma_f32_16x16x32_bf16 v[44:47], a[80:83], v[52:55], 0
  s_waitcnt lgkmcnt(4)
  v_mfma_f32_16x16x32_bf16 v[32:35], a[4:7], v[56:59], v[32:35]
  ds_read_b128 v[52:55], v8 offset:23552
  v_mfma_f32_16x16x32_bf16 v[40:43], a[84:87], v[56:59], v[40:43]
  s_waitcnt lgkmcnt(4)
  v_mfma_f32_16x16x32_bf16 v[36:39], a[4:7], v[60:63], v[36:39]
  ds_read_b128 v[56:59], v8 offset:4096
  v_mfma_f32_16x16x32_bf16 v[44:47], a[84:87], v[60:63], v[44:47]
  s_waitcnt lgkmcnt(4)
  v_mfma_f32_16x16x32_bf16 v[32:35], a[8:11], v[64:67], v[32:35]
  ds_read_b128 v[60:63], v8 offset:24576
  v_mfma_f32_16x16x32_bf16 v[40:43], a[88:91], v[64:67], v[40:43]
  s_waitcnt lgkmcnt(4)
  v_mfma_f32_16x16x32_bf16 v[36:39], a[8:11], v[68:71], v[36:39]
  ds_read_b128 v[64:67], v8 offset:5120
  v_mfma_f32_16x16x32_bf16 v[44:47], a[88:91], v[68:71], v[44:47]
  s_waitcnt lgkmcnt(4)
  v_mfma_f32_16x16x32_bf16 v[32:35], a[12:15], v[48:51], v[32:35]
  ds_read_b128 v[68:71], v8 offset:25600
  v_mfma_f32_16x16x32_bf16 v[40:43], a[92:95], v[48:51], v[40:43]
  s_waitcnt lgkmcnt(4)
  v_mfma_f32_16x16x32_bf16 v[36:39], a[12:15], v[52:55], v[36:39]
  ds_read_b128 v[48:51], v8 offset:6144
  v_mfma_f32_16x16x32_bf16 v[44:47], a[92:95], v[52:55], v[44:47]
  s_waitcnt lgkmcnt(4)
  v_mfma_f32_16x16x32_bf16 v[32:35], a[16:19], v[56:59], v[32:35]
  ds_read_b128 v[52:55], v8 offset:26624
  v_mfma_f32_16x16x32_bf16 v[40:43], a[96:99], v[56:59], v[40:43]
  s_waitcnt lgkmcnt(4)
  v_mfma_f32_16x16x32_bf16 v[36:39], a[16:19], v[60:63], v[36:39]
  ds_read_b128 v[56:59], v8 offset:7168
  v_mfma_f32_16x16x32_bf16 v[44:47], a[96:99], v[60:63], v[44:47]
  s_waitcnt lgkmcnt(4)
  v_mfma_f32_16x16x32_bf16 v[32:35], a[20:23], v[64:67], v[32:35]
  ds_read_b128 v[60:63], v8 offset:27648
  v_mfma_f32_16x16x32_bf16 v[40:43], a[100:103], v[64:67], v[40:43]
  s_waitcnt lgkmcnt(4)
  v_mfma_f32_16x16x32_bf16 v[36:39], a[20:23], v[68:71], v[36:39]
  ds_read_b128 v[64:67], v8 offset:8192
  v_mfma_f32_16x16x32_bf16 v[44:47], a[100:103], v[68:71], v[44:47]
  s_waitcnt lgkmcnt(4)
  v_mfma_f32_16x16x32_bf16 v[32:35], a[24:27], v[48:51], v[32:35]
  ds_read_b128 v[68:71], v8 offset:28672
  v_mfma_f32_16x16x32_bf16 v[40:43], a[104:107], v[48:51], v[40:43]
  s_waitcnt lgkmcnt(4)
  v_mfma_f32_16x16x32_bf16 v[36:39], a[24:27], v[52:55], v[36:39]
  ds_read_b128 v[48:51], v8 offset:9216
  v_mfma_f32_16x16x32_bf16 v[44:47], a[104:107], v[52:55], v[44:47]
  s_waitcnt lgkmcnt(4)
  v_mfma_f32_16x16x32_bf16 v[32:35], a[28:31], v[56:59], v[32:35]
  ds_read_b128 v[52:55], v8 offset:29696
  v_mfma_f32_16x16x32_bf16 v[40:43], a[108:111], v[56:59], v[40:43]
  s_waitcnt lgkmcnt(4)
  v_mfma_f32_16x16x32_bf16 v[36:39], a[28:31], v[60:63], v[36:39]
  ds_read_b128 v[56:59], v8 offset:10240
  v_mfma_f32_16x16x32_bf16 v[44:47], a[108:111], v[60:63], v[44:47]
  s_waitcnt lgkmcnt(4)
  v_mfma_f32_16x16x32_bf16 v[32:35], a[32:35], v[64:67], v[32:35]
  ds_read_b128 v[60:63], v8 offset:30720
  v_mfma_f32_16x16x32_bf16 v[40:43], a[112:115], v[64:67], v[40:43]
  s_waitcnt lgkmcnt(4)
  v_mfma_f32_16x16x32_bf16 v[36:39], a[32:35], v[68:71], v[36:39]
  ds_read_b128 v[64:67], v8 offset:11264
  v_mfma_f32_16x16x32_bf16 v[44:47], a[112:115], v[68:71], v[44:47]
  s_waitcnt lgkmcnt(4)
  v_mfma_f32_16x16x32_bf16 v[32:35], a[36:39], v[48:51], v[32:35]
  ds_read_b128 v[68:71], v8 offset:31744
  v_mfma_f32_16x16x32_bf16 v[40:43], a[116:119], v[48:51], v[40:43]
  s_waitcnt lgkmcnt(4)
  v_mfma_f32_16x16x32_bf16 v[36:39], a[36:39], v[52:55], v[36:39]
  ds_read_b128 v[48:51], v8 offset:12288
  v_mfma_f32_16x16x32_bf16 v[44:47], a[116:119], v[52:55], v[44:47]
  s_waitcnt lgkmcnt(4)
  v_mfma_f32_16x16x32_bf16 v[32:35], a[40:43], v[56:59], v[32:35]
  ds_read_b128 v[52:55], v8 offset:32768
  v_mfma_f32_16x16x32_bf16 v[40:43], a[120:123], v[56:59], v[40:43]
  s_waitcnt lgkmcnt(4)
  v_mfma_f32_16x16x32_bf16 v[36:39], a[40:43], v[60:63], v[36:39]
  ds_read_b128 v[56:59], v8 offset:13312
  v_mfma_f32_16x16x32_bf16 v[44:47], a[120:123], v[60:63], v[44:47]
  s_waitcnt lgkmcnt(4)
  v_mfma_f32_16x16x32_bf16 v[32:35], a[44:47], v[64:67], v[32:35]
  ds_read_b128 v[60:63], v8 offset:33792
  v_mfma_f32_16x16x32_bf16 v[40:43], a[124:127], v[64:67], v[40:43]
  s_waitcnt lgkmcnt(4)
  v_mfma_f32_16x16x32_bf16 v[36:39], a[44:47], v[68:71], v[36:39]
  ds_read_b128 v[64:67], v8 offset:14336
  v_mfma_f32_16x16x32_bf16 v[44:47], a[124:127], v[68:71], v[44:47]
  s_waitcnt lgkmcnt(4)
  v_mfma_f32_16x16x32_bf16 v[32:35], a[48:51], v[48:51], v[32:35]
  ds_read_b128 v[68:71], v8 offset:34816
  v_mfma_f32_16x16x32_bf16 v[40:43], a[128:131], v[48:51], v[40:43]
  s_waitcnt lgkmcnt(4)
  v_mfma_f32_16x16x32_bf16 v[36:39], a[48:51], v[52:55], v[36:39]
  ds_read_b128 v[48:51], v8 offset:15360
  v_mfma_f32_16x16x32_bf16 v[44:47], a[128:131], v[52:55], v[44:47]
  s_waitcnt lgkmcnt(4)
  v_mfma_f32_16x16x32_bf16 v[32:35], a[52:55], v[56:59], v[32:35]
  ds_read_b128 v[52:55], v8 offset:35840
  v_mfma_f32_16x16x32_bf16 v[40:43], a[132:135], v[56:59], v[40:43]
  s_waitcnt lgkmcnt(4)
  v_mfma_f32_16x16x32_bf16 v[36:39], a[52:55], v[60:63], v[36:39]
  ds_read_b128 v[56:59], v8 offset:16384
  v_mfma_f32_16x16x32_bf16 v[44:47], a[132:135], v[60:63], v[44:47]
  s_waitcnt lgkmcnt(4)
  v_mfma_f32_16x16x32_bf16 v[32:35], a[56:59], v[64:67], v[32:35]
  ds_read_b128 v[60:63], v8 offset:36864
  v_mfma_f32_16x16x32_bf16 v[40:43], a[136:139], v[64:67], v[40:43]
  s_waitcnt lgkmcnt(4)
  v_mfma_f32_16x16x32_bf16 v[36:39], a[56:59], v[68:71], v[36:39]
  ds_read_b128 v[64:67], v8 offset:17408
  v_mfma_f32_16x16x32_bf16 v[44:47], a[136:139], v[68:71], v[44:47]
  s_waitcnt lgkmcnt(4)
  v_mfma_f32_16x16x32_bf16 v[32:35], a[60:63], v[48:51], v[32:35]
  ds_read_b128 v[68:71], v8 offset:37888
  v_mfma_f32_16x16x32_bf16 v[40:43], a[140:143], v[48:51], v[40:43]
  s_waitcnt lgkmcnt(4)
  v_mfma_f32_16x16x32_bf16 v[36:39], a[60:63], v[52:55], v[36:39]
  ds_read_b128 v[48:51], v8 offset:18432
  v_mfma_f32_16x16x32_bf16 v[44:47], a[140:143], v[52:55], v[44:47]
  s_waitcnt lgkmcnt(4)
  v_mfma_f32_16x16x32_bf16 v[32:35], a[64:67], v[56:59], v[32:35]
  ds_read_b128 v[52:55], v8 offset:38912
  v_mfma_f32_16x16x32_bf16 v[40:43], a[144:147], v[56:59], v[40:43]
  s_waitcnt lgkmcnt(4)
  v_mfma_f32_16x16x32_bf16 v[36:39], a[64:67], v[60:63], v[36:39]
  ds_read_b128 v[56:59], v8 offset:19456
  v_mfma_f32_16x16x32_bf16 v[44:47], a[144:147], v[60:63], v[44:47]
  s_waitcnt lgkmcnt(4)
  v_mfma_f32_16x16x32_bf16 v[32:35], a[68:71], v[64:67], v[32:35]
  ds_read_b128 v[60:63], v8 offset:39936
  v_mfma_f32_16x16x32_bf16 v[40:43], a[148:151], v[64:67], v[40:43]
  s_waitcnt lgkmcnt(4)
  v_mfma_f32_16x16x32_bf16 v[36:39], a[68:71], v[68:71], v[36:39]
  v_mfma_f32_16x16x32_bf16 v[44:47], a[148:151], v[68:71], v[44:47]
  s_waitcnt lgkmcnt(3)
  v_mfma_f32_16x16x32_bf16 v[32:35], a[72:75], v[48:51], v[32:35]
  v_mfma_f32_16x16x32_bf16 v[40:43], a[152:155], v[48:51], v[40:43]
  s_waitcnt lgkmcnt(2)
  v_mfma_f32_16x16x32_bf16 v[36:39], a[72:75], v[52:55], v[36:39]
  v_mfma_f32_16x16x32_bf16 v[44:47], a[152:155], v[52:55], v[44:47]
  s_waitcnt lgkmcnt(1)
  v_mfma_f32_16x16x32_bf16 v[32:35], a[76:79], v[56:59], v[32:35]
  v_mfma_f32_16x16x32_bf16 v[40:43], a[156:159], v[56:59], v[40:43]
  s_waitcnt lgkmcnt(0)
  v_mfma_f32_16x16x32_bf16 v[36:39], a[76:79], v[60:63], v[36:39]
  v_mfma_f32_16x16x32_bf16 v[44:47], a[156:159], v[60:63], v[44:47]
  s_lshl_b32 s40, s44, 5
  s_add_u32 s40, s40, s33
  s_lshl_b32 s40, s40, 13
  s_add_u32 s40, s40, 33554432
  v_cvt_pk_bf16_f32 v80, v32, v33
  v_cvt_pk_bf16_f32 v81, v34, v35
  v_cvt_pk_bf16_f32 v82, v40, v41
  v_cvt_pk_bf16_f32 v83, v42, v43
  buffer_store_dwordx4 v[80:83], v10, s[4:7], s40 offen offset:0 sc1
  v_cvt_pk_bf16_f32 v84, v36, v37
  v_cvt_pk_bf16_f32 v85, v38, v39
  v_cvt_pk_bf16_f32 v86, v44, v45
  v_cvt_pk_bf16_f32 v87, v46, v47
  s_add_u32 s40, s40, 4096
  buffer_store_dwordx4 v[84:87], v10, s[4:7], s40 offen offset:0 sc1
  s_add_u32 s44, s44, 1
  s_cmp_lt_u32 s44, 64
  s_cbranch_scc1 K_loop
  s_waitcnt vmcnt(0)
  s_barrier
  s_cmp_lg_u32 s34, 0
  s_cbranch_scc1 pub_47
  s_lshl_b32 s40, s33, 7
  s_add_u32 s40, s40, 16384
  v_and_b32 v11, 63, v0
  v_cmp_eq_u32 vcc, 0, v11
  v_mov_b32 v12, 0x7ffffff0
  s_nop 0
  v_cndmask_b32 v11, v12, 0, vcc
  v_mov_b32 v12, 64
  buffer_store_dword v12, v11, s[4:7], s40 offen sc1
pub_47:
  s_branch L_kvdone
L_v:
  s_load_dwordx2 s[20:21], s[0:1], 32
  s_mov_b32 s22, 0x500000
  s_mov_b32 s23, 0x00020000
  s_waitcnt lgkmcnt(0)
  v_bfe_u32 v14, v0, 4, 2
  v_mov_b32 v8, 0x0
  s_mov_b32 s36, 0x2000
  v_mad_i32_i24 v8, v14, s36, v8
  v_and_b32 v14, 15, v0
  v_mov_b32 v9, 0x0
  v_mad_i32_i24 v9, v14, 16, v9
  v_bfe_u32 v15, v0, 4, 2
  v_mov_b32 v14, 0x0
  v_mad_i32_i24 v14, v15, 32, v14
  v_xor_b32 v9, v9, v14
  v_add_u32 v8, v8, v9
  v_xor_b32 v9, 128, v8
  s_lshl_b32 s41, s33, 8
  s_mul_i32 s42, s34, 262144
  s_add_u32 s41, s41, s42
  s_add_u32 s41, s41, 0
  s_lshl_b32 s42, s34, 13
  s_add_u32 s42, s42, 0
  s_mov_b32 m0, s42
  s_nop 0
  buffer_load_dwordx4 v8, s[20:23], s41 offen lds
  s_add_u32 s41, s41, 32768
  s_add_u32 s42, s42, 1024
  s_mov_b32 m0, s42
  s_nop 0
  buffer_load_dwordx4 v8, s[20:23], s41 offen lds
  s_add_u32 s41, s41, 32768
  s_add_u32 s42, s42, 1024
  s_mov_b32 m0, s42
  s_nop 0
  buffer_load_dwordx4 v9, s[20:23], s41 offen lds
  s_add_u32 s41, s41, 32768
  s_add_u32 s42, s42, 1024
  s_mov_b32 m0, s42
  s_nop 0
  buffer_load_dwordx4 v9, s[20:23], s41 offen lds
  s_add_u32 s41, s41, 32768
  s_add_u32 s42, s42, 1024
  s_mov_b32 m0, s42
  s_nop 0
  buffer_load_dwordx4 v8, s[20:23], s41 offen lds
  s_add_u32 s41, s41, 32768
  s_add_u32 s42, s42, 1024
  s_mov_b32 m0, s42
  s_nop 0
  buffer_load_dwordx4 v8, s[20:23], s41 offen lds
  s_add_u32 s41, s41, 32768
  s_add_u32 s42, s42, 1024
  s_mov_b32 m0, s42
  s_nop 0
  buffer_load_dwordx4 v9, s[20:23], s41 offen lds
  s_add_u32 s41, s41, 32768
  s_add_u32 s42, s42, 1024
  s_mov_b32 m0, s42
  s_nop 0
  buffer_load_dwordx4 v9, s[20:23], s41 offen lds
  s_lshl_b32 s41, s33, 8
  s_mul_i32 s42, s34, 262144
  s_add_u32 s41, s41, s42
  s_add_u32 s41, s41, 1048576
  s_lshl_b32 s42, s34, 13
  s_add_u32 s42, s42, 32768
  s_mov_b32 m0, s42
  s_nop 0
  buffer_load_dwordx4 v8, s[20:23], s41 offen lds
  s_add_u32 s41, s41, 32768
  s_add_u32 s42, s42, 1024
  s_mov_b32 m0, s42
  s_nop 0
  buffer_load_dwordx4 v8, s[20:23], s41 offen lds
  s_add_u32 s41, s41, 32768
  s_add_u32 s42, s42, 1024
  s_mov_b32 m0, s42
  s_nop 0
  buffer_load_dwordx4 v9, s[20:23], s41 offen lds
  s_add_u32 s41, s41, 32768
  s_add_u32 s42, s42, 1024
  s_mov_b32 m0, s42
  s_nop 0
  buffer_load_dwordx4 v9, s[20:23], s41 offen lds
  s_add_u32 s41, s41, 32768
  s_add_u32 s42, s42, 1024
  s_mov_b32 m0, s42
  s_nop 0
  buffer_load_dwordx4 v8, s[20:23], s41 offen lds
  s_add_u32 s41, s41, 32768
  s_add_u32 s42, s42, 1024
  s_mov_b32 m0, s42
  s_nop 0
  buffer_load_dwordx4 v8, s[20:23], s41 offen lds
  s_add_u32 s41, s41, 32768
  s_add_u32 s42, s42, 1024
  s_mov_b32 m0, s42
  s_nop 0
  buffer_load_dwordx4 v9, s[20:23], s41 offen lds
  s_add_u32 s41, s41, 32768
  s_add_u32 s42, s42, 1024
  s_mov_b32 m0, s42
  s_nop 0
  buffer_load_dwordx4 v9, s[20:23], s41 offen lds
  s_lshl_b32 s41, s33, 8
  s_mul_i32 s42, s34, 262144
  s_add_u32 s41, s41, s42
  s_add_u32 s41, s41, 2097152
  s_lshl_b32 s42, s34, 13
  s_add_u32 s42, s42, 65536
  s_mov_b32 m0, s42
  s_nop 0
  buffer_load_dwordx4 v8, s[20:23], s41 offen lds
  s_add_u32 s41, s41, 32768
  s_add_u32 s42, s42, 1024
  s_mov_b32 m0, s42
  s_nop 0
  buffer_load_dwordx4 v8, s[20:23], s41 offen lds
  s_add_u32 s41, s41, 32768
  s_add_u32 s42, s42, 1024
  s_mov_b32 m0, s42
  s_nop 0
  buffer_load_dwordx4 v9, s[20:23], s41 offen lds
  s_add_u32 s41, s41, 32768
  s_add_u32 s42, s42, 1024
  s_mov_b32 m0, s42
  s_nop 0
  buffer_load_dwordx4 v9, s[20:23], s41 offen lds
  s_add_u32 s41, s41, 32768
  s_add_u32 s42, s42, 1024
  s_mov_b32 m0, s42
  s_nop 0
  buffer_load_dwordx4 v8, s[20:23], s41 offen lds
  s_add_u32 s41, s41, 32768
  s_add_u32 s42, s42, 1024
  s_mov_b32 m0, s42
  s_nop 0
  buffer_load_dwordx4 v8, s[20:23], s41 offen lds
  s_add_u32 s41, s41, 32768
  s_add_u32 s42, s42, 1024
  s_mov_b32 m0, s42
  s_nop 0
  buffer_load_dwordx4 v9, s[20:23], s41 offen lds
  s_add_u32 s41, s41, 32768
  s_add_u32 s42, s42, 1024
  s_mov_b32 m0, s42
  s_nop 0
  buffer_load_dwordx4 v9, s[20:23], s41 offen lds
  s_lshl_b32 s41, s33, 8
  s_mul_i32 s42, s34, 262144
  s_add_u32 s41, s41, s42
  s_add_u32 s41, s41, 3145728
  s_lshl_b32 s42, s34, 13
  s_add_u32 s42, s42, 98304
  s_mov_b32 m0, s42
  s_nop 0
  buffer_load_dwordx4 v8, s[20:23], s41 offen lds
  s_add_u32 s41, s41, 32768
  s_add_u32 s42, s42, 1024
  s_mov_b32 m0, s42
  s_nop 0
  buffer_load_dwordx4 v8, s[20:23], s41 offen lds
  s_add_u32 s41, s41, 32768
  s_add_u32 s42, s42, 1024
  s_mov_b32 m0, s42
  s_nop 0
  buffer_load_dwordx4 v9, s[20:23], s41 offen lds
  s_add_u32 s41, s41, 32768
  s_add_u32 s42, s42, 1024
  s_mov_b32 m0, s42
  s_nop 0
  buffer_load_dwordx4 v9, s[20:23], s41 offen lds
  s_add_u32 s41, s41, 32768
  s_add_u32 s42, s42, 1024
  s_mov_b32 m0, s42
  s_nop 0
  buffer_load_dwordx4 v8, s[20:23], s41 offen lds
  s_add_u32 s41, s41, 32768
  s_add_u32 s42, s42, 1024
  s_mov_b32 m0, s42
  s_nop 0
  buffer_load_dwordx4 v8, s[20:23], s41 offen lds
  s_add_u32 s41, s41, 32768
  s_add_u32 s42, s42, 1024
  s_mov_b32 m0, s42
  s_nop 0
  buffer_load_dwordx4 v9, s[20:23], s41 offen lds
  s_add_u32 s41, s41, 32768
  s_add_u32 s42, s42, 1024
  s_mov_b32 m0, s42
  s_nop 0
  buffer_load_dwordx4 v9, s[20:23], s41 offen lds
  v_bfe_u32 v14, v0, 1, 1
  v_mov_b32 v10, 0x0
  v_mad_i32_i24 v10, v14, 1, v10
  v_lshrrev_b32 v14, 6, v0
  v_mad_i32_i24 v10, v14, 4, v10
  v_bfe_u32 v14, v0, 2, 3
  v_mov_b32 v11, 0x0
  v_mad_i32_i24 v11, v14, 2, v11
  v_xor_b32 v10, v10, v11
  v_lshlrev_b32 v10, 4, v10
  v_and_b32 v14, 1, v0
  v_mov_b32 v11, 0x0
  v_mad_i32_i24 v11, v14, 8, v11
  v_bfe_u32 v14, v0, 2, 2
  s_mov_b32 s36, 0x100
  v_mad_i32_i24 v11, v14, s36, v11
  v_bfe_u32 v14, v0, 4, 2
  s_mov_b32 s36, 0x800
  v_mad_i32_i24 v11, v14, s36, v11
  v_add_u32 v10, v10, v11
  v_xor_b32 v11, 32, v10
  v_add_u32 v12, 0x10000, v10
  v_add_u32 v13, 0x10000, v11
  s_waitcnt vmcnt(24)
  s_barrier
  ds_read_b64_tr_b16 a[0:1], v10 offset:0
  ds_read_b64_tr_b16 a[2:3], v10 offset:1024
  ds_read_b64_tr_b16 a[80:81], v11 offset:0
  ds_read_b64_tr_b16 a[82:83], v11 offset:1024
  ds_read_b64_tr_b16 a[4:5], v10 offset:8192
  ds_read_b64_tr_b16 a[6:7], v10 offset:9216
  ds_read_b64_tr_b16 a[84:85], v11 offset:8192
  ds_read_b64_tr_b16 a[86:87], v11 offset:9216
  ds_read_b64_tr_b16 a[8:9], v10 offset:16384
  ds_read_b64_tr_b16 a[10:11], v10 offset:17408
  ds_read_b64_tr_b16 a[88:89], v11 offset:16384
  ds_read_b64_tr_b16 a[90:91], v11 offset:17408
  ds_read_b64_tr_b16 a[12:13], v10 offset:24576
  ds_read_b64_tr_b16 a[14:15], v10 offset:25600
  ds_read_b64_tr_b16 a[92:93], v11 offset:24576
  ds_read_b64_tr_b16 a[94:95], v11 offset:25600
  s_waitcnt lgkmcnt(0)
  s_barrier
  s_lshl_b32 s41, s33, 8
  s_mul_i32 s42, s34, 262144
  s_add_u32 s41, s41, s42
  s_add_u32 s41, s41, 4194304
  s_lshl_b32 s42, s34, 13
  s_add_u32 s42, s42, 0
  s_mov_b32 m0, s42
  s_nop 0
  buffer_load_dwordx4 v8, s[20:23], s41 offen lds
  s_add_u32 s41, s41, 32768
  s_add_u32 s42, s42, 1024
  s_mov_b32 m0, s42
  s_nop 0
  buffer_load_dwordx4 v8, s[20:23], s41 offen lds
  s_add_u32 s41, s41, 32768
  s_add_u32 s42, s42, 1024
  s_mov_b32 m0, s42
  s_nop 0
  buffer_load_dwordx4 v9, s[20:23], s41 offen lds
  s_add_u32 s41, s41, 32768
  s_add_u32 s42, s42, 1024
  s_mov_b32 m0, s42
  s_nop 0
  buffer_load_dwordx4 v9, s[20:23], s41 offen lds
  s_add_u32 s41, s41, 32768
  s_add_u32 s42, s42, 1024
  s_mov_b32 m0, s42
  s_nop 0
  buffer_load_dwordx4 v8, s[20:23], s41 offen lds
  s_add_u32 s41, s41, 32768
  s_add_u32 s42, s42, 1024
  s_mov_b32 m0, s42
  s_nop 0
  buffer_load_dwordx4 v8, s[20:23], s41 offen lds
  s_add_u32 s41, s41, 32768
  s_add_u32 s42, s42, 1024
  s_mov_b32 m0, s42
  s_nop 0
  buffer_load_dwordx4 v9, s[20:23], s41 offen lds
  s_add_u32 s41, s41, 32768
  s_add_u32 s42, s42, 1024
  s_mov_b32 m0, s42
  s_nop 0
  buffer_load_dwordx4 v9, s[20:23], s41 offen lds
  s_waitcnt vmcnt(24)
  s_barrier
  ds_read_b64_tr_b16 a[16:17], v10 offset:32768
  ds_read_b64_tr_b16 a[18:19], v10 offset:33792
  ds_read_b64_tr_b16 a[96:97], v11 offset:32768
  ds_read_b64_tr_b16 a[98:99], v11 offset:33792
  ds_read_b64_tr_b16 a[20:21], v10 offset:40960
  ds_read_b64_tr_b16 a[22:23], v10 offset:41984
  ds_read_b64_tr_b16 a[100:101], v11 offset:40960
  ds_read_b64_tr_b16 a[102:103], v11 offset:41984
  ds_read_b64_tr_b16 a[24:25], v10 offset:49152
  ds_read_b64_tr_b16 a[26:27], v10 offset:50176
  ds_read_b64_tr_b16 a[104:105], v11 offset:49152
  ds_read_b64_tr_b16 a[106:107], v11 offset:50176
  ds_read_b64_tr_b16 a[28:29], v10 offset:57344
  ds_read_b64_tr_b16 a[30:31], v10 offset:58368
  ds_read_b64_tr_b16 a[108:109], v11 offset:57344
  ds_read_b64_tr_b16 a[110:111], v11 offset:58368
  s_waitcnt vmcnt(16)
  s_barrier
  ds_read_b64_tr_b16 a[32:33], v12 offset:0
  ds_read_b64_tr_b16 a[34:35], v12 offset:1024
  ds_read_b64_tr_b16 a[112:113], v13 offset:0
  ds_read_b64_tr_b16 a[114:115], v13 offset:1024
  ds_read_b64_tr_b16 a[36:37], v12 offset:8192
  ds_read_b64_tr_b16 a[38:39], v12 offset:9216
  ds_read_b64_tr_b16 a[116:117], v13 offset:8192
  ds_read_b64_tr_b16 a[118:119], v13 offset:9216
  ds_read_b64_tr_b16 a[40:41], v12 offset:16384
  ds_read_b64_tr_b16 a[42:43], v12 offset:17408
  ds_read_b64_tr_b16 a[120:121], v13 offset:16384
  ds_read_b64_tr_b16 a[122:123], v13 offset:17408
  ds_read_b64_tr_b16 a[44:45], v12 offset:24576
  ds_read_b64_tr_b16 a[46:47], v12 offset:25600
  ds_read_b64_tr_b16 a[124:125], v13 offset:24576
  ds_read_b64_tr_b16 a[126:127], v13 offset:25600
  s_waitcnt vmcnt(8)
  s_barrier
  ds_read_b64_tr_b16 a[48:49], v12 offset:32768
  ds_read_b64_tr_b16 a[50:51], v12 offset:33792
  ds_read_b64_tr_b16 a[128:129], v13 offset:32768
  ds_read_b64_tr_b16 a[130:131], v13 offset:33792
  ds_read_b64_tr_b16 a[52:53], v12 offset:40960
  ds_read_b64_tr_b16 a[54:55], v12 offset:41984
  ds_read_b64_tr_b16 a[132:133], v13 offset:40960
  ds_read_b64_tr_b16 a[134:135], v13 offset:41984
  ds_read_b64_tr_b16 a[56:57], v12 offset:49152
  ds_read_b64_tr_b16 a[58:59], v12 offset:50176
  ds_read_b64_tr_b16 a[136:137], v13 offset:49152
  ds_read_b64_tr_b16 a[138:139], v13 offset:50176
  ds_read_b64_tr_b16 a[60:61], v12 offset:57344
  ds_read_b64_tr_b16 a[62:63], v12 offset:58368
  ds_read_b64_tr_b16 a[140:141], v13 offset:57344
  ds_read_b64_tr_b16 a[142:143], v13 offset:58368
  s_waitcnt vmcnt(0)
  s_barrier
  ds_read_b64_tr_b16 a[64:65], v10 offset:0
  ds_read_b64_tr_b16 a[66:67], v10 offset:1024
  ds_read_b64_tr_b16 a[144:145], v11 offset:0
  ds_read_b64_tr_b16 a[146:147], v11 offset:1024
  ds_read_b64_tr_b16 a[68:69], v10 offset:8192
  ds_read_b64_tr_b16 a[70:71], v10 offset:9216
  ds_read_b64_tr_b16 a[148:149], v11 offset:8192
  ds_read_b64_tr_b16 a[150:151], v11 offset:9216
  ds_read_b64_tr_b16 a[72:73], v10 offset:16384
  ds_read_b64_tr_b16 a[74:75], v10 offset:17408
  ds_read_b64_tr_b16 a[152:153], v11 offset:16384
  ds_read_b64_tr_b16 a[154:155], v11 offset:17408
  ds_read_b64_tr_b16 a[76:77], v10 offset:24576
  ds_read_b64_tr_b16 a[78:79], v10 offset:25600
  ds_read_b64_tr_b16 a[156:157], v11 offset:24576
  ds_read_b64_tr_b16 a[158:159], v11 offset:25600
  s_waitcnt lgkmcnt(0)
  s_barrier
  s_cmp_lg_u32 s34, 0
  s_cbranch_scc1 pd_48
  v_mov_b32 v8, 32
poll_49:
  buffer_load_dword v9, v8, s[8:11], 0 offen sc1
  s_waitcnt vmcnt(0)
  v_cmp_gt_u32 vcc, 40, v9
  s_cbranch_vccz polled_50
  s_sleep 3
  s_add_u32 s35, s35, 1
  s_cmp_lt_u32 s35, 300000
  s_cbranch_scc1 poll_49
polled_50:
pd_48:
  s_barrier
  v_and_b32 v12, 63, v0
  v_min_u32 v12, 63, v12
  v_lshlrev_b32 v12, 7, v12
  v_add_u32 v11, 0x0, v12
  s_cmp_lg_u32 s34, 0
  s_cbranch_scc1 pw_51
poll_52:
  buffer_load_dword v12, v11, s[4:7], 0 offen sc1
  s_waitcnt vmcnt(0)
  v_cmp_gt_u32 vcc, 1, v12
  s_cbranch_vccz polled_53
  s_sleep 3
  s_add_u32 s35, s35, 1
  s_cmp_lt_u32 s35, 300000
  s_cbranch_scc1 poll_52
polled_53:
pw_51:
  s_barrier
  v_and_b32 v12, 63, v0
  v_min_u32 v12, 63, v12
  v_lshlrev_b32 v12, 7, v12
  v_add_u32 v11, 0x2000, v12
  s_cmp_lg_u32 s34, 0
  s_cbranch_scc1 pw_54
poll_55:
  buffer_load_dword v12, v11, s[4:7], 0 offen sc1
  s_waitcnt vmcnt(0)
  v_cmp_gt_u32 vcc, 1, v12
  s_cbranch_vccz polled_56
  s_sleep 3
  s_add_u32 s35, s35, 1
  s_cmp_lt_u32 s35, 300000
  s_cbranch_scc1 poll_55
polled_56:
pw_54:
  s_barrier
  v_and_b32 v11, 63, v0
  v_mov_b32 v9, 0x0
  v_mad_i32_i24 v9, v11, 16, v9
  v_and_b32 v11, 63, v0
  v_mov_b32 v10, 0x0
  v_mad_i32_i24 v10, v11, 16, v10
  v_lshrrev_b32 v11, 6, v0
  s_mov_b32 s36, 0x800
  v_mad_i32_i24 v10, v11, s36, v10
  s_mov_b32 s44, 0
  s_mov_b32 s45, 0
  s_mul_i32 s41, s44, 40960
  s_mul_i32 s42, s34, 10240
  s_add_u32 s41, s41, s42
  s_add_u32 s41, s41, 4194304
  s_add_u32 s42, s42, s45
  s_mov_b32 m0, s42
  s_nop 0
  buffer_load_dwordx4 v9, s[4:7], s41 offen offset:0 sc1 lds
  buffer_load_dwordx4 v9, s[4:7], s41 offen offset:1024 sc1 lds
  buffer_load_dwordx4 v9, s[4:7], s41 offen offset:2048 sc1 lds
  buffer_load_dwordx4 v9, s[4:7], s41 offen offset:3072 sc1 lds
  s_add_u32 s41, s41, 4096
  s_add_u32 s42, s42, 4096
  s_mov_b32 m0, s42
  s_nop 0
  buffer_load_dwordx4 v9, s[4:7], s41 offen offset:0 sc1 lds
  buffer_load_dwordx4 v9, s[4:7], s41 offen offset:1024 sc1 lds
  buffer_load_dwordx4 v9, s[4:7], s41 offen offset:2048 sc1 lds
  buffer_load_dwordx4 v9, s[4:7], s41 offen offset:3072 sc1 lds
  s_add_u32 s41, s41, 4096
  s_add_u32 s42, s42, 4096
  s_mov_b32 m0, s42
  s_nop 0
  buffer_load_dwordx4 v9, s[4:7], s41 offen offset:0 sc1 lds
  buffer_load_dwordx4 v9, s[4:7], s41 offen offset:1024 sc1 lds
V_loop:
  s_waitcnt vmcnt(0)
  s_barrier
  s_cmp_lg_u32 s34, 0
  s_cbranch_scc1 pub_57
  s_lshl_b32 s40, s33, 7
  s_add_u32 s40, s40, 20480
  v_and_b32 v11, 63, v0
  v_cmp_eq_u32 vcc, 0, v11
  v_mov_b32 v12, 0x7ffffff0
  s_nop 0
  v_cndmask_b32 v11, v12, 0, vcc
  v_mov_b32 v12, s44
  buffer_store_dword v12, v11, s[4:7], s40 offen sc1
pub_57:
  v_add_u32 v8, s45, v9
  s_xor_b32 s45, s45, 40960
  s_add_u32 s46, s44, 1
  s_cmp_ge_u32 s46, 64
  s_cbranch_scc1 nonext_58
  s_mul_i32 s41, s46, 40960
  s_mul_i32 s42, s34, 10240
  s_add_u32 s41, s41, s42
  s_add_u32 s41, s41, 4194304
  s_add_u32 s42, s42, s45
  s_mov_b32 m0, s42
  s_nop 0
  buffer_load_dwordx4 v9, s[4:7], s41 offen offset:0 sc1 lds
  buffer_load_dwordx4 v9, s[4:7], s41 offen offset:1024 sc1 lds
  buffer_load_dwordx4 v9, s[4:7], s41 offen offset:2048 sc1 lds
  buffer_load_dwordx4 v9, s[4:7], s41 offen offset:3072 sc1 lds
  s_add_u32 s41, s41, 4096
  s_add_u32 s42, s42, 4096
  s_mov_b32 m0, s42
  s_nop 0
  buffer_load_dwordx4 v9, s[4:7], s41 offen offset:0 sc1 lds
  buffer_load_dwordx4 v9, s[4:7], s41 offen offset:1024 sc1 lds
  buffer_load_dwordx4 v9, s[4:7], s41 offen offset:2048 sc1 lds
  buffer_load_dwordx4 v9, s[4:7], s41 offen offset:3072 sc1 lds
  s_add_u32 s41, s41, 4096
  s_add_u32 s42, s42, 4096
  s_mov_b32 m0, s42
  s_nop 0
  buffer_load_dwordx4 v9, s[4:7], s41 offen offset:0 sc1 lds
  buffer_load_dwordx4 v9, s[4:7], s41 offen offset:1024 sc1 lds
nonext_58:
  ds_read_b128 v[48:51], v8 offset:0
  ds_read_b128 v[52:55], v8 offset:20480
  ds_read_b128 v[56:59], v8 offset:1024
  ds_read_b128 v[60:63], v8 offset:21504
  ds_read_b128 v[64:67], v8 offset:2048
  s_waitcnt lgkmcnt(4)
  v_mfma_f32_16x16x32_bf16 v[32:35], v[48:51], a[0:3], 0
  ds_read_b128 v[68:71], v8 offset:22528
  v_mfma_f32_16x16x32_bf16 v[40:43], v[48:51], a[80:83], 0
  s_waitcnt lgkmcnt(4)
  v_mfma_f32_16x16x32_bf16 v[36:39], v[52:55], a[0:3], 0
  ds_read_b128 v[48:51], v8 offset:3072
  v_mfma_f32_16x16x32_bf16 v[44:47], v[52:55], a[80:83], 0
  s_waitcnt lgkmcnt(4)
  v_mfma_f32_16x16x32_bf16 v[32:35], v[56:59], a[4:7], v[32:35]
  ds_read_b128 v[52:55], v8 offset:23552
  v_mfma_f32_16x16x32_bf16 v[40:43], v[56:59], a[84:87], v[40:43]
  s_waitcnt lgkmcnt(4)
  v_mfma_f32_16x16x32_bf16 v[36:39], v[60:63], a[4:7], v[36:39]
  ds_read_b128 v[56:59], v8 offset:4096
  v_mfma_f32_16x16x32_bf16 v[44:47], v[60:63], a[84:87], v[44:47]
  s_waitcnt lgkmcnt(4)
  v_mfma_f32_16x16x32_bf16 v[32:35], v[64:67], a[8:11], v[32:35]
  ds_read_b128 v[60:63], v8 offset:24576
  v_mfma_f32_16x16x32_bf16 v[40:43], v[64:67], a[88:91], v[40:43]
  s_waitcnt lgkmcnt(4)
  v_mfma_f32_16x16x32_bf16 v[36:39], v[68:71], a[8:11], v[36:39]
  ds_read_b128 v[64:67], v8 offset:5120
  v_mfma_f32_16x16x32_bf16 v[44:47], v[68:71], a[88:91], v[44:47]
  s_waitcnt lgkmcnt(4)
  v_mfma_f32_16x16x32_bf16 v[32:35], v[48:51], a[12:15], v[32:35]
  ds_read_b128 v[68:71], v8 offset:25600
  v_mfma_f32_16x16x32_bf16 v[40:43], v[48:51], a[92:95], v[40:43]
  s_waitcnt lgkmcnt(4)
  v_mfma_f32_16x16x32_bf16 v[36:39], v[52:55], a[12:15], v[36:39]
  ds_read_b128 v[48:51], v8 offset:6144
  v_mfma_f32_16x16x32_bf16 v[44:47], v[52:55], a[92:95], v[44:47]
  s_waitcnt lgkmcnt(4)
  v_mfma_f32_16x16x32_bf16 v[32:35], v[56:59], a[16:19], v[32:35]
  ds_read_b128 v[52:55], v8 offset:26624
  v_mfma_f32_16x16x32_bf16 v[40:43], v[56:59], a[96:99], v[40:43]
  s_waitcnt lgkmcnt(4)
  v_mfma_f32_16x16x32_bf16 v[36:39], v[60:63], a[16:19], v[36:39]
  ds_read_b128 v[56:59], v8 offset:7168
  v_mfma_f32_16x16x32_bf16 v[44:47], v[60:63], a[96:99], v[44:47]
  s_waitcnt lgkmcnt(4)
  v_mfma_f32_16x16x32_bf16 v[32:35], v[64:67], a[20:23], v[32:35]
  ds_read_b128 v[60:63], v8 offset:27648
  v_mfma_f32_16x16x32_bf16 v[40:43], v[64:67], a[100:103], v[40:43]
  s_waitcnt lgkmcnt(4)
  v_mfma_f32_16x16x32_bf16 v[36:39], v[68:71], a[20:23], v[36:39]
  ds_read_b128 v[64:67], v8 offset:8192
  v_mfma_f32_16x16x32_bf16 v[44:47], v[68:71], a[100:103], v[44:47]
  s_waitcnt lgkmcnt(4)
  v_mfma_f32_16x16x32_bf16 v[32:35], v[48:51], a[24:27], v[32:35]
  ds_read_b128 v[68:71], v8 offset:28672
  v_mfma_f32_16x16x32_bf16 v[40:43], v[48:51], a[104:107], v[40:43]
  s_waitcnt lgkmcnt(4)
  v_mfma_f32_16x16x32_bf16 v[36:39], v[52:55], a[24:27], v[36:39]
  ds_read_b128 v[48:51], v8 offset:9216
  v_mfma_f32_16x16x32_bf16 v[44:47], v[52:55], a[104:107], v[44:47]
  s_waitcnt lgkmcnt(4)
  v_mfma_f32_16x16x32_bf16 v[32:35], v[56:59], a[28:31], v[32:35]
  ds_read_b128 v[52:55], v8 offset:29696
  v_mfma_f32_16x16x32_bf16 v[40:43], v[56:59], a[108:111], v[40:43]
  s_waitcnt lgkmcnt(4)
  v_mfma_f32_16x16x32_bf16 v[36:39], v[60:63], a[28:31], v[36:39]
  ds_read_b128 v[56:59], v8 offset:10240
  v_mfma_f32_16x16x32_bf16 v[44:47], v[60:63], a[108:111], v[44:47]
  s_waitcnt lgkmcnt(4)
  v_mfma_f32_16x16x32_bf16 v[32:35], v[64:67], a[32:35], v[32:35]
  ds_read_b128 v[60:63], v8 offset:30720
  v_mfma_f32_16x16x32_bf16 v[40:43], v[64:67], a[112:115], v[40:43]
  s_waitcnt lgkmcnt(4)
  v_mfma_f32_16x16x32_bf16 v[36:39], v[68:71], a[32:35], v[36:39]
  ds_read_b128 v[64:67], v8 offset:11264
  v_mfma_f32_16x16x32_bf16 v[44:47], v[68:71], a[112:115], v[44:47]
  s_waitcnt lgkmcnt(4)
  v_mfma_f32_16x16x32_bf16 v[32:35], v[48:51], a[36:39], v[32:35]
  ds_read_b128 v[68:71], v8 offset:31744
  v_mfma_f32_16x16x32_bf16 v[40:43], v[48:51], a[116:119], v[40:43]
  s_waitcnt lgkmcnt(4)
  v_mfma_f32_16x16x32_bf16 v[36:39], v[52:55], a[36:39], v[36:39]
  ds_read_b128 v[48:51], v8 offset:12288
  v_mfma_f32_16x16x32_bf16 v[44:47], v[52:55], a[116:119], v[44:47]
  s_waitcnt lgkmcnt(4)
  v_mfma_f32_16x16x32_bf16 v[32:35], v[56:59], a[40:43], v[32:35]
  ds_read_b128 v[52:55], v8 offset:32768
  v_mfma_f32_16x16x32_bf16 v[40:43], v[56:59], a[120:123], v[40:43]
  s_waitcnt lgkmcnt(4)
  v_mfma_f32_16x16x32_bf16 v[36:39], v[60:63], a[40:43], v[36:39]
  ds_read_b128 v[56:59], v8 offset:13312
  v_mfma_f32_16x16x32_bf16 v[44:47], v[60:63], a[120:123], v[44:47]
  s_waitcnt lgkmcnt(4)
  v_mfma_f32_16x16x32_bf16 v[32:35], v[64:67], a[44:47], v[32:35]
  ds_read_b128 v[60:63], v8 offset:33792
  v_mfma_f32_16x16x32_bf16 v[40:43], v[64:67], a[124:127], v[40:43]
  s_waitcnt lgkmcnt(4)
  v_mfma_f32_16x16x32_bf16 v[36:39], v[68:71], a[44:47], v[36:39]
  ds_read_b128 v[64:67], v8 offset:14336
  v_mfma_f32_16x16x32_bf16 v[44:47], v[68:71], a[124:127], v[44:47]
  s_waitcnt lgkmcnt(4)
  v_mfma_f32_16x16x32_bf16 v[32:35], v[48:51], a[48:51], v[32:35]
  ds_read_b128 v[68:71], v8 offset:34816
  v_mfma_f32_16x16x32_bf16 v[40:43], v[48:51], a[128:131], v[40:43]
  s_waitcnt lgkmcnt(4)
  v_mfma_f32_16x16x32_bf16 v[36:39], v[52:55], a[48:51], v[36:39]
  ds_read_b128 v[48:51], v8 offset:15360
  v_mfma_f32_16x16x32_bf16 v[44:47], v[52:55], a[128:131], v[44:47]
  s_waitcnt lgkmcnt(4)
  v_mfma_f32_16x16x32_bf16 v[32:35], v[56:59], a[52:55], v[32:35]
  ds_read_b128 v[52:55], v8 offset:35840
  v_mfma_f32_16x16x32_bf16 v[40:43], v[56:59], a[132:135], v[40:43]
  s_waitcnt lgkmcnt(4)
  v_mfma_f32_16x16x32_bf16 v[36:39], v[60:63], a[52:55], v[36:39]
  ds_read_b128 v[56:59], v8 offset:16384
  v_mfma_f32_16x16x32_bf16 v[44:47], v[60:63], a[132:135], v[44:47]
  s_waitcnt lgkmcnt(4)
  v_mfma_f32_16x16x32_bf16 v[32:35], v[64:67], a[56:59], v[32:35]
  ds_read_b128 v[60:63], v8 offset:36864
  v_mfma_f32_16x16x32_bf16 v[40:43], v[64:67], a[136:139], v[40:43]
  s_waitcnt lgkmcnt(4)
  v_mfma_f32_16x16x32_bf16 v[36:39], v[68:71], a[56:59], v[36:39]
  ds_read_b128 v[64:67], v8 offset:17408
  v_mfma_f32_16x16x32_bf16 v[44:47], v[68:71], a[136:139], v[44:47]
  s_waitcnt lgkmcnt(4)
  v_mfma_f32_16x16x32_bf16 v[32:35], v[48:51], a[60:63], v[32:35]
  ds_read_b128 v[68:71], v8 offset:37888
  v_mfma_f32_16x16x32_bf16 v[40:43], v[48:51], a[140:143], v[40:43]
  s_waitcnt lgkmcnt(4)
  v_mfma_f32_16x16x32_bf16 v[36:39], v[52:55], a[60:63], v[36:39]
  ds_read_b128 v[48:51], v8 offset:18432
  v_mfma_f32_16x16x32_bf16 v[44:47], v[52:55], a[140:143], v[44:47]
  s_waitcnt lgkmcnt(4)
  v_mfma_f32_16x16x32_bf16 v[32:35], v[56:59], a[64:67], v[32:35]
  ds_read_b128 v[52:55], v8 offset:38912
  v_mfma_f32_16x16x32_bf16 v[40:43], v[56:59], a[144:147], v[40:43]
  s_waitcnt lgkmcnt(4)
  v_mfma_f32_16x16x32_bf16 v[36:39], v[60:63], a[64:67], v[36:39]
  ds_read_b128 v[56:59], v8 offset:19456
  v_mfma_f32_16x16x32_bf16 v[44:47], v[60:63], a[144:147], v[44:47]
  s_waitcnt lgkmcnt(4)
  v_mfma_f32_16x16x32_bf16 v[32:35], v[64:67], a[68:71], v[32:35]
  ds_read_b128 v[60:63], v8 offset:39936
  v_mfma_f32_16x16x32_bf16 v[40:43], v[64:67], a[148:151], v[40:43]
  s_waitcnt lgkmcnt(4)
  v_mfma_f32_16x16x32_bf16 v[36:39], v[68:71], a[68:71], v[36:39]
  v_mfma_f32_16x16x32_bf16 v[44:47], v[68:71], a[148:151], v[44:47]
  s_waitcnt lgkmcnt(3)
  v_mfma_f32_16x16x32_bf16 v[32:35], v[48:51], a[72:75], v[32:35]
  v_mfma_f32_16x16x32_bf16 v[40:43], v[48:51], a[152:155], v[40:43]
  s_waitcnt lgkmcnt(2)
  v_mfma_f32_16x16x32_bf16 v[36:39], v[52:55], a[72:75], v[36:39]
  v_mfma_f32_16x16x32_bf16 v[44:47], v[52:55], a[152:155], v[44:47]
  s_waitcnt lgkmcnt(1)
  v_mfma_f32_16x16x32_bf16 v[32:35], v[56:59], a[76:79], v[32:35]
  v_mfma_f32_16x16x32_bf16 v[40:43], v[56:59], a[156:159], v[40:43]
  s_waitcnt lgkmcnt(0)
  v_mfma_f32_16x16x32_bf16 v[36:39], v[60:63], a[76:79], v[36:39]
  v_mfma_f32_16x16x32_bf16 v[44:47], v[60:63], a[156:159], v[44:47]
  s_lshl_b32 s40, s44, 5
  s_add_u32 s40, s40, s33
  s_lshl_b32 s40, s40, 13
  s_add_u32 s40, s40, 50331648
  v_cvt_pk_bf16_f32 v80, v32, v33
  v_cvt_pk_bf16_f32 v81, v34, v35
  v_cvt_pk_bf16_f32 v82, v36, v37
  v_cvt_pk_bf16_f32 v83, v38, v39
  buffer_store_dwordx4 v[80:83], v10, s[4:7], s40 offen offset:0 sc1
  v_cvt_pk_bf16_f32 v84, v40, v41
  v_cvt_pk_bf16_f32 v85, v42, v43
  v_cvt_pk_bf16_f32 v86, v44, v45
  v_cvt_pk_bf16_f32 v87, v46, v47
  buffer_store_dwordx4 v[84:87], v10, s[4:7], s40 offen offset:1024 sc1
  s_add_u32 s44, s44, 1
  s_cmp_lt_u32 s44, 64
  s_cbranch_scc1 V_loop
  s_waitcnt vmcnt(0)
  s_barrier
  s_cmp_lg_u32 s34, 0
  s_cbranch_scc1 pub_59
  s_lshl_b32 s40, s33, 7
  s_add_u32 s40, s40, 20480
  v_and_b32 v11, 63, v0
  v_cmp_eq_u32 vcc, 0, v11
  v_mov_b32 v12, 0x7ffffff0
  s_nop 0
  v_cndmask_b32 v11, v12, 0, vcc
  v_mov_b32 v12, 64
  buffer_store_dword v12, v11, s[4:7], s40 offen sc1
pub_59:
L_kvdone:
  s_sub_u32 s54, s32, 2
  s_lshl_b32 s54, s54, 5
  s_add_u32 s54, s54, s33
L_kvdone2:
  s_cmp_lt_u32 s54, 90
  s_cselect_b32 s80, 1, 0
  s_branch L_w2
L_chain:
  s_cmp_eq_u32 s32, 1
  s_cbranch_scc1 L_role_b
  s_mov_b32 s47, s33
  s_sub_u32 s40, 0, s4
  s_and_b32 s40, s40, 0x1fffff
  s_add_u32 s49, s40, 163577856
  s_load_dwordx2 s[12:13], s[0:1], 16
  s_mov_b32 s14, 0x500000
  s_mov_b32 s15, 0x00020000
  s_load_dwordx2 s[16:17], s[0:1], 24
  s_mov_b32 s18, 0x500000
  s_mov_b32 s19, 0x00020000
  s_load_dwordx2 s[24:25], s[0:1], 40
  s_mov_b32 s26, 0x500000
  s_mov_b32 s27, 0x00020000
  s_load_dwordx2 s[28:29], s[0:1], 8
  s_mov_b32 s30, 0x2800
  s_mov_b32 s31, 0x00020000
  s_waitcnt lgkmcnt(0)
  v_mov_b32 v44, 0x00010001
  v_mov_b32 v45, 0x00010001
  v_mov_b32 v46, 0x00010001
  v_mov_b32 v47, 0x00010001
  v_lshrrev_b32 v40, 0, v0
  v_mov_b32 v41, 0x0
  v_mad_i32_i24 v41, v40, 16, v41
  s_mul_i32 s40, s33, 20480
  s_add_u32 s40, s40, 1048576
  buffer_store_dwordx4 v[44:47], v41, s[4:7], s40 offen
  s_add_u32 s40, s40, 4096
  buffer_store_dwordx4 v[44:47], v41, s[4:7], s40 offen
  s_add_u32 s40, s40, 4096
  buffer_store_dwordx4 v[44:47], v41, s[4:7], s40 offen
  s_add_u32 s40, s40, 4096
  buffer_store_dwordx4 v[44:47], v41, s[4:7], s40 offen
  s_add_u32 s40, s40, 4096
  buffer_store_dwordx4 v[44:47], v41, s[4:7], s40 offen
  v_cmp_gt_u32 vcc, 40, v0
  v_mov_b32 v40, 0x7ffffff0
  s_nop 0
  v_cndmask_b32 v48, v40, v41, vcc
  s_mul_i32 s40, s33, 640
  s_add_u32 s40, s40, 524288
  buffer_store_dwordx4 v[44:47], v48, s[4:7], s40 offen
  v_cmp_gt_u32 vcc, 16, v0
  s_nop 1
  v_cndmask_b32 v48, v40, v41, vcc
  s_lshl_b32 s40, s33, 8
  s_add_u32 s40, s40, 2097152
  buffer_store_dwordx4 v[44:47], v48, s[4:7], s40 offen
  v_cmp_gt_u32 vcc, 128, v0
  s_nop 1
  v_cndmask_b32 v48, v40, v41, vcc
  s_lshl_b32 s40, s33, 11
  s_add_u32 s40, s40, s49
  s_add_u32 s40, s40, 0x200000
  buffer_store_dwordx4 v[44:47], v48, s[4:7], s40 offen sc1
  v_and_b32 v18, 63, v0
  v_mov_b32 v20, 0x0
  v_mad_i32_i24 v20, v18, 16, v20
  s_mul_i32 s41, s47, 163840
  s_add_u32 s41, s41, 0
  s_mul_i32 s42, s34, 20480
  s_add_u32 s41, s41, s42
  s_add_u32 s42, s42, 0
  s_mov_b32 m0, s42
  s_nop 0
  buffer_load_dwordx4 v20, s[24:27], s41 offen lds
  s_add_u32 s41, s41, 1024
  s_add_u32 s42, s42, 1024
  s_mov_b32 m0, s42
  s_nop 0
  buffer_load_dwordx4 v20, s[24:27], s41 offen lds
  s_add_u32 s41, s41, 1024
  s_add_u32 s42, s42, 1024
  s_mov_b32 m0, s42
  s_nop 0
  buffer_load_dwordx4 v20, s[24:27], s41 offen lds
  s_add_u32 s41, s41, 1024
  s_add_u32 s42, s42, 1024
  s_mov_b32 m0, s42
  s_nop 0
  buffer_load_dwordx4 v20, s[24:27], s41 offen lds
  s_add_u32 s41, s41, 1024
  s_add_u32 s42, s42, 1024
  s_mov_b32 m0, s42
  s_nop 0
  buffer_load_dwordx4 v20, s[24:27], s41 offen lds
  s_add_u32 s41, s41, 1024
  s_add_u32 s42, s42, 1024
  s_mov_b32 m0, s42
  s_nop 0
  buffer_load_dwordx4 v20, s[24:27], s41 offen lds
  s_add_u32 s41, s41, 1024
  s_add_u32 s42, s42, 1024
  s_mov_b32 m0, s42
  s_nop 0
  buffer_load_dwordx4 v20, s[24:27], s41 offen lds
  s_add_u32 s41, s41, 1024
  s_add_u32 s42, s42, 1024
  s_mov_b32 m0, s42
  s_nop 0
  buffer_load_dwordx4 v20, s[24:27], s41 offen lds
  s_add_u32 s41, s41, 1024
  s_add_u32 s42, s42, 1024
  s_mov_b32 m0, s42
  s_nop 0
  buffer_load_dwordx4 v20, s[24:27], s41 offen lds
  s_add_u32 s41, s41, 1024
  s_add_u32 s42, s42, 1024
  s_mov_b32 m0, s42
  s_nop 0
  buffer_load_dwordx4 v20, s[24:27], s41 offen lds
  s_add_u32 s41, s41, 1024
  s_add_u32 s42, s42, 1024
  s_mov_b32 m0, s42
  s_nop 0
  buffer_load_dwordx4 v20, s[24:27], s41 offen lds
  s_add_u32 s41, s41, 1024
  s_add_u32 s42, s42, 1024
  s_mov_b32 m0, s42
  s_nop 0
  buffer_load_dwordx4 v20, s[24:27], s41 offen lds
  s_add_u32 s41, s41, 1024
  s_add_u32 s42, s42, 1024
  s_mov_b32 m0, s42
  s_nop 0
  buffer_load_dwordx4 v20, s[24:27], s41 offen lds
  s_add_u32 s41, s41, 1024
  s_add_u32 s42, s42, 1024
  s_mov_b32 m0, s42
  s_nop 0
  buffer_load_dwordx4 v20, s[24:27], s41 offen lds
  s_add_u32 s41, s41, 1024
  s_add_u32 s42, s42, 1024
  s_mov_b32 m0, s42
  s_nop 0
  buffer_load_dwordx4 v20, s[24:27], s41 offen lds
  s_add_u32 s41, s41, 1024
  s_add_u32 s42, s42, 1024
  s_mov_b32 m0, s42
  s_nop 0
  buffer_load_dwordx4 v20, s[24:27], s41 offen lds
  s_add_u32 s41, s41, 1024
  s_add_u32 s42, s42, 1024
  s_mov_b32 m0, s42
  s_nop 0
  buffer_load_dwordx4 v20, s[24:27], s41 offen lds
  s_add_u32 s41, s41, 1024
  s_add_u32 s42, s42, 1024
  s_mov_b32 m0, s42
  s_nop 0
  buffer_load_dwordx4 v20, s[24:27], s41 offen lds
  s_add_u32 s41, s41, 1024
  s_add_u32 s42, s42, 1024
  s_mov_b32 m0, s42
  s_nop 0
  buffer_load_dwordx4 v20, s[24:27], s41 offen lds
  s_add_u32 s41, s41, 1024
  s_add_u32 s42, s42, 1024
  s_mov_b32 m0, s42
  s_nop 0
  buffer_load_dwordx4 v20, s[24:27], s41 offen lds
  s_mul_i32 s41, s47, 163840
  s_add_u32 s41, s41, 81920
  s_mul_i32 s42, s34, 20480
  s_add_u32 s41, s41, s42
  s_add_u32 s42, s42, 81920
  s_mov_b32 m0, s42
  s_nop 0
  buffer_load_dwordx4 v20, s[24:27], s41 offen lds
  s_add_u32 s41, s41, 1024
  s_add_u32 s42, s42, 1024
  s_mov_b32 m0, s42
  s_nop 0
  buffer_load_dwordx4 v20, s[24:27], s41 offen lds
  s_add_u32 s41, s41, 1024
  s_add_u32 s42, s42, 1024
  s_mov_b32 m0, s42
  s_nop 0
  buffer_load_dwordx4 v20, s[24:27], s41 offen lds
  s_add_u32 s41, s41, 1024
  s_add_u32 s42, s42, 1024
  s_mov_b32 m0, s42
  s_nop 0
  buffer_load_dwordx4 v20, s[24:27], s41 offen lds
  s_add_u32 s41, s41, 1024
  s_add_u32 s42, s42, 1024
  s_mov_b32 m0, s42
  s_nop 0
  buffer_load_dwordx4 v20, s[24:27], s41 offen lds
  s_add_u32 s41, s41, 1024
  s_add_u32 s42, s42, 1024
  s_mov_b32 m0, s42
  s_nop 0
  buffer_load_dwordx4 v20, s[24:27], s41 offen lds
  s_add_u32 s41, s41, 1024
  s_add_u32 s42, s42, 1024
  s_mov_b32 m0, s42
  s_nop 0
  buffer_load_dwordx4 v20, s[24:27], s41 offen lds
  s_add_u32 s41, s41, 1024
  s_add_u32 s42, s42, 1024
  s_mov_b32 m0, s42
  s_nop 0
  buffer_load_dwordx4 v20, s[24:27], s41 offen lds
  s_add_u32 s41, s41, 1024
  s_add_u32 s42, s42, 1024
  s_mov_b32 m0, s42
  s_nop 0
  buffer_load_dwordx4 v20, s[24:27], s41 offen lds
  s_add_u32 s41, s41, 1024
  s_add_u32 s42, s42, 1024
  s_mov_b32 m0, s42
  s_nop 0
  buffer_load_dwordx4 v20, s[24:27], s41 offen lds
  s_add_u32 s41, s41, 1024
  s_add_u32 s42, s42, 1024
  s_mov_b32 m0, s42
  s_nop 0
  buffer_load_dwordx4 v20, s[24:27], s41 offen lds
  s_add_u32 s41, s41, 1024
  s_add_u32 s42, s42, 1024
  s_mov_b32 m0, s42
  s_nop 0
  buffer_load_dwordx4 v20, s[24:27], s41 offen lds
  s_add_u32 s41, s41, 1024
  s_add_u32 s42, s42, 1024
  s_mov_b32 m0, s42
  s_nop 0
  buffer_load_dwordx4 v20, s[24:27], s41 offen lds
  s_add_u32 s41, s41, 1024
  s_add_u32 s42, s42, 1024
  s_mov_b32 m0, s42
  s_nop 0
  buffer_load_dwordx4 v20, s[24:27], s41 offen lds
  s_add_u32 s41, s41, 1024
  s_add_u32 s42, s42, 1024
  s_mov_b32 m0, s42
  s_nop 0
  buffer_load_dwordx4 v20, s[24:27], s41 offen lds
  s_add_u32 s41, s41, 1024
  s_add_u32 s42, s42, 1024
  s_mov_b32 m0, s42
  s_nop 0
  buffer_load_dwordx4 v20, s[24:27], s41 offen lds
  s_add_u32 s41, s41, 1024
  s_add_u32 s42, s42, 1024
  s_mov_b32 m0, s42
  s_nop 0
  buffer_load_dwordx4 v20, s[24:27], s41 offen lds
  s_add_u32 s41, s41, 1024
  s_add_u32 s42, s42, 1024
  s_mov_b32 m0, s42
  s_nop 0
  buffer_load_dwordx4 v20, s[24:27], s41 offen lds
  s_add_u32 s41, s41, 1024
  s_add_u32 s42, s42, 1024
  s_mov_b32 m0, s42
  s_nop 0
  buffer_load_dwordx4 v20, s[24:27], s41 offen lds
  s_add_u32 s41, s41, 1024
  s_add_u32 s42, s42, 1024
  s_mov_b32 m0, s42
  s_nop 0
  buffer_load_dwordx4 v20, s[24:27], s41 offen lds
  v_bfe_u32 v18, v0, 4, 2
  v_mov_b32 v12, 0x0
  s_mov_b32 s36, 0x2000
  v_mad_i32_i24 v12, v18, s36, v12
  v_and_b32 v18, 15, v0
  v_mov_b32 v13, 0x0
  v_mad_i32_i24 v13, v18, 16, v13
  v_bfe_u32 v19, v0, 4, 2
  v_mov_b32 v18, 0x0
  v_mad_i32_i24 v18, v19, 32, v18
  v_xor_b32 v13, v13, v18
  v_add_u32 v12, v12, v13
  v_xor_b32 v13, 128, v12
  v_bfe_u32 v18, v0, 1, 1
  v_mov_b32 v14, 0x0
  v_mad_i32_i24 v14, v18, 1, v14
  v_lshrrev_b32 v18, 6, v0
  v_mad_i32_i24 v14, v18, 4, v14
  v_bfe_u32 v18, v0, 2, 3
  v_mov_b32 v15, 0x0
  v_mad_i32_i24 v15, v18, 2, v15
  v_xor_b32 v14, v14, v15
  v_lshlrev_b32 v14, 4, v14
  v_and_b32 v18, 1, v0
  v_mov_b32 v15, 0x0
  v_mad_i32_i24 v15, v18, 8, v15
  v_bfe_u32 v18, v0, 2, 2
  s_mov_b32 s36, 0x100
  v_mad_i32_i24 v15, v18, s36, v15
  v_bfe_u32 v18, v0, 4, 2
  s_mov_b32 s36, 0x800
  v_mad_i32_i24 v15, v18, s36, v15
  v_add_u32 v14, v14, v15
  v_xor_b32 v15, 32, v14
  v_add_u32 v16, 0x10000, v14
  v_add_u32 v17, 0x10000, v15
  s_waitcnt vmcnt(20)
  s_barrier
  s_cmp_lg_u32 s34, 0
  s_cbranch_scc1 cinit_60
  v_and_b32 v28, 63, v0
  v_cmp_eq_u32 vcc, 0, v28
  v_mov_b32 v29, 0x7ffffff0
  v_mov_b32 v28, 64
  v_cndmask_b32 v28, v29, v28, vcc
  v_mov_b32 v29, 1
  buffer_atomic_add v29, v28, s[8:11], 0 offen
cinit_60:
  v_and_b32 v23, 3, v0
  v_mov_b32 v21, 0x0
  v_mad_i32_i24 v21, v23, 8, v21
  v_bfe_u32 v23, v0, 2, 1
  s_mov_b32 s36, 0x500
  v_mad_i32_i24 v21, v23, s36, v21
  v_bfe_u32 v23, v0, 3, 1
  s_mov_b32 s36, 0xa000
  v_mad_i32_i24 v21, v23, s36, v21
  v_bfe_u32 v23, v0, 4, 1
  s_mov_b32 s36, 0x5000
  v_mad_i32_i24 v21, v23, s36, v21
  v_bfe_u32 v23, v0, 5, 1
  s_mov_b32 s36, 0x1400
  v_mad_i32_i24 v21, v23, s36, v21
  v_lshrrev_b32 v23, 6, v0
  s_mov_b32 s36, 0x140
  v_mad_i32_i24 v21, v23, s36, v21
  ds_read_b64_tr_b16 a[240:241], v21 offset:0
  ds_read_b64_tr_b16 a[248:249], v21 offset:32
  ds_read_b64_tr_b16 v[112:113], v21 offset:64
  ds_read_b64_tr_b16 v[120:121], v21 offset:96
  ds_read_b64_tr_b16 v[128:129], v21 offset:128
  ds_read_b64_tr_b16 v[136:137], v21 offset:160
  ds_read_b64_tr_b16 v[144:145], v21 offset:192
  ds_read_b64_tr_b16 v[152:153], v21 offset:224
  ds_read_b64_tr_b16 v[160:161], v21 offset:256
  ds_read_b64_tr_b16 v[168:169], v21 offset:288
  v_and_b32 v23, 3, v0
  v_mov_b32 v22, 0xa00
  v_mad_i32_i24 v22, v23, 8, v22
  v_bfe_u32 v23, v0, 2, 1
  s_mov_b32 s36, 0x500
  v_mad_i32_i24 v22, v23, s36, v22
  v_bfe_u32 v23, v0, 3, 1
  s_mov_b32 s36, 0xa000
  v_mad_i32_i24 v22, v23, s36, v22
  v_bfe_u32 v23, v0, 4, 1
  s_mov_b32 s36, 0x5000
  v_mad_i32_i24 v22, v23, s36, v22
  v_bfe_u32 v23, v0, 5, 1
  s_mov_b32 s36, 0x1400
  v_mad_i32_i24 v22, v23, s36, v22
  v_lshrrev_b32 v23, 6, v0
  s_mov_b32 s36, 0x140
  v_mad_i32_i24 v22, v23, s36, v22
  ds_read_b64_tr_b16 a[242:243], v22 offset:0
  ds_read_b64_tr_b16 a[250:251], v22 offset:32
  ds_read_b64_tr_b16 v[114:115], v22 offset:64
  ds_read_b64_tr_b16 v[122:123], v22 offset:96
  ds_read_b64_tr_b16 v[130:131], v22 offset:128
  ds_read_b64_tr_b16 v[138:139], v22 offset:160
  ds_read_b64_tr_b16 v[146:147], v22 offset:192
  ds_read_b64_tr_b16 v[154:155], v22 offset:224
  ds_read_b64_tr_b16 v[162:163], v22 offset:256
  ds_read_b64_tr_b16 v[170:171], v22 offset:288
  s_waitcnt lgkmcnt(0)
  v_and_b32 v23, 3, v0
  v_mov_b32 v21, 0x2800
  v_mad_i32_i24 v21, v23, 8, v21
  v_bfe_u32 v23, v0, 2, 1
  s_mov_b32 s36, 0x500
  v_mad_i32_i24 v21, v23, s36, v21
  v_bfe_u32 v23, v0, 3, 1
  s_mov_b32 s36, 0xa000
  v_mad_i32_i24 v21, v23, s36, v21
  v_bfe_u32 v23, v0, 4, 1
  s_mov_b32 s36, 0x5000
  v_mad_i32_i24 v21, v23, s36, v21
  v_bfe_u32 v23, v0, 5, 1
  s_mov_b32 s36, 0x1400
  v_mad_i32_i24 v21, v23, s36, v21
  v_lshrrev_b32 v23, 6, v0
  s_mov_b32 s36, 0x140
  v_mad_i32_i24 v21, v23, s36, v21
  ds_read_b64_tr_b16 a[244:245], v21 offset:0
  ds_read_b64_tr_b16 a[252:253], v21 offset:32
  ds_read_b64_tr_b16 v[116:117], v21 offset:64
  ds_read_b64_tr_b16 v[124:125], v21 offset:96
  ds_read_b64_tr_b16 v[132:133], v21 offset:128
  ds_read_b64_tr_b16 v[140:141], v21 offset:160
  ds_read_b64_tr_b16 v[148:149], v21 offset:192
  ds_read_b64_tr_b16 v[156:157], v21 offset:224
  ds_read_b64_tr_b16 v[164:165], v21 offset:256
  ds_read_b64_tr_b16 v[172:173], v21 offset:288
  v_and_b32 v23, 3, v0
  v_mov_b32 v22, 0x3200
  v_mad_i32_i24 v22, v23, 8, v22
  v_bfe_u32 v23, v0, 2, 1
  s_mov_b32 s36, 0x500
  v_mad_i32_i24 v22, v23, s36, v22
  v_bfe_u32 v23, v0, 3, 1
  s_mov_b32 s36, 0xa000
  v_mad_i32_i24 v22, v23, s36, v22
  v_bfe_u32 v23, v0, 4, 1
  s_mov_b32 s36, 0x5000
  v_mad_i32_i24 v22, v23, s36, v22
  v_bfe_u32 v23, v0, 5, 1
  s_mov_b32 s36, 0x1400
  v_mad_i32_i24 v22, v23, s36, v22
  v_lshrrev_b32 v23, 6, v0
  s_mov_b32 s36, 0x140
  v_mad_i32_i24 v22, v23, s36, v22
  ds_read_b64_tr_b16 a[246:247], v22 offset:0
  ds_read_b64_tr_b16 a[254:255], v22 offset:32
  ds_read_b64_tr_b16 v[118:119], v22 offset:64
  ds_read_b64_tr_b16 v[126:127], v22 offset:96
  ds_read_b64_tr_b16 v[134:135], v22 offset:128
  ds_read_b64_tr_b16 v[142:143], v22 offset:160
  ds_read_b64_tr_b16 v[150:151], v22 offset:192
  ds_read_b64_tr_b16 v[158:159], v22 offset:224
  ds_read_b64_tr_b16 v[166:167], v22 offset:256
  ds_read_b64_tr_b16 v[174:175], v22 offset:288
  s_waitcnt lgkmcnt(0)
  s_waitcnt lgkmcnt(0)
  s_barrier
  s_lshl_b32 s41, s47, 8
  s_mul_i32 s42, s34, 262144
  s_add_u32 s41, s41, s42
  s_add_u32 s41, s41, 0
  s_lshl_b32 s42, s34, 13
  s_add_u32 s42, s42, 0
  s_mov_b32 m0, s42
  s_nop 0
  buffer_load_dwordx4 v12, s[12:15], s41 offen lds
  s_add_u32 s41, s41, 32768
  s_add_u32 s42, s42, 1024
  s_mov_b32 m0, s42
  s_nop 0
  buffer_load_dwordx4 v12, s[12:15], s41 offen lds
  s_add_u32 s41, s41, 32768
  s_add_u32 s42, s42, 1024
  s_mov_b32 m0, s42
  s_nop 0
  buffer_load_dwordx4 v13, s[12:15], s41 offen lds
  s_add_u32 s41, s41, 32768
  s_add_u32 s42, s42, 1024
  s_mov_b32 m0, s42
  s_nop 0
  buffer_load_dwordx4 v13, s[12:15], s41 offen lds
  s_add_u32 s41, s41, 32768
  s_add_u32 s42, s42, 1024
  s_mov_b32 m0, s42
  s_nop 0
  buffer_load_dwordx4 v12, s[12:15], s41 offen lds
  s_add_u32 s41, s41, 32768
  s_add_u32 s42, s42, 1024
  s_mov_b32 m0, s42
  s_nop 0
  buffer_load_dwordx4 v12, s[12:15], s41 offen lds
  s_add_u32 s41, s41, 32768
  s_add_u32 s42, s42, 1024
  s_mov_b32 m0, s42
  s_nop 0
  buffer_load_dwordx4 v13, s[12:15], s41 offen lds
  s_add_u32 s41, s41, 32768
  s_add_u32 s42, s42, 1024
  s_mov_b32 m0, s42
  s_nop 0
  buffer_load_dwordx4 v13, s[12:15], s41 offen lds
  s_lshl_b32 s41, s47, 8
  s_mul_i32 s42, s34, 262144
  s_add_u32 s41, s41, s42
  s_add_u32 s41, s41, 1048576
  s_lshl_b32 s42, s34, 13
  s_add_u32 s42, s42, 32768
  s_mov_b32 m0, s42
  s_nop 0
  buffer_load_dwordx4 v12, s[12:15], s41 offen lds
  s_add_u32 s41, s41, 32768
  s_add_u32 s42, s42, 1024
  s_mov_b32 m0, s42
  s_nop 0
  buffer_load_dwordx4 v12, s[12:15], s41 offen lds
  s_add_u32 s41, s41, 32768
  s_add_u32 s42, s42, 1024
  s_mov_b32 m0, s42
  s_nop 0
  buffer_load_dwordx4 v13, s[12:15], s41 offen lds
  s_add_u32 s41, s41, 32768
  s_add_u32 s42, s42, 1024
  s_mov_b32 m0, s42
  s_nop 0
  buffer_load_dwordx4 v13, s[12:15], s41 offen lds
  s_add_u32 s41, s41, 32768
  s_add_u32 s42, s42, 1024
  s_mov_b32 m0, s42
  s_nop 0
  buffer_load_dwordx4 v12, s[12:15], s41 offen lds
  s_add_u32 s41, s41, 32768
  s_add_u32 s42, s42, 1024
  s_mov_b32 m0, s42
  s_nop 0
  buffer_load_dwordx4 v12, s[12:15], s41 offen lds
  s_add_u32 s41, s41, 32768
  s_add_u32 s42, s42, 1024
  s_mov_b32 m0, s42
  s_nop 0
  buffer_load_dwordx4 v13, s[12:15], s41 offen lds
  s_add_u32 s41, s41, 32768
  s_add_u32 s42, s42, 1024
  s_mov_b32 m0, s42
  s_nop 0
  buffer_load_dwordx4 v13, s[12:15], s41 offen lds
  s_waitcnt vmcnt(16)
  s_barrier
  v_and_b32 v23, 3, v0
  v_mov_b32 v21, 0x14000
  v_mad_i32_i24 v21, v23, 8, v21
  v_bfe_u32 v23, v0, 2, 1
  s_mov_b32 s36, 0x500
  v_mad_i32_i24 v21, v23, s36, v21
  v_bfe_u32 v23, v0, 3, 1
  s_mov_b32 s36, 0xa000
  v_mad_i32_i24 v21, v23, s36, v21
  v_bfe_u32 v23, v0, 4, 1
  s_mov_b32 s36, 0x5000
  v_mad_i32_i24 v21, v23, s36, v21
  v_bfe_u32 v23, v0, 5, 1
  s_mov_b32 s36, 0x1400
  v_mad_i32_i24 v21, v23, s36, v21
  v_lshrrev_b32 v23, 6, v0
  s_mov_b32 s36, 0x140
  v_mad_i32_i24 v21, v23, s36, v21
  ds_read_b64_tr_b16 v[176:177], v21 offset:0
  ds_read_b64_tr_b16 v[184:185], v21 offset:32
  ds_read_b64_tr_b16 v[192:193], v21 offset:64
  ds_read_b64_tr_b16 v[200:201], v21 offset:96
  ds_read_b64_tr_b16 v[208:209], v21 offset:128
  ds_read_b64_tr_b16 v[216:217], v21 offset:160
  ds_read_b64_tr_b16 v[224:225], v21 offset:192
  ds_read_b64_tr_b16 v[232:233], v21 offset:224
  ds_read_b64_tr_b16 v[240:241], v21 offset:256
  ds_read_b64_tr_b16 v[248:249], v21 offset:288
  v_and_b32 v23, 3, v0
  v_mov_b32 v22, 0x14a00
  v_mad_i32_i24 v22, v23, 8, v22
  v_bfe_u32 v23, v0, 2, 1
  s_mov_b32 s36, 0x500
  v_mad_i32_i24 v22, v23, s36, v22
  v_bfe_u32 v23, v0, 3, 1
  s_mov_b32 s36, 0xa000
  v_mad_i32_i24 v22, v23, s36, v22
  v_bfe_u32 v23, v0, 4, 1
  s_mov_b32 s36, 0x5000
  v_mad_i32_i24 v22, v23, s36, v22
  v_bfe_u32 v23, v0, 5, 1
  s_mov_b32 s36, 0x1400
  v_mad_i32_i24 v22, v23, s36, v22
  v_lshrrev_b32 v23, 6, v0
  s_mov_b32 s36, 0x140
  v_mad_i32_i24 v22, v23, s36, v22
  ds_read_b64_tr_b16 v[178:179], v22 offset:0
  ds_read_b64_tr_b16 v[186:187], v22 offset:32
  ds_read_b64_tr_b16 v[194:195], v22 offset:64
  ds_read_b64_tr_b16 v[202:203], v22 offset:96
  ds_read_b64_tr_b16 v[210:211], v22 offset:128
  ds_read_b64_tr_b16 v[218:219], v22 offset:160
  ds_read_b64_tr_b16 v[226:227], v22 offset:192
  ds_read_b64_tr_b16 v[234:235], v22 offset:224
  ds_read_b64_tr_b16 v[242:243], v22 offset:256
  ds_read_b64_tr_b16 v[250:251], v22 offset:288
  s_waitcnt lgkmcnt(0)
  v_and_b32 v23, 3, v0
  v_mov_b32 v21, 0x16800
  v_mad_i32_i24 v21, v23, 8, v21
  v_bfe_u32 v23, v0, 2, 1
  s_mov_b32 s36, 0x500
  v_mad_i32_i24 v21, v23, s36, v21
  v_bfe_u32 v23, v0, 3, 1
  s_mov_b32 s36, 0xa000
  v_mad_i32_i24 v21, v23, s36, v21
  v_bfe_u32 v23, v0, 4, 1
  s_mov_b32 s36, 0x5000
  v_mad_i32_i24 v21, v23, s36, v21
  v_bfe_u32 v23, v0, 5, 1
  s_mov_b32 s36, 0x1400
  v_mad_i32_i24 v21, v23, s36, v21
  v_lshrrev_b32 v23, 6, v0
  s_mov_b32 s36, 0x140
  v_mad_i32_i24 v21, v23, s36, v21
  ds_read_b64_tr_b16 v[180:181], v21 offset:0
  ds_read_b64_tr_b16 v[188:189], v21 offset:32
  ds_read_b64_tr_b16 v[196:197], v21 offset:64
  ds_read_b64_tr_b16 v[204:205], v21 offset:96
  ds_read_b64_tr_b16 v[212:213], v21 offset:128
  ds_read_b64_tr_b16 v[220:221], v21 offset:160
  ds_read_b64_tr_b16 v[228:229], v21 offset:192
  ds_read_b64_tr_b16 v[236:237], v21 offset:224
  ds_read_b64_tr_b16 v[244:245], v21 offset:256
  ds_read_b64_tr_b16 v[252:253], v21 offset:288
  v_and_b32 v23, 3, v0
  v_mov_b32 v22, 0x17200
  v_mad_i32_i24 v22, v23, 8, v22
  v_bfe_u32 v23, v0, 2, 1
  s_mov_b32 s36, 0x500
  v_mad_i32_i24 v22, v23, s36, v22
  v_bfe_u32 v23, v0, 3, 1
  s_mov_b32 s36, 0xa000
  v_mad_i32_i24 v22, v23, s36, v22
  v_bfe_u32 v23, v0, 4, 1
  s_mov_b32 s36, 0x5000
  v_mad_i32_i24 v22, v23, s36, v22
  v_bfe_u32 v23, v0, 5, 1
  s_mov_b32 s36, 0x1400
  v_mad_i32_i24 v22, v23, s36, v22
  v_lshrrev_b32 v23, 6, v0
  s_mov_b32 s36, 0x140
  v_mad_i32_i24 v22, v23, s36, v22
  ds_read_b64_tr_b16 v[182:183], v22 offset:0
  ds_read_b64_tr_b16 v[190:191], v22 offset:32
  ds_read_b64_tr_b16 v[198:199], v22 offset:64
  ds_read_b64_tr_b16 v[206:207], v22 offset:96
  ds_read_b64_tr_b16 v[214:215], v22 offset:128
  ds_read_b64_tr_b16 v[222:223], v22 offset:160
  ds_read_b64_tr_b16 v[230:231], v22 offset:192
  ds_read_b64_tr_b16 v[238:239], v22 offset:224
  ds_read_b64_tr_b16 v[246:247], v22 offset:256
  ds_read_b64_tr_b16 v[254:255], v22 offset:288
  s_waitcnt lgkmcnt(0)
  s_waitcnt lgkmcnt(0)
  s_barrier
  s_lshl_b32 s41, s47, 8
  s_mul_i32 s42, s34, 262144
  s_add_u32 s41, s41, s42
  s_add_u32 s41, s41, 2097152
  s_lshl_b32 s42, s34, 13
  s_add_u32 s42, s42, 65536
  s_mov_b32 m0, s42
  s_nop 0
  buffer_load_dwordx4 v12, s[12:15], s41 offen lds
  s_add_u32 s41, s41, 32768
  s_add_u32 s42, s42, 1024
  s_mov_b32 m0, s42
  s_nop 0
  buffer_load_dwordx4 v12, s[12:15], s41 offen lds
  s_add_u32 s41, s41, 32768
  s_add_u32 s42, s42, 1024
  s_mov_b32 m0, s42
  s_nop 0
  buffer_load_dwordx4 v13, s[12:15], s41 offen lds
  s_add_u32 s41, s41, 32768
  s_add_u32 s42, s42, 1024
  s_mov_b32 m0, s42
  s_nop 0
  buffer_load_dwordx4 v13, s[12:15], s41 offen lds
  s_add_u32 s41, s41, 32768
  s_add_u32 s42, s42, 1024
  s_mov_b32 m0, s42
  s_nop 0
  buffer_load_dwordx4 v12, s[12:15], s41 offen lds
  s_add_u32 s41, s41, 32768
  s_add_u32 s42, s42, 1024
  s_mov_b32 m0, s42
  s_nop 0
  buffer_load_dwordx4 v12, s[12:15], s41 offen lds
  s_add_u32 s41, s41, 32768
  s_add_u32 s42, s42, 1024
  s_mov_b32 m0, s42
  s_nop 0
  buffer_load_dwordx4 v13, s[12:15], s41 offen lds
  s_add_u32 s41, s41, 32768
  s_add_u32 s42, s42, 1024
  s_mov_b32 m0, s42
  s_nop 0
  buffer_load_dwordx4 v13, s[12:15], s41 offen lds
  s_lshl_b32 s41, s47, 8
  s_mul_i32 s42, s34, 262144
  s_add_u32 s41, s41, s42
  s_add_u32 s41, s41, 3145728
  s_lshl_b32 s42, s34, 13
  s_add_u32 s42, s42, 98304
  s_mov_b32 m0, s42
  s_nop 0
  buffer_load_dwordx4 v12, s[12:15], s41 offen lds
  s_add_u32 s41, s41, 32768
  s_add_u32 s42, s42, 1024
  s_mov_b32 m0, s42
  s_nop 0
  buffer_load_dwordx4 v12, s[12:15], s41 offen lds
  s_add_u32 s41, s41, 32768
  s_add_u32 s42, s42, 1024
  s_mov_b32 m0, s42
  s_nop 0
  buffer_load_dwordx4 v13, s[12:15], s41 offen lds
  s_add_u32 s41, s41, 32768
  s_add_u32 s42, s42, 1024
  s_mov_b32 m0, s42
  s_nop 0
  buffer_load_dwordx4 v13, s[12:15], s41 offen lds
  s_add_u32 s41, s41, 32768
  s_add_u32 s42, s42, 1024
  s_mov_b32 m0, s42
  s_nop 0
  buffer_load_dwordx4 v12, s[12:15], s41 offen lds
  s_add_u32 s41, s41, 32768
  s_add_u32 s42, s42, 1024
  s_mov_b32 m0, s42
  s_nop 0
  buffer_load_dwordx4 v12, s[12:15], s41 offen lds
  s_add_u32 s41, s41, 32768
  s_add_u32 s42, s42, 1024
  s_mov_b32 m0, s42
  s_nop 0
  buffer_load_dwordx4 v13, s[12:15], s41 offen lds
  s_add_u32 s41, s41, 32768
  s_add_u32 s42, s42, 1024
  s_mov_b32 m0, s42
  s_nop 0
  buffer_load_dwordx4 v13, s[12:15], s41 offen lds
  s_lshl_b32 s41, s47, 8
  s_mul_i32 s42, s34, 262144
  s_add_u32 s41, s41, s42
  s_add_u32 s41, s41, 4194304
  s_lshl_b32 s42, s34, 13
  s_add_u32 s42, s42, 131072
  s_mov_b32 m0, s42
  s_nop 0
  buffer_load_dwordx4 v12, s[12:15], s41 offen lds
  s_add_u32 s41, s41, 32768
  s_add_u32 s42, s42, 1024
  s_mov_b32 m0, s42
  s_nop 0
  buffer_load_dwordx4 v12, s[12:15], s41 offen lds
  s_add_u32 s41, s41, 32768
  s_add_u32 s42, s42, 1024
  s_mov_b32 m0, s42
  s_nop 0
  buffer_load_dwordx4 v13, s[12:15], s41 offen lds
  s_add_u32 s41, s41, 32768
  s_add_u32 s42, s42, 1024
  s_mov_b32 m0, s42
  s_nop 0
  buffer_load_dwordx4 v13, s[12:15], s41 offen lds
  s_add_u32 s41, s41, 32768
  s_add_u32 s42, s42, 1024
  s_mov_b32 m0, s42
  s_nop 0
  buffer_load_dwordx4 v12, s[12:15], s41 offen lds
  s_add_u32 s41, s41, 32768
  s_add_u32 s42, s42, 1024
  s_mov_b32 m0, s42
  s_nop 0
  buffer_load_dwordx4 v12, s[12:15], s41 offen lds
  s_add_u32 s41, s41, 32768
  s_add_u32 s42, s42, 1024
  s_mov_b32 m0, s42
  s_nop 0
  buffer_load_dwordx4 v13, s[12:15], s41 offen lds
  s_add_u32 s41, s41, 32768
  s_add_u32 s42, s42, 1024
  s_mov_b32 m0, s42
  s_nop 0
  buffer_load_dwordx4 v13, s[12:15], s41 offen lds
  s_waitcnt vmcnt(32)
  s_barrier
  v_add_u32 v18, 0, v14
  v_add_u32 v19, 0, v15
  ds_read_b64_tr_b16 a[0:1], v18 offset:0
  ds_read_b64_tr_b16 a[2:3], v18 offset:1024
  ds_read_b64_tr_b16 a[4:5], v18 offset:8192
  ds_read_b64_tr_b16 a[6:7], v18 offset:9216
  ds_read_b64_tr_b16 a[80:81], v19 offset:0
  ds_read_b64_tr_b16 a[82:83], v19 offset:1024
  ds_read_b64_tr_b16 a[84:85], v19 offset:8192
  ds_read_b64_tr_b16 a[86:87], v19 offset:9216
  ds_read_b64_tr_b16 a[8:9], v18 offset:16384
  ds_read_b64_tr_b16 a[10:11], v18 offset:17408
  ds_read_b64_tr_b16 a[12:13], v18 offset:24576
  ds_read_b64_tr_b16 a[14:15], v18 offset:25600
  ds_read_b64_tr_b16 a[88:89], v19 offset:16384
  ds_read_b64_tr_b16 a[90:91], v19 offset:17408
  ds_read_b64_tr_b16 a[92:93], v19 offset:24576
  ds_read_b64_tr_b16 a[94:95], v19 offset:25600
  s_waitcnt lgkmcnt(0)
  s_barrier
  s_lshl_b32 s41, s47, 8
  s_mul_i32 s42, s34, 262144
  s_add_u32 s41, s41, s42
  s_add_u32 s41, s41, 0
  s_lshl_b32 s42, s34, 13
  s_add_u32 s42, s42, 0
  s_mov_b32 m0, s42
  s_nop 0
  buffer_load_dwordx4 v12, s[16:19], s41 offen lds
  s_add_u32 s41, s41, 32768
  s_add_u32 s42, s42, 1024
  s_mov_b32 m0, s42
  s_nop 0
  buffer_load_dwordx4 v12, s[16:19], s41 offen lds
  s_add_u32 s41, s41, 32768
  s_add_u32 s42, s42, 1024
  s_mov_b32 m0, s42
  s_nop 0
  buffer_load_dwordx4 v13, s[16:19], s41 offen lds
  s_add_u32 s41, s41, 32768
  s_add_u32 s42, s42, 1024
  s_mov_b32 m0, s42
  s_nop 0
  buffer_load_dwordx4 v13, s[16:19], s41 offen lds
  s_add_u32 s41, s41, 32768
  s_add_u32 s42, s42, 1024
  s_mov_b32 m0, s42
  s_nop 0
  buffer_load_dwordx4 v12, s[16:19], s41 offen lds
  s_add_u32 s41, s41, 32768
  s_add_u32 s42, s42, 1024
  s_mov_b32 m0, s42
  s_nop 0
  buffer_load_dwordx4 v12, s[16:19], s41 offen lds
  s_add_u32 s41, s41, 32768
  s_add_u32 s42, s42, 1024
  s_mov_b32 m0, s42
  s_nop 0
  buffer_load_dwordx4 v13, s[16:19], s41 offen lds
  s_add_u32 s41, s41, 32768
  s_add_u32 s42, s42, 1024
  s_mov_b32 m0, s42
  s_nop 0
  buffer_load_dwordx4 v13, s[16:19], s41 offen lds
  s_waitcnt vmcnt(32)
  s_barrier
  v_add_u32 v18, 32768, v14
  v_add_u32 v19, 32768, v15
  ds_read_b64_tr_b16 a[16:17], v18 offset:0
  ds_read_b64_tr_b16 a[18:19], v18 offset:1024
  ds_read_b64_tr_b16 a[20:21], v18 offset:8192
  ds_read_b64_tr_b16 a[22:23], v18 offset:9216
  ds_read_b64_tr_b16 a[96:97], v19 offset:0
  ds_read_b64_tr_b16 a[98:99], v19 offset:1024
  ds_read_b64_tr_b16 a[100:101], v19 offset:8192
  ds_read_b64_tr_b16 a[102:103], v19 offset:9216
  ds_read_b64_tr_b16 a[24:25], v18 offset:16384
  ds_read_b64_tr_b16 a[26:27], v18 offset:17408
  ds_read_b64_tr_b16 a[28:29], v18 offset:24576
  ds_read_b64_tr_b16 a[30:31], v18 offset:25600
  ds_read_b64_tr_b16 a[104:105], v19 offset:16384
  ds_read_b64_tr_b16 a[106:107], v19 offset:17408
  ds_read_b64_tr_b16 a[108:109], v19 offset:24576
  ds_read_b64_tr_b16 a[110:111], v19 offset:25600
  s_waitcnt lgkmcnt(0)
  s_barrier
  s_lshl_b32 s41, s47, 8
  s_mul_i32 s42, s34, 262144
  s_add_u32 s41, s41, s42
  s_add_u32 s41, s41, 1048576
  s_lshl_b32 s42, s34, 13
  s_add_u32 s42, s42, 32768
  s_mov_b32 m0, s42
  s_nop 0
  buffer_load_dwordx4 v12, s[16:19], s41 offen lds
  s_add_u32 s41, s41, 32768
  s_add_u32 s42, s42, 1024
  s_mov_b32 m0, s42
  s_nop 0
  buffer_load_dwordx4 v12, s[16:19], s41 offen lds
  s_add_u32 s41, s41, 32768
  s_add_u32 s42, s42, 1024
  s_mov_b32 m0, s42
  s_nop 0
  buffer_load_dwordx4 v13, s[16:19], s41 offen lds
  s_add_u32 s41, s41, 32768
  s_add_u32 s42, s42, 1024
  s_mov_b32 m0, s42
  s_nop 0
  buffer_load_dwordx4 v13, s[16:19], s41 offen lds
  s_add_u32 s41, s41, 32768
  s_add_u32 s42, s42, 1024
  s_mov_b32 m0, s42
  s_nop 0
  buffer_load_dwordx4 v12, s[16:19], s41 offen lds
  s_add_u32 s41, s41, 32768
  s_add_u32 s42, s42, 1024
  s_mov_b32 m0, s42
  s_nop 0
  buffer_load_dwordx4 v12, s[16:19], s41 offen lds
  s_add_u32 s41, s41, 32768
  s_add_u32 s42, s42, 1024
  s_mov_b32 m0, s42
  s_nop 0
  buffer_load_dwordx4 v13, s[16:19], s41 offen lds
  s_add_u32 s41, s41, 32768
  s_add_u32 s42, s42, 1024
  s_mov_b32 m0, s42
  s_nop 0
  buffer_load_dwordx4 v13, s[16:19], s41 offen lds
  s_waitcnt vmcnt(32)
  s_barrier
  v_add_u32 v18, 65536, v14
  v_add_u32 v19, 65536, v15
  ds_read_b64_tr_b16 a[32:33], v18 offset:0
  ds_read_b64_tr_b16 a[34:35], v18 offset:1024
  ds_read_b64_tr_b16 a[36:37], v18 offset:8192
  ds_read_b64_tr_b16 a[38:39], v18 offset:9216
  ds_read_b64_tr_b16 a[112:113], v19 offset:0
  ds_read_b64_tr_b16 a[114:115], v19 offset:1024
  ds_read_b64_tr_b16 a[116:117], v19 offset:8192
  ds_read_b64_tr_b16 a[118:119], v19 offset:9216
  ds_read_b64_tr_b16 a[40:41], v18 offset:16384
  ds_read_b64_tr_b16 a[42:43], v18 offset:17408
  ds_read_b64_tr_b16 a[44:45], v18 offset:24576
  ds_read_b64_tr_b16 a[46:47], v18 offset:25600
  ds_read_b64_tr_b16 a[120:121], v19 offset:16384
  ds_read_b64_tr_b16 a[122:123], v19 offset:17408
  ds_read_b64_tr_b16 a[124:125], v19 offset:24576
  ds_read_b64_tr_b16 a[126:127], v19 offset:25600
  s_waitcnt lgkmcnt(0)
  s_barrier
  s_lshl_b32 s41, s47, 8
  s_mul_i32 s42, s34, 262144
  s_add_u32 s41, s41, s42
  s_add_u32 s41, s41, 2097152
  s_lshl_b32 s42, s34, 13
  s_add_u32 s42, s42, 65536
  s_mov_b32 m0, s42
  s_nop 0
  buffer_load_dwordx4 v12, s[16:19], s41 offen lds
  s_add_u32 s41, s41, 32768
  s_add_u32 s42, s42, 1024
  s_mov_b32 m0, s42
  s_nop 0
  buffer_load_dwordx4 v12, s[16:19], s41 offen lds
  s_add_u32 s41, s41, 32768
  s_add_u32 s42, s42, 1024
  s_mov_b32 m0, s42
  s_nop 0
  buffer_load_dwordx4 v13, s[16:19], s41 offen lds
  s_add_u32 s41, s41, 32768
  s_add_u32 s42, s42, 1024
  s_mov_b32 m0, s42
  s_nop 0
  buffer_load_dwordx4 v13, s[16:19], s41 offen lds
  s_add_u32 s41, s41, 32768
  s_add_u32 s42, s42, 1024
  s_mov_b32 m0, s42
  s_nop 0
  buffer_load_dwordx4 v12, s[16:19], s41 offen lds
  s_add_u32 s41, s41, 32768
  s_add_u32 s42, s42, 1024
  s_mov_b32 m0, s42
  s_nop 0
  buffer_load_dwordx4 v12, s[16:19], s41 offen lds
  s_add_u32 s41, s41, 32768
  s_add_u32 s42, s42, 1024
  s_mov_b32 m0, s42
  s_nop 0
  buffer_load_dwordx4 v13, s[16:19], s41 offen lds
  s_add_u32 s41, s41, 32768
  s_add_u32 s42, s42, 1024
  s_mov_b32 m0, s42
  s_nop 0
  buffer_load_dwordx4 v13, s[16:19], s41 offen lds
  s_waitcnt vmcnt(32)
  s_barrier
  v_add_u32 v18, 98304, v14
  v_add_u32 v19, 98304, v15
  ds_read_b64_tr_b16 a[48:49], v18 offset:0
  ds_read_b64_tr_b16 a[50:51], v18 offset:1024
  ds_read_b64_tr_b16 a[52:53], v18 offset:8192
  ds_read_b64_tr_b16 a[54:55], v18 offset:9216
  ds_read_b64_tr_b16 a[128:129], v19 offset:0
  ds_read_b64_tr_b16 a[130:131], v19 offset:1024
  ds_read_b64_tr_b16 a[132:133], v19 offset:8192
  ds_read_b64_tr_b16 a[134:135], v19 offset:9216
  ds_read_b64_tr_b16 a[56:57], v18 offset:16384
  ds_read_b64_tr_b16 a[58:59], v18 offset:17408
  ds_read_b64_tr_b16 a[60:61], v18 offset:24576
  ds_read_b64_tr_b16 a[62:63], v18 offset:25600
  ds_read_b64_tr_b16 a[136:137], v19 offset:16384
  ds_read_b64_tr_b16 a[138:139], v19 offset:17408
  ds_read_b64_tr_b16 a[140:141], v19 offset:24576
  ds_read_b64_tr_b16 a[142:143], v19 offset:25600
  s_waitcnt lgkmcnt(0)
  s_barrier
  s_lshl_b32 s41, s47, 8
  s_mul_i32 s42, s34, 262144
  s_add_u32 s41, s41, s42
  s_add_u32 s41, s41, 3145728
  s_lshl_b32 s42, s34, 13
  s_add_u32 s42, s42, 98304
  s_mov_b32 m0, s42
  s_nop 0
  buffer_load_dwordx4 v12, s[16:19], s41 offen lds
  s_add_u32 s41, s41, 32768
  s_add_u32 s42, s42, 1024
  s_mov_b32 m0, s42
  s_nop 0
  buffer_load_dwordx4 v12, s[16:19], s41 offen lds
  s_add_u32 s41, s41, 32768
  s_add_u32 s42, s42, 1024
  s_mov_b32 m0, s42
  s_nop 0
  buffer_load_dwordx4 v13, s[16:19], s41 offen lds
  s_add_u32 s41, s41, 32768
  s_add_u32 s42, s42, 1024
  s_mov_b32 m0, s42
  s_nop 0
  buffer_load_dwordx4 v13, s[16:19], s41 offen lds
  s_add_u32 s41, s41, 32768
  s_add_u32 s42, s42, 1024
  s_mov_b32 m0, s42
  s_nop 0
  buffer_load_dwordx4 v12, s[16:19], s41 offen lds
  s_add_u32 s41, s41, 32768
  s_add_u32 s42, s42, 1024
  s_mov_b32 m0, s42
  s_nop 0
  buffer_load_dwordx4 v12, s[16:19], s41 offen lds
  s_add_u32 s41, s41, 32768
  s_add_u32 s42, s42, 1024
  s_mov_b32 m0, s42
  s_nop 0
  buffer_load_dwordx4 v13, s[16:19], s41 offen lds
  s_add_u32 s41, s41, 32768
  s_add_u32 s42, s42, 1024
  s_mov_b32 m0, s42
  s_nop 0
  buffer_load_dwordx4 v13, s[16:19], s41 offen lds
  s_waitcnt vmcnt(32)
  s_barrier
  v_add_u32 v18, 131072, v14
  v_add_u32 v19, 131072, v15
  ds_read_b64_tr_b16 a[64:65], v18 offset:0
  ds_read_b64_tr_b16 a[66:67], v18 offset:1024
  ds_read_b64_tr_b16 a[68:69], v18 offset:8192
  ds_read_b64_tr_b16 a[70:71], v18 offset:9216
  ds_read_b64_tr_b16 a[144:145], v19 offset:0
  ds_read_b64_tr_b16 a[146:147], v19 offset:1024
  ds_read_b64_tr_b16 a[148:149], v19 offset:8192
  ds_read_b64_tr_b16 a[150:151], v19 offset:9216
  ds_read_b64_tr_b16 a[72:73], v18 offset:16384
  ds_read_b64_tr_b16 a[74:75], v18 offset:17408
  ds_read_b64_tr_b16 a[76:77], v18 offset:24576
  ds_read_b64_tr_b16 a[78:79], v18 offset:25600
  ds_read_b64_tr_b16 a[152:153], v19 offset:16384
  ds_read_b64_tr_b16 a[154:155], v19 offset:17408
  ds_read_b64_tr_b16 a[156:157], v19 offset:24576
  ds_read_b64_tr_b16 a[158:159], v19 offset:25600
  s_waitcnt lgkmcnt(0)
  s_barrier
  s_lshl_b32 s41, s47, 8
  s_mul_i32 s42, s34, 262144
  s_add_u32 s41, s41, s42
  s_add_u32 s41, s41, 4194304
  s_lshl_b32 s42, s34, 13
  s_add_u32 s42, s42, 131072
  s_mov_b32 m0, s42
  s_nop 0
  buffer_load_dwordx4 v12, s[16:19], s41 offen lds
  s_add_u32 s41, s41, 32768
  s_add_u32 s42, s42, 1024
  s_mov_b32 m0, s42
  s_nop 0
  buffer_load_dwordx4 v12, s[16:19], s41 offen lds
  s_add_u32 s41, s41, 32768
  s_add_u32 s42, s42, 1024
  s_mov_b32 m0, s42
  s_nop 0
  buffer_load_dwordx4 v13, s[16:19], s41 offen lds
  s_add_u32 s41, s41, 32768
  s_add_u32 s42, s42, 1024
  s_mov_b32 m0, s42
  s_nop 0
  buffer_load_dwordx4 v13, s[16:19], s41 offen lds
  s_add_u32 s41, s41, 32768
  s_add_u32 s42, s42, 1024
  s_mov_b32 m0, s42
  s_nop 0
  buffer_load_dwordx4 v12, s[16:19], s41 offen lds
  s_add_u32 s41, s41, 32768
  s_add_u32 s42, s42, 1024
  s_mov_b32 m0, s42
  s_nop 0
  buffer_load_dwordx4 v12, s[16:19], s41 offen lds
  s_add_u32 s41, s41, 32768
  s_add_u32 s42, s42, 1024
  s_mov_b32 m0, s42
  s_nop 0
  buffer_load_dwordx4 v13, s[16:19], s41 offen lds
  s_add_u32 s41, s41, 32768
  s_add_u32 s42, s42, 1024
  s_mov_b32 m0, s42
  s_nop 0
  buffer_load_dwordx4 v13, s[16:19], s41 offen lds
  s_waitcnt vmcnt(32)
  s_barrier
  v_add_u32 v18, 0, v14
  v_add_u32 v19, 0, v15
  ds_read_b64_tr_b16 a[160:161], v18 offset:0
  ds_read_b64_tr_b16 a[162:163], v18 offset:1024
  ds_read_b64_tr_b16 a[164:165], v18 offset:8192
  ds_read_b64_tr_b16 a[166:167], v18 offset:9216
  ds_read_b64_tr_b16 v[32:33], v19 offset:0
  ds_read_b64_tr_b16 v[34:35], v19 offset:1024
  ds_read_b64_tr_b16 v[36:37], v19 offset:8192
  ds_read_b64_tr_b16 v[38:39], v19 offset:9216
  ds_read_b64_tr_b16 a[168:169], v18 offset:16384
  ds_read_b64_tr_b16 a[170:171], v18 offset:17408
  ds_read_b64_tr_b16 a[172:173], v18 offset:24576
  ds_read_b64_tr_b16 a[174:175], v18 offset:25600
  ds_read_b64_tr_b16 v[40:41], v19 offset:16384
  ds_read_b64_tr_b16 v[42:43], v19 offset:17408
  ds_read_b64_tr_b16 v[44:45], v19 offset:24576
  ds_read_b64_tr_b16 v[46:47], v19 offset:25600
  s_waitcnt lgkmcnt(0)
  s_barrier
  s_waitcnt vmcnt(24)
  s_barrier
  v_add_u32 v18, 32768, v14
  v_add_u32 v19, 32768, v15
  ds_read_b64_tr_b16 a[176:177], v18 offset:0
  ds_read_b64_tr_b16 a[178:179], v18 offset:1024
  ds_read_b64_tr_b16 a[180:181], v18 offset:8192
  ds_read_b64_tr_b16 a[182:183], v18 offset:9216
  ds_read_b64_tr_b16 v[48:49], v19 offset:0
  ds_read_b64_tr_b16 v[50:51], v19 offset:1024
  ds_read_b64_tr_b16 v[52:53], v19 offset:8192
  ds_read_b64_tr_b16 v[54:55], v19 offset:9216
  ds_read_b64_tr_b16 a[184:185], v18 offset:16384
  ds_read_b64_tr_b16 a[186:187], v18 offset:17408
  ds_read_b64_tr_b16 a[188:189], v18 offset:24576
  ds_read_b64_tr_b16 a[190:191], v18 offset:25600
  ds_read_b64_tr_b16 v[56:57], v19 offset:16384
  ds_read_b64_tr_b16 v[58:59], v19 offset:17408
  ds_read_b64_tr_b16 v[60:61], v19 offset:24576
  ds_read_b64_tr_b16 v[62:63], v19 offset:25600
  s_waitcnt lgkmcnt(0)
  s_barrier
  s_waitcnt vmcnt(16)
  s_barrier
  v_add_u32 v18, 65536, v14
  v_add_u32 v19, 65536, v15
  ds_read_b64_tr_b16 a[192:193], v18 offset:0
  ds_read_b64_tr_b16 a[194:195], v18 offset:1024
  ds_read_b64_tr_b16 a[196:197], v18 offset:8192
  ds_read_b64_tr_b16 a[198:199], v18 offset:9216
  ds_read_b64_tr_b16 v[64:65], v19 offset:0
  ds_read_b64_tr_b16 v[66:67], v19 offset:1024
  ds_read_b64_tr_b16 v[68:69], v19 offset:8192
  ds_read_b64_tr_b16 v[70:71], v19 offset:9216
  ds_read_b64_tr_b16 a[200:201], v18 offset:16384
  ds_read_b64_tr_b16 a[202:203], v18 offset:17408
  ds_read_b64_tr_b16 a[204:205], v18 offset:24576
  ds_read_b64_tr_b16 a[206:207], v18 offset:25600
  ds_read_b64_tr_b16 v[72:73], v19 offset:16384
  ds_read_b64_tr_b16 v[74:75], v19 offset:17408
  ds_read_b64_tr_b16 v[76:77], v19 offset:24576
  ds_read_b64_tr_b16 v[78:79], v19 offset:25600
  s_waitcnt lgkmcnt(0)
  s_barrier
  s_waitcnt vmcnt(8)
  s_barrier
  v_add_u32 v18, 98304, v14
  v_add_u32 v19, 98304, v15
  ds_read_b64_tr_b16 a[208:209], v18 offset:0
  ds_read_b64_tr_b16 a[210:211], v18 offset:1024
  ds_read_b64_tr_b16 a[212:213], v18 offset:8192
  ds_read_b64_tr_b16 a[214:215], v18 offset:9216
  ds_read_b64_tr_b16 v[80:81], v19 offset:0
  ds_read_b64_tr_b16 v[82:83], v19 offset:1024
  ds_read_b64_tr_b16 v[84:85], v19 offset:8192
  ds_read_b64_tr_b16 v[86:87], v19 offset:9216
  ds_read_b64_tr_b16 a[216:217], v18 offset:16384
  ds_read_b64_tr_b16 a[218:219], v18 offset:17408
  ds_read_b64_tr_b16 a[220:221], v18 offset:24576
  ds_read_b64_tr_b16 a[222:223], v18 offset:25600
  ds_read_b64_tr_b16 v[88:89], v19 offset:16384
  ds_read_b64_tr_b16 v[90:91], v19 offset:17408
  ds_read_b64_tr_b16 v[92:93], v19 offset:24576
  ds_read_b64_tr_b16 v[94:95], v19 offset:25600
  s_waitcnt lgkmcnt(0)
  s_barrier
  v_lshrrev_b32 v30, 0, v0
  v_mov_b32 v28, 0x0
  v_mad_i32_i24 v28, v30, 4, v28
  s_mov_b32 s40, 0
  buffer_load_dword v1, v28, s[28:31], s40 offen
  s_mov_b32 s40, 1280
  buffer_load_dword v2, v28, s[28:31], s40 offen
  s_mov_b32 s40, 2560
  buffer_load_dword v3, v28, s[28:31], s40 offen
  s_mov_b32 s40, 3840
  buffer_load_dword v4, v28, s[28:31], s40 offen
  s_mov_b32 s40, 5120
  buffer_load_dword v5, v28, s[28:31], s40 offen
  s_mov_b32 s40, 6400
  buffer_load_dword v6, v28, s[28:31], s40 offen
  s_mov_b32 s40, 7680
  buffer_load_dword v7, v28, s[28:31], s40 offen
  s_mov_b32 s40, 8960
  buffer_load_dword v8, v28, s[28:31], s40 offen
  v_lshrrev_b32 v30, 0, v0
  v_mov_b32 v29, 0x400
  v_mad_i32_i24 v29, v30, 4, v29
  v_cmp_gt_u32 vcc, 64, v0
  v_mov_b32 v30, 0x7ff00000
  s_nop 0
  v_cndmask_b32 v29, v30, v29, vcc
  s_mov_b32 s40, 0
  buffer_load_dword v9, v29, s[28:31], s40 offen
  s_mov_b32 s40, 1280
  buffer_load_dword v10, v29, s[28:31], s40 offen
  s_mov_b32 s40, 2560
  buffer_load_dword v11, v29, s[28:31], s40 offen
  s_mov_b32 s40, 3840
  buffer_load_dword v24, v29, s[28:31], s40 offen
  s_mov_b32 s40, 5120
  buffer_load_dword v25, v29, s[28:31], s40 offen
  s_mov_b32 s40, 6400
  buffer_load_dword v31, v29, s[28:31], s40 offen
  s_mov_b32 s40, 7680
  buffer_load_dword v12, v29, s[28:31], s40 offen
  s_mov_b32 s40, 8960
  buffer_load_dword v13, v29, s[28:31], s40 offen
  s_waitcnt vmcnt(16)
  s_barrier
  v_add_u32 v18, 131072, v14
  v_add_u32 v19, 131072, v15
  ds_read_b64_tr_b16 a[224:225], v18 offset:0
  ds_read_b64_tr_b16 a[226:227], v18 offset:1024
  ds_read_b64_tr_b16 a[228:229], v18 offset:8192
  ds_read_b64_tr_b16 a[230:231], v18 offset:9216
  ds_read_b64_tr_b16 v[96:97], v19 offset:0
  ds_read_b64_tr_b16 v[98:99], v19 offset:1024
  ds_read_b64_tr_b16 v[100:101], v19 offset:8192
  ds_read_b64_tr_b16 v[102:103], v19 offset:9216
  ds_read_b64_tr_b16 a[232:233], v18 offset:16384
  ds_read_b64_tr_b16 a[234:235], v18 offset:17408
  ds_read_b64_tr_b16 a[236:237], v18 offset:24576
  ds_read_b64_tr_b16 a[238:239], v18 offset:25600
  ds_read_b64_tr_b16 v[104:105], v19 offset:16384
  ds_read_b64_tr_b16 v[106:107], v19 offset:17408
  ds_read_b64_tr_b16 v[108:109], v19 offset:24576
  ds_read_b64_tr_b16 v[110:111], v19 offset:25600
  s_waitcnt lgkmcnt(0)
  s_barrier
  s_cmp_ge_u32 s34, 2
  s_cbranch_scc1 dma0_61
  v_mov_b32 v28, 32
poll_63:
  buffer_load_dword v29, v28, s[8:11], 0 offen sc1
  s_waitcnt vmcnt(0)
  v_cmp_gt_u32 vcc, 40, v29
  s_cbranch_vccz polled_64
  s_sleep 3
  s_add_u32 s35, s35, 1
  s_cmp_lt_u32 s35, 300000
  s_cbranch_scc1 poll_63
polled_64:
pd_62:
  s_and_b32 s41, s34, 1
  s_mul_i32 s42, s41, 4096
  s_lshl_b32 s40, s47, 7
  s_add_u32 s40, s40, s42
  s_add_u32 s40, s40, 16384
  v_mov_b32 v28, s40
poll_65:
  buffer_load_dword v29, v28, s[4:7], 0 offen sc1
  s_waitcnt vmcnt(0)
  v_cmp_gt_u32 vcc, 1, v29
  s_cbranch_vccz polled_66
  s_sleep 1
  s_add_u32 s35, s35, 1
  s_cmp_lt_u32 s35, 300000
  s_cbranch_scc1 poll_65
polled_66:
  s_lshl_b32 s40, s47, 13
  s_mul_i32 s42, s41, 16777216
  s_add_u32 s40, s40, s42
  s_add_u32 s40, s40, 33554432
  s_lshl_b32 s41, s41, 13
  s_add_u32 s41, s41, 16384
  s_mov_b32 m0, s41
  s_nop 0
  buffer_load_dwordx4 v20, s[4:7], s40 offen offset:0 sc1 lds
  buffer_load_dwordx4 v20, s[4:7], s40 offen offset:1024 sc1 lds
  buffer_load_dwordx4 v20, s[4:7], s40 offen offset:2048 sc1 lds
  buffer_load_dwordx4 v20, s[4:7], s40 offen offset:3072 sc1 lds
  s_add_u32 s40, s40, 4096
  s_add_u32 s41, s41, 4096
  s_mov_b32 m0, s41
  s_nop 0
  buffer_load_dwordx4 v20, s[4:7], s40 offen offset:0 sc1 lds
  buffer_load_dwordx4 v20, s[4:7], s40 offen offset:1024 sc1 lds
  buffer_load_dwordx4 v20, s[4:7], s40 offen offset:2048 sc1 lds
  buffer_load_dwordx4 v20, s[4:7], s40 offen offset:3072 sc1 lds
dma0_61:
  v_and_b32 v29, 63, v0
  v_mov_b32 v26, 0xc000
  v_mad_i32_i24 v26, v29, 16, v26
  v_lshrrev_b32 v29, 6, v0
  s_mov_b32 s36, 0x5000
  v_mad_i32_i24 v26, v29, s36, v26
  ds_write_b128 v26, v[32:35] offset:0
  ds_write_b128 v26, v[36:39] offset:1024
  ds_write_b128 v26, v[40:43] offset:2048
  ds_write_b128 v26, v[44:47] offset:3072
  ds_write_b128 v26, v[48:51] offset:4096
  ds_write_b128 v26, v[52:55] offset:5120
  ds_write_b128 v26, v[56:59] offset:6144
  ds_write_b128 v26, v[60:63] offset:7168
  ds_write_b128 v26, v[64:67] offset:8192
  ds_write_b128 v26, v[68:71] offset:9216
  ds_write_b128 v26, v[72:75] offset:10240
  ds_write_b128 v26, v[76:79] offset:11264
  ds_write_b128 v26, v[80:83] offset:12288
  ds_write_b128 v26, v[84:87] offset:13312
  ds_write_b128 v26, v[88:91] offset:14336
  ds_write_b128 v26, v[92:95] offset:15360
  ds_write_b128 v26, v[96:99] offset:16384
  ds_write_b128 v26, v[100:103] offset:17408
  ds_write_b128 v26, v[104:107] offset:18432
  ds_write_b128 v26, v[108:111] offset:19456
  s_waitcnt lgkmcnt(0)
  s_barrier
  s_waitcnt vmcnt(0)
  s_mov_b32 s40, 0x05040100
  s_mov_b32 s41, 0x07060302
  v_perm_b32 v32, v2, v1, s40
  v_perm_b32 v36, v2, v1, s41
  v_perm_b32 v33, v4, v3, s40
  v_perm_b32 v37, v4, v3, s41
  v_perm_b32 v34, v6, v5, s40
  v_perm_b32 v38, v6, v5, s41
  v_perm_b32 v35, v8, v7, s40
  v_perm_b32 v39, v8, v7, s41
  v_lshrrev_b32 v29, 0, v0
  v_mov_b32 v28, 0x0
  v_mad_i32_i24 v28, v29, 32, v28
  v_bfe_u32 v29, v0, 3, 1
  v_lshlrev_b32 v29, 7, v29
  v_xor_b32 v28, v28, v29
  ds_write_b128 v28, v[32:35]
  ds_write_b128 v28, v[36:39] offset:16
  v_perm_b32 v32, v10, v9, s40
  v_perm_b32 v36, v10, v9, s41
  v_perm_b32 v33, v24, v11, s40
  v_perm_b32 v37, v24, v11, s41
  v_perm_b32 v34, v31, v25, s40
  v_perm_b32 v38, v31, v25, s41
  v_perm_b32 v35, v13, v12, s40
  v_perm_b32 v39, v13, v12, s41
  v_lshrrev_b32 v29, 0, v0
  v_mov_b32 v28, 0x2000
  v_mad_i32_i24 v28, v29, 32, v28
  v_bfe_u32 v29, v0, 3, 1
  v_lshlrev_b32 v29, 7, v29
  v_xor_b32 v28, v28, v29
  v_cmp_gt_u32 vcc, 64, v0
  v_mov_b32 v29, 10752
  s_nop 0
  v_cndmask_b32 v28, v29, v28, vcc
  ds_write_b128 v28, v[32:35]
  ds_write_b128 v28, v[36:39] offset:16
  v_and_b32 v40, 8, v0
  v_cmp_eq_u32 vcc, 0, v40
  v_mov_b32 v40, 0xeeee
  v_mov_b32 v41, 0x4444
  v_cndmask_b32 v1, v40, v41, vcc
  v_mov_b32 v41, -1
  v_mov_b32 v40, 0
  v_cndmask_b32 v14, v40, v41, vcc
  v_and_b32 v40, 15, v0
  v_cmp_eq_u32 vcc, 0, v40
  v_mov_b32 v41, 0
  v_mov_b32 v22, 0x3f80
  v_cndmask_b32 v4, v41, v22, vcc
  v_cmp_eq_u32 vcc, 1, v40
  v_mov_b32 v22, 0x3f800000
  s_nop 0
  v_cndmask_b32 v4, v4, v22, vcc
  v_cmp_eq_u32 vcc, 2, v40
  v_mov_b32 v41, 0
  v_mov_b32 v22, 0x3f80
  v_cndmask_b32 v5, v41, v22, vcc
  v_cmp_eq_u32 vcc, 3, v40
  v_mov_b32 v22, 0x3f800000
  s_nop 0
  v_cndmask_b32 v5, v5, v22, vcc
  v_cmp_eq_u32 vcc, 4, v40
  v_mov_b32 v41, 0
  v_mov_b32 v22, 0x3f80
  v_cndmask_b32 v6, v41, v22, vcc
  v_cmp_eq_u32 vcc, 5, v40
  v_mov_b32 v22, 0x3f800000
  s_nop 0
  v_cndmask_b32 v6, v6, v22, vcc
  v_cmp_eq_u32 vcc, 6, v40
  v_mov_b32 v41, 0
  v_mov_b32 v22, 0x3f80
  v_cndmask_b32 v7, v41, v22, vcc
  v_cmp_eq_u32 vcc, 7, v40
  v_mov_b32 v22, 0x3f800000
  s_nop 0
  v_cndmask_b32 v7, v7, v22, vcc
  v_and_b32 v40, 1, v0
  v_mov_b32 v2, 0x0
  v_mad_i32_i24 v2, v40, 8, v2
  v_bfe_u32 v40, v0, 1, 1
  v_mad_i32_i24 v2, v40, 32, v2
  v_bfe_u32 v40, v0, 2, 1
  v_mad_i32_i24 v2, v40, 16, v2
  v_bfe_u32 v40, v0, 3, 1
  v_mad_i32_i24 v2, v40, 64, v2
  v_bfe_u32 v40, v0, 4, 2
  s_mov_b32 s36, 0x100
  v_mad_i32_i24 v2, v40, s36, v2
  v_bfe_u32 v40, v0, 4, 1
  v_mov_b32 v41, 0x0
  s_mov_b32 s36, 0x80
  v_mad_i32_i24 v41, v40, s36, v41
  v_xor_b32 v2, v2, v41
  v_xor_b32 v3, 128, v2
  v_and_b32 v40, 63, v0
  v_mov_b32 v10, 0x0
  v_mad_i32_i24 v10, v40, 16, v10
  v_and_b32 v40, 63, v0
  v_mov_b32 v109, 0x0
  s_mov_b32 s36, 0x80
  v_mad_i32_i24 v109, v40, s36, v109
  v_and_b32 v40, 63, v0
  v_cmp_gt_u32 vcc, 40, v40
  v_mov_b32 v40, 0x7ff00000
  s_nop 0
  v_cndmask_b32 v111, v40, v109, vcc
  v_and_b32 v40, 15, v0
  v_mov_b32 v8, 0x3000
  v_mad_i32_i24 v8, v40, 16, v8
  v_bfe_u32 v40, v0, 4, 1
  v_mad_i32_i24 v8, v40, 8, v8
  v_bfe_u32 v40, v0, 5, 1
  s_mov_b32 s36, 0x800
  v_mad_i32_i24 v8, v40, s36, v8
  v_lshrrev_b32 v40, 6, v0
  s_mov_b32 s36, 0x200
  v_mad_i32_i24 v8, v40, s36, v8
  v_and_b32 v40, 1, v0
  v_mov_b32 v9, 0x3000
  v_mad_i32_i24 v9, v40, 8, v9
  v_bfe_u32 v40, v0, 2, 4
  v_mad_i32_i24 v9, v40, 16, v9
  v_and_b32 v40, 15, v0
  v_mov_b32 v41, 0x0
  v_mad_i32_i24 v41, v40, 1, v41
  v_bfe_u32 v40, v0, 4, 1
  v_mad_i32_i24 v41, v40, 32, v41
  v_bfe_u32 v40, v0, 5, 1
  v_mad_i32_i24 v41, v40, 16, v41
  v_lshrrev_b32 v40, 6, v0
  s_mov_b32 s36, 0xa0
  v_mad_i32_i24 v41, v40, s36, v41
  s_mov_b32 s40, 3277
  v_mul_u32_u24 v40, s40, v41
  v_lshrrev_b32 v40, 16, v40
  v_mul_u32_u24 v20, 20, v40
  v_sub_u32 v41, v41, v20
  s_mov_b32 s40, 10240
  v_mul_u32_u24 v40, s40, v40
  v_lshl_add_u32 v11, v41, 4, v40
  v_and_b32 v40, 15, v0
  v_mov_b32 v41, 0x40
  v_mad_i32_i24 v41, v40, 1, v41
  v_bfe_u32 v40, v0, 4, 1
  v_mad_i32_i24 v41, v40, 32, v41
  v_bfe_u32 v40, v0, 5, 1
  v_mad_i32_i24 v41, v40, 16, v41
  v_lshrrev_b32 v40, 6, v0
  s_mov_b32 s36, 0xa0
  v_mad_i32_i24 v41, v40, s36, v41
  s_mov_b32 s40, 3277
  v_mul_u32_u24 v40, s40, v41
  v_lshrrev_b32 v40, 16, v40
  v_mul_u32_u24 v20, 20, v40
  v_sub_u32 v41, v41, v20
  s_mov_b32 s40, 10240
  v_mul_u32_u24 v40, s40, v40
  v_lshl_add_u32 v12, v41, 4, v40
  v_and_b32 v40, 15, v0
  v_mov_b32 v41, 0x80
  v_mad_i32_i24 v41, v40, 1, v41
  v_bfe_u32 v40, v0, 4, 1
  v_mad_i32_i24 v41, v40, 32, v41
  v_bfe_u32 v40, v0, 5, 1
  v_mad_i32_i24 v41, v40, 16, v41
  v_lshrrev_b32 v40, 6, v0
  s_mov_b32 s36, 0xa0
  v_mad_i32_i24 v41, v40, s36, v41
  s_mov_b32 s40, 3277
  v_mul_u32_u24 v40, s40, v41
  v_lshrrev_b32 v40, 16, v40
  v_mul_u32_u24 v20, 20, v40
  v_sub_u32 v41, v41, v20
  s_mov_b32 s40, 10240
  v_mul_u32_u24 v40, s40, v40
  v_lshl_add_u32 v13, v41, 4, v40
  v_bfe_u32 v40, v0, 4, 1
  v_cmp_eq_u32 vcc, 0, v40
  v_mov_b32 v40, 0x7ffffff0
  s_nop 0
  v_cndmask_b32 v13, v40, v13, vcc
  v_and_b32 v40, 15, v0
  v_mov_b32 v15, 0x0
  v_mad_i32_i24 v15, v40, 16, v15
  v_bfe_u32 v40, v0, 4, 2
  s_mov_b32 s36, 0x140
  v_mad_i32_i24 v15, v40, s36, v15
  v_and_b32 v40, 3, v0
  v_mov_b32 v41, 0x100
  v_mad_i32_i24 v41, v40, 16, v41
  v_bfe_u32 v40, v0, 2, 2
  s_mov_b32 s36, 0x500
  v_mad_i32_i24 v41, v40, s36, v41
  v_bfe_u32 v40, v0, 4, 2
  s_mov_b32 s36, 0x140
  v_mad_i32_i24 v41, v40, s36, v41
  s_bitcmp1_b32 s34, 0
  s_cselect_b64 vcc, -1, 0
  v_cndmask_b32 v15, v15, v41, vcc
  v_and_b32 v40, 7, v0
  v_mov_b32 v24, 0x0
  v_mad_i32_i24 v24, v40, 16, v24
  v_bfe_u32 v40, v0, 3, 1
  s_mov_b32 s36, 0x200
  v_mad_i32_i24 v24, v40, s36, v24
  v_bfe_u32 v40, v0, 4, 2
  s_mov_b32 s36, 0x80
  v_mad_i32_i24 v24, v40, s36, v24
  v_and_b32 v40, 15, v0
  v_mov_b32 v16, 0x0
  v_mad_i32_i24 v16, v40, 16, v16
  v_bfe_u32 v40, v0, 6, 1
  s_mov_b32 s36, 0x100
  v_mad_i32_i24 v16, v40, s36, v16
  v_and_b32 v40, 48, v0
  v_and_b32 v41, 12, v0
  s_cmp_eq_u32 s34, 1
  s_cselect_b32 s40, -1, 0
  v_and_b32 v41, s40, v41
  v_or_b32 v40, v40, v41
  v_cmp_eq_u32 vcc, 0, v40
  v_mov_b32 v40, 0x7ffffff0
  s_nop 0
  v_cndmask_b32 v16, v40, v16, vcc
  v_and_b32 v40, 63, v0
  v_mov_b32 v25, 0x20000
  v_mad_i32_i24 v25, v40, 16, v25
  v_bfe_u32 v40, v0, 6, 1
  s_mov_b32 s36, 0x800
  v_mad_i32_i24 v25, v40, s36, v25
  v_and_b32 v40, 31, v0
  v_mov_b32 v110, 0x20000
  v_mad_i32_i24 v110, v40, 16, v110
  v_bfe_u32 v40, v0, 6, 1
  s_mov_b32 s36, 0x800
  v_mad_i32_i24 v110, v40, s36, v110
  v_and_b32 v40, 3, v0
  v_mov_b32 v41, 0x20800
  v_mad_i32_i24 v41, v40, 16, v41
  v_bfe_u32 v40, v0, 4, 1
  s_mov_b32 s36, 0x100
  v_mad_i32_i24 v41, v40, s36, v41
  s_bitcmp1_b32 s34, 0
  s_cselect_b64 vcc, -1, 0
  v_cndmask_b32 v110, v110, v41, vcc
  s_mul_i32 s40, s34, 192
  s_sub_u32 s41, s40, 64
  s_cmp_eq_u32 s34, 3
  s_cselect_b32 s40, s41, s40
  v_and_b32 v17, 63, v0
  v_add_u32 v17, s40, v17
  v_lshlrev_b32 v17, 4, v17
  v_mov_b32 v18, v17
  v_lshrrev_b32 v40, 1, v18
  v_and_b32 v40, 128, v40
  v_xor_b32 v18, v18, v40
  s_mul_i32 s40, s33, 320
  s_add_u32 s51, s40, 1048576
  s_mul_i32 s40, s33, 10240
  s_add_u32 s52, s40, 1048576
  s_cmp_lg_u32 s34, 0
  s_cbranch_scc1 pd_67
  v_mov_b32 v40, 64
poll_68:
  buffer_load_dword v41, v40, s[8:11], 0 offen sc1
  s_waitcnt vmcnt(0)
  v_cmp_gt_u32 vcc, 64, v41
  s_cbranch_vccz polled_69
  s_sleep 3
  s_add_u32 s35, s35, 1
  s_cmp_lt_u32 s35, 300000
  s_cbranch_scc1 poll_68
polled_69:
pd_67:
  s_barrier
  v_mov_b32 v40, 192
poll_71:
  buffer_load_dword v41, v40, s[8:11], 0 offen sc1
  s_waitcnt vmcnt(0)
  v_cmp_gt_u32 vcc, 1, v41
  s_cbranch_vccz polled_72
  s_sleep 3
  s_add_u32 s35, s35, 1
  s_cmp_lt_u32 s35, 300000
  s_cbranch_scc1 poll_71
polled_72:
pd_70:
  v_readfirstlane_b32 s40, v41
  s_nop 1
  s_sub_u32 s40, s40, 1
  s_and_b32 s40, s40, 1
  s_lshl_b32 s50, s40, 13
  s_add_u32 s54, s49, s50
  s_lshl_b32 s40, s33, 15
  s_add_u32 s54, s54, s40
  s_xor_b32 s40, s50, 8192
  s_add_u32 s55, s49, s40
  s_add_u32 s55, s55, 0x200000
  s_lshr_b32 s40, s33, 4
  s_lshl_b32 s40, s40, 14
  s_add_u32 s55, s55, s40
  s_and_b32 s40, s33, 15
  s_mul_i32 s40, s40, 320
  s_add_u32 s55, s55, s40
  s_cmp_lg_u32 s34, 0
  s_cbranch_scc1 pd_73
  v_mov_b32 v40, 32
poll_74:
  buffer_load_dword v41, v40, s[8:11], 0 offen sc1
  s_waitcnt vmcnt(0)
  v_cmp_gt_u32 vcc, 40, v41
  s_cbranch_vccz polled_75
  s_sleep 3
  s_add_u32 s35, s35, 1
  s_cmp_lt_u32 s35, 300000
  s_cbranch_scc1 poll_74
polled_75:
pd_73:
  s_barrier
  s_mov_b32 s84, 0xf000f0
  s_mov_b32 s85, 0xf000f0
  s_mov_b32 s86, 0xf000f00
  s_mov_b32 s87, 0xf000f00
  s_mov_b32 s88, 0xf000f000
  s_mov_b32 s89, 0xf000f000
  s_mov_b32 s44, 0
  s_mov_b32 s48, 0
  s_mov_b32 s64, 0
  s_and_b32 s41, s34, 1
  s_mul_i32 s41, s41, 4096
  s_lshl_b32 s40, s47, 7
  s_add_u32 s40, s40, s41
  s_add_u32 s40, s40, 16384
  s_mov_b32 s67, s40
  s_lshl_b32 s40, s47, 2
  s_add_u32 s40, s40, s34
  s_lshl_b32 s40, s40, 10
  s_add_u32 s73, s40, 83886080
  s_add_u32 s40, s47, 32
  s_lshl_b32 s40, s40, 13
  s_and_b32 s41, s34, 1
  s_mul_i32 s41, s41, 16777216
  s_add_u32 s40, s40, s41
  s_add_u32 s74, s40, 33554432
  s_and_b32 s40, s34, 1
  s_lshl_b32 s40, s40, 13
  s_add_u32 s75, s40, 32768
  s_add_u32 s40, s47, 32
  s_lshl_b32 s40, s40, 13
  s_and_b32 s41, s34, 1
  s_mul_i32 s41, s41, 16777216
  s_add_u32 s40, s40, s41
  s_add_u32 s68, s40, 33554432
  v_mov_b32 v68, 0
  v_mov_b32 v69, 0
  v_mov_b32 v70, 0
  v_mov_b32 v71, 0
  v_mov_b32 v72, 0
  v_mov_b32 v73, 0
  v_mov_b32 v74, 0
  v_mov_b32 v75, 0
  v_mov_b32 v76, 0
  v_mov_b32 v77, 0
  v_mov_b32 v78, 0
  v_mov_b32 v79, 0
  v_mov_b32 v80, 0
  v_mov_b32 v81, 0
  v_mov_b32 v82, 0
  v_mov_b32 v83, 0
  s_waitcnt vmcnt(0) lgkmcnt(0)
  ds_read_b128 v[84:87], v26 offset:0
  ds_read_b128 v[88:91], v26 offset:1024
  ds_read_b128 v[92:95], v26 offset:2048
  ds_read_b128 v[96:99], v26 offset:3072
  ds_read_b128 v[100:103], v26 offset:4096
  ds_read_b128 v[104:107], v26 offset:5120
  v_mov_b32 v108, 0
  s_waitcnt lgkmcnt(0)
A_step:
  s_barrier
  ds_read_b64_tr_b16 v[28:29], v2 offset:0
  ds_read_b64_tr_b16 v[30:31], v3 offset:0
  ds_read_b64_tr_b16 v[32:33], v2 offset:1024
  ds_read_b64_tr_b16 v[34:35], v3 offset:1024
  ds_read_b64_tr_b16 v[36:37], v2 offset:2048
  ds_read_b64_tr_b16 v[38:39], v3 offset:2048
  s_lshr_b32 s45, s44, 1
  s_and_b32 s45, s45, 1
  s_and_b32 s46, s44, 1
  v_mov_b32 v19, s45
  s_lshl_b32 s64, s46, 14
  s_add_u32 s64, s64, 16384
  s_cmp_lt_u32 s34, 2
  s_cbranch_scc1 side_76
  v_readfirstlane_b32 s40, v108
  s_nop 1
  s_min_u32 s40, s40, 64
  s_max_u32 s48, s48, s40
  s_add_u32 s42, s44, 2
  s_min_u32 s42, s42, 64
  s_cmp_ge_u32 s48, s42
  s_cbranch_scc1 seen_77
  v_mov_b32 v20, s67
poll_78:
  buffer_load_dword v21, v20, s[4:7], 0 offen sc1
  s_waitcnt vmcnt(0)
  v_cmp_gt_u32 vcc, s42, v21
  s_cbranch_vccz polled_79
  s_add_u32 s35, s35, 1
  s_cmp_lt_u32 s35, 300000
  s_nop 0
  s_cbranch_scc1 poll_78
polled_79:
  v_readfirstlane_b32 s48, v21
  s_nop 1
  s_min_u32 s48, s48, 64
seen_77:
  buffer_load_dword v108, v109, s[4:7], s68 offen sc1
  s_add_u32 s68, s68, 262144
  buffer_load_dword v108, off, s[4:7], s67 sc1
side_76:
  s_waitcnt lgkmcnt(4)
  v_smfmac_f32_16x16x64_bf16 v[80:83], v[28:31], v[84:91], v1
  ds_read_b64_tr_b16 v[40:41], v2 offset:3072
  v_smfmac_f32_16x16x64_bf16 v[68:71], v[28:31], a[0:7], v1
  ds_read_b64_tr_b16 v[42:43], v3 offset:3072
  v_smfmac_f32_16x16x64_bf16 v[76:79], v[28:31], a[160:167], v1
  ds_read_b128 v[84:87], v26 offset:6144
  v_smfmac_f32_16x16x64_bf16 v[72:75], v[28:31], a[80:87], v1
  ds_read_b128 v[88:91], v26 offset:7168
  s_waitcnt lgkmcnt(6)
  v_smfmac_f32_16x16x64_bf16 v[80:83], v[32:35], v[92:99], v1
  ds_read_b64_tr_b16 v[44:45], v2 offset:4096
  v_smfmac_f32_16x16x64_bf16 v[68:71], v[32:35], a[8:15], v1
  ds_read_b64_tr_b16 v[46:47], v3 offset:4096
  v_smfmac_f32_16x16x64_bf16 v[76:79], v[32:35], a[168:175], v1
  ds_read_b128 v[92:95], v26 offset:8192
  v_smfmac_f32_16x16x64_bf16 v[72:75], v[32:35], a[88:95], v1
  ds_read_b128 v[96:99], v26 offset:9216
  s_waitcnt lgkmcnt(8)
  v_smfmac_f32_16x16x64_bf16 v[80:83], v[36:39], v[100:107], v1
  ds_read_b64_tr_b16 v[48:49], v2 offset:5120
  v_smfmac_f32_16x16x64_bf16 v[68:71], v[36:39], a[16:23], v1
  ds_read_b64_tr_b16 v[50:51], v3 offset:5120
  v_smfmac_f32_16x16x64_bf16 v[76:79], v[36:39], a[176:183], v1
  ds_read_b128 v[100:103], v26 offset:10240
  v_smfmac_f32_16x16x64_bf16 v[72:75], v[36:39], a[96:103], v1
  ds_read_b128 v[104:107], v26 offset:11264
  s_waitcnt lgkmcnt(8)
  v_smfmac_f32_16x16x64_bf16 v[80:83], v[40:43], v[84:91], v1
  ds_read_b64_tr_b16 v[52:53], v2 offset:6144
  v_smfmac_f32_16x16x64_bf16 v[68:71], v[40:43], a[24:31], v1
  ds_read_b64_tr_b16 v[54:55], v3 offset:6144
  v_smfmac_f32_16x16x64_bf16 v[76:79], v[40:43], a[184:191], v1
  ds_read_b128 v[84:87], v26 offset:12288
  v_smfmac_f32_16x16x64_bf16 v[72:75], v[40:43], a[104:111], v1
  ds_read_b128 v[88:91], v26 offset:13312
  s_waitcnt lgkmcnt(8)
  v_smfmac_f32_16x16x64_bf16 v[80:83], v[44:47], v[92:99], v1
  ds_read_b64_tr_b16 v[56:57], v2 offset:7168
  v_smfmac_f32_16x16x64_bf16 v[68:71], v[44:47], a[32:39], v1
  ds_read_b64_tr_b16 v[58:59], v3 offset:7168
  v_smfmac_f32_16x16x64_bf16 v[76:79], v[44:47], a[192:199], v1
  ds_read_b128 v[92:95], v26 offset:14336
  v_smfmac_f32_16x16x64_bf16 v[72:75], v[44:47], a[112:119], v1
  ds_read_b128 v[96:99], v26 offset:15360
  s_waitcnt lgkmcnt(8)
  v_smfmac_f32_16x16x64_bf16 v[80:83], v[48:51], v[100:107], v1
  ds_read_b64_tr_b16 v[60:61], v2 offset:8192
  v_smfmac_f32_16x16x64_bf16 v[68:71], v[48:51], a[40:47], v1
  ds_read_b64_tr_b16 v[62:63], v3 offset:8192
  v_smfmac_f32_16x16x64_bf16 v[76:79], v[48:51], a[200:207], v1
  ds_read_b128 v[100:103], v26 offset:16384
  v_smfmac_f32_16x16x64_bf16 v[72:75], v[48:51], a[120:127], v1
  ds_read_b128 v[104:107], v26 offset:17408
  s_waitcnt lgkmcnt(8)
  v_smfmac_f32_16x16x64_bf16 v[80:83], v[52:55], v[84:91], v1
  ds_read_b64_tr_b16 v[64:65], v2 offset:9216
  v_smfmac_f32_16x16x64_bf16 v[68:71], v[52:55], a[48:55], v1
  ds_read_b64_tr_b16 v[66:67], v3 offset:9216
  v_smfmac_f32_16x16x64_bf16 v[76:79], v[52:55], a[208:215], v1
  ds_read_b128 v[84:87], v26 offset:18432
  v_smfmac_f32_16x16x64_bf16 v[72:75], v[52:55], a[128:135], v1
  ds_read_b128 v[88:91], v26 offset:19456
  v_add_u32 v23, s64, v10
  s_waitcnt lgkmcnt(8)
  v_smfmac_f32_16x16x64_bf16 v[80:83], v[56:59], v[92:99], v1
  v_smfmac_f32_16x16x64_bf16 v[68:71], v[56:59], a[56:63], v1
  v_smfmac_f32_16x16x64_bf16 v[76:79], v[56:59], a[216:223], v1
  v_smfmac_f32_16x16x64_bf16 v[72:75], v[56:59], a[136:143], v1
  s_waitcnt lgkmcnt(4)
  v_smfmac_f32_16x16x64_bf16 v[80:83], v[60:63], v[100:107], v1
  ds_read_b128 v[28:31], v23 offset:0
  v_smfmac_f32_16x16x64_bf16 v[68:71], v[60:63], a[64:71], v1
  ds_read_b128 v[32:35], v23 offset:1024
  v_smfmac_f32_16x16x64_bf16 v[76:79], v[60:63], a[224:231], v1
  ds_read_b128 v[36:39], v23 offset:2048
  v_smfmac_f32_16x16x64_bf16 v[72:75], v[60:63], a[144:151], v1
  ds_read_b128 v[40:43], v23 offset:3072
  s_waitcnt lgkmcnt(4)
  v_smfmac_f32_16x16x64_bf16 v[68:71], v[64:67], a[72:79], v1
  ds_read_b128 v[44:47], v23 offset:4096
  v_smfmac_f32_16x16x64_bf16 v[76:79], v[64:67], a[232:239], v1
  ds_read_b128 v[48:51], v23 offset:5120
  v_smfmac_f32_16x16x64_bf16 v[80:83], v[64:67], v[84:91], v1
  ds_read_b128 v[52:55], v23 offset:6144
  v_smfmac_f32_16x16x64_bf16 v[72:75], v[64:67], a[152:159], v1
  ds_read_b128 v[56:59], v23 offset:7168
  v_permlane32_swap_b32 v68, v76
  v_permlane32_swap_b32 v69, v77
  v_permlane32_swap_b32 v70, v78
  v_permlane32_swap_b32 v71, v79
  v_pk_add_f32 v[68:69], v[68:69], v[76:77]
  v_pk_add_f32 v[70:71], v[70:71], v[78:79]
  v_cvt_pk_bf16_f32 v20, v68, v69
  v_cvt_pk_bf16_f32 v21, v70, v71
  ds_write_b64 v8, v[20:21] offset:0
  v_permlane32_swap_b32 v72, v80
  v_permlane32_swap_b32 v73, v81
  v_permlane32_swap_b32 v74, v82
  v_permlane32_swap_b32 v75, v83
  v_pk_add_f32 v[72:73], v[72:73], v[80:81]
  v_pk_add_f32 v[74:75], v[74:75], v[82:83]
  v_cvt_pk_bf16_f32 v20, v72, v73
  v_cvt_pk_bf16_f32 v21, v74, v75
  ds_write_b64 v8, v[20:21] offset:256
  s_waitcnt lgkmcnt(0)
  s_barrier
  ds_read_b64_tr_b16 v[76:77], v9 offset:2048
  ds_read_b64_tr_b16 v[60:61], v9 offset:0
  ds_read_b64_tr_b16 v[78:79], v9 offset:2304
  ds_read_b64_tr_b16 v[62:63], v9 offset:256
  ds_read_b64_tr_b16 v[80:81], v9 offset:2560
  ds_read_b64_tr_b16 v[64:65], v9 offset:512
  ds_read_b64_tr_b16 v[82:83], v9 offset:2816
  ds_read_b64_tr_b16 v[66:67], v9 offset:768
  ds_read_b64_tr_b16 v[84:85], v9 offset:3072
  ds_read_b64_tr_b16 v[68:69], v9 offset:1024
  ds_read_b64_tr_b16 v[86:87], v9 offset:3328
  ds_read_b64_tr_b16 v[70:71], v9 offset:1280
  ds_read_b64_tr_b16 v[88:89], v9 offset:3584
  ds_read_b64_tr_b16 v[72:73], v9 offset:1536
  ds_read_b64_tr_b16 v[90:91], v9 offset:3840
  ds_read_b64_tr_b16 v[74:75], v9 offset:1792
  s_waitcnt lgkmcnt(12)
  v_mfma_f32_16x16x32_bf16 v[92:95], v[76:79], v[60:63], 0
  v_mfma_f32_16x16x32_bf16 v[96:99], v[28:31], v[60:63], 0
  v_mfma_f32_16x16x32_bf16 v[100:103], v[44:47], v[60:63], 0
  s_waitcnt lgkmcnt(8)
  v_mfma_f32_16x16x32_bf16 v[92:95], v[80:83], v[64:67], v[92:95]
  v_mfma_f32_16x16x32_bf16 v[96:99], v[32:35], v[64:67], v[96:99]
  v_mfma_f32_16x16x32_bf16 v[100:103], v[48:51], v[64:67], v[100:103]
  s_waitcnt lgkmcnt(4)
  v_mfma_f32_16x16x32_bf16 v[92:95], v[84:87], v[68:71], v[92:95]
  v_mfma_f32_16x16x32_bf16 v[96:99], v[36:39], v[68:71], v[96:99]
  v_mfma_f32_16x16x32_bf16 v[100:103], v[52:55], v[68:71], v[100:103]
  s_waitcnt lgkmcnt(0)
  v_mfma_f32_16x16x32_bf16 v[92:95], v[88:91], v[72:75], v[92:95]
  v_mfma_f32_16x16x32_bf16 v[96:99], v[40:43], v[72:75], v[96:99]
  v_mfma_f32_16x16x32_bf16 v[100:103], v[56:59], v[72:75], v[100:103]
  s_cmp_lg_u32 s34, 0
  s_cbranch_scc1 km_81
  buffer_store_dwordx4 v[76:79], v10, s[4:7], s73 offen sc1
  s_branch kmd_80
km_81:
  s_cmp_lg_u32 s34, 1
  s_cbranch_scc1 km_82
  buffer_store_dwordx4 v[80:83], v10, s[4:7], s73 offen sc1
  s_branch kmd_80
km_82:
  s_cmp_lg_u32 s34, 2
  s_cbranch_scc1 km_83
  buffer_store_dwordx4 v[84:87], v10, s[4:7], s73 offen sc1
  s_branch kmd_80
km_83:
  buffer_store_dwordx4 v[88:91], v10, s[4:7], s73 offen sc1
km_84:
kmd_80:
  s_add_u32 s73, s73, 131072
  s_cmp_eq_u32 s44, 63
  s_cbranch_scc1 A_last
  ds_read_b128 v[28:31], v23 offset:8192
  ds_read_b128 v[32:35], v23 offset:9216
  ds_read_b128 v[36:39], v23 offset:10240
  ds_read_b128 v[40:43], v23 offset:11264
  ds_read_b128 v[44:47], v23 offset:12288
  ds_read_b128 v[48:51], v23 offset:13312
  ds_read_b128 v[52:55], v23 offset:14336
  ds_read_b128 v[56:59], v23 offset:15360
  v_max3_f32 v20, v92, v93, v94
  v_max3_f32 v21, v95, v96, v97
  v_max3_f32 v22, v98, v99, v100
  v_max3_f32 v23, v101, v102, v103
  v_max3_f32 v20, v20, v21, v22
  v_max_f32 v20, v20, v23
  s_mov_b32 s40, 0x3e0293ee
  v_mov_b32 v21, v20
  s_nop 1
  v_permlane16_swap_b32 v20, v21
  v_max_f32 v20, v20, v21
  v_mov_b32 v21, v20
  s_nop 1
  v_permlane32_swap_b32 v20, v21
  v_max_f32 v20, v20, v21
  v_mul_f32 v20, s40, v20
  s_mov_b32 s41, s40
  v_pk_fma_f32 v[92:93], v[92:93], s[40:41], v[20:21] op_sel_hi:[1,1,0] neg_lo:[0,0,1] neg_hi:[0,0,1]
  v_pk_fma_f32 v[94:95], v[94:95], s[40:41], v[20:21] op_sel_hi:[1,1,0] neg_lo:[0,0,1] neg_hi:[0,0,1]
  v_pk_fma_f32 v[96:97], v[96:97], s[40:41], v[20:21] op_sel_hi:[1,1,0] neg_lo:[0,0,1] neg_hi:[0,0,1]
  v_pk_fma_f32 v[98:99], v[98:99], s[40:41], v[20:21] op_sel_hi:[1,1,0] neg_lo:[0,0,1] neg_hi:[0,0,1]
  v_pk_fma_f32 v[100:101], v[100:101], s[40:41], v[20:21] op_sel_hi:[1,1,0] neg_lo:[0,0,1] neg_hi:[0,0,1]
  v_pk_fma_f32 v[102:103], v[102:103], s[40:41], v[20:21] op_sel_hi:[1,1,0] neg_lo:[0,0,1] neg_hi:[0,0,1]
  v_exp_f32 v92, v92
  v_exp_f32 v93, v93
  v_exp_f32 v94, v94
  v_exp_f32 v95, v95
  v_exp_f32 v96, v96
  v_exp_f32 v97, v97
  v_exp_f32 v98, v98
  v_exp_f32 v99, v99
  v_exp_f32 v100, v100
  v_exp_f32 v101, v101
  v_exp_f32 v102, v102
  v_exp_f32 v103, v103
  v_pk_add_f32 v[20:21], v[92:93], v[94:95]
  v_pk_add_f32 v[22:23], v[96:97], v[98:99]
  v_pk_mul_f32 v[20:21], v[20:21], 0.5 op_sel_hi:[1,0]
  v_cvt_pk_bf16_f32 v60, v96, v97
  v_cvt_pk_bf16_f32 v61, v98, v99
  v_cvt_pk_bf16_f32 v62, v100, v101
  v_cvt_pk_bf16_f32 v63, v102, v103
  v_pk_add_f32 v[22:23], v[22:23], v[100:101]
  v_pk_add_f32 v[20:21], v[20:21], v[102:103]
  v_and_b32 v60, v14, v60
  v_and_b32 v61, v14, v61
  v_and_b32 v62, v14, v62
  v_and_b32 v63, v14, v63
  v_pk_add_f32 v[20:21], v[20:21], v[22:23]
  v_mov_b32_dpp v64, v60 row_ror:8 row_mask:0xf bank_mask:0xf
  v_mov_b32_dpp v65, v61 row_ror:8 row_mask:0xf bank_mask:0xf
  v_mov_b32_dpp v66, v62 row_ror:8 row_mask:0xf bank_mask:0xf
  v_mov_b32_dpp v67, v63 row_ror:8 row_mask:0xf bank_mask:0xf
  v_add_f32 v20, v20, v21
  s_cmp_lt_u32 s34, 2
  s_cbranch_scc1 yt_85
  s_lshl_b32 s40, s46, 20
  s_add_u32 s40, s40, s54
  s_and_b32 s41, s34, 1
  s_lshl_b32 s41, s41, 14
  s_add_u32 s40, s40, s41
  buffer_load_dword v107, v111, s[4:7], s40 offen sc1
yt_85:
  s_waitcnt lgkmcnt(0)
  v_mfma_f32_16x16x32_bf16 v[68:71], v[28:31], v[60:63], 0
  v_mov_b64 v[28:29], 0
  v_mov_b64 v[30:31], 0
  v_mfma_f32_16x16x32_bf16 v[72:75], v[32:35], v[60:63], 0
  v_mov_b64 v[32:33], 0
  v_mov_b64 v[34:35], 0
  v_mfma_f32_16x16x32_bf16 v[76:79], v[44:47], v[60:63], 0
  v_mov_b64 v[44:45], 0
  v_mov_b64 v[46:47], 0
  v_mfma_f32_16x16x32_bf16 v[80:83], v[48:51], v[60:63], 0
  v_mov_b64 v[48:49], 0
  v_mov_b64 v[50:51], 0
  v_mov_b32 v21, v20
  v_mfma_f32_16x16x32_bf16 v[68:71], v[36:39], v[64:67], v[68:71]
  v_mov_b64 v[36:37], 0
  v_mov_b64 v[38:39], 0
  v_permlane16_swap_b32 v20, v21
  v_mfma_f32_16x16x32_bf16 v[72:75], v[40:43], v[64:67], v[72:75]
  v_mov_b64 v[40:41], 0
  v_mov_b64 v[42:43], 0
  v_add_f32 v20, v20, v21
  v_mfma_f32_16x16x32_bf16 v[76:79], v[52:55], v[64:67], v[76:79]
  v_mov_b64 v[52:53], 0
  v_mov_b64 v[54:55], 0
  v_mov_b32 v21, v20
  v_mfma_f32_16x16x32_bf16 v[80:83], v[56:59], v[64:67], v[80:83]
  v_mov_b64 v[56:57], 0
  v_mov_b64 v[58:59], 0
  v_permlane32_swap_b32 v20, v21
  v_add_f32 v20, v20, v21
  v_rcp_f32 v22, v20
  s_lshl_b32 s62, s46, 12
  s_add_u32 s62, s62, 2097152
  s_mul_i32 s60, s46, 327680
  s_add_u32 s61, s60, s52
  s_add_u32 s60, s60, s51
  s_cmp_lg_u32 s34, 0
  s_cbranch_scc1 nopm_86
  v_mul_f32 v92, v92, v22
  v_mul_f32 v93, v93, v22
  v_mul_f32 v94, v94, v22
  v_mul_f32 v95, v95, v22
  v_cvt_pk_bf16_f32 v96, v92, v93
  v_cvt_pk_bf16_f32 v97, v94, v95
  v_mov_b32 v98, v96
  v_mov_b32 v99, v97
  s_lshl_b32 s40, s47, 7
  s_add_u32 s40, s40, s62
  v_permlane16_swap_b32 v96, v98
  v_permlane16_swap_b32 v97, v99
  v_and_or_b32 v96, v96, -2, v19
  s_mov_b64 exec, 0xff
  buffer_store_dwordx4 v[96:99], v24, s[4:7], s40 offen
  s_mov_b64 exec, -1
nopm_86:
  v_mov_b64 v[60:61], 0
  v_mov_b64 v[62:63], 0
  v_mov_b64 v[64:65], 0
  v_mov_b64 v[66:67], 0
  v_pk_mul_f32 v[68:69], v[68:69], v[22:23] op_sel_hi:[1,0]
  v_pk_mul_f32 v[70:71], v[70:71], v[22:23] op_sel_hi:[1,0]
  v_pk_mul_f32 v[72:73], v[72:73], v[22:23] op_sel_hi:[1,0]
  v_pk_mul_f32 v[74:75], v[74:75], v[22:23] op_sel_hi:[1,0]
  v_pk_mul_f32 v[76:77], v[76:77], v[22:23] op_sel_hi:[1,0]
  v_pk_mul_f32 v[78:79], v[78:79], v[22:23] op_sel_hi:[1,0]
  v_pk_mul_f32 v[80:81], v[80:81], v[22:23] op_sel_hi:[1,0]
  v_pk_mul_f32 v[82:83], v[82:83], v[22:23] op_sel_hi:[1,0]
  v_cvt_pk_bf16_f32 v84, v68, v69
  v_cvt_pk_bf16_f32 v85, v70, v71
  v_cvt_pk_bf16_f32 v86, v72, v73
  v_cvt_pk_bf16_f32 v87, v74, v75
  v_cvt_pk_bf16_f32 v88, v76, v77
  v_cvt_pk_bf16_f32 v89, v78, v79
  v_cvt_pk_bf16_f32 v90, v80, v81
  v_cvt_pk_bf16_f32 v91, v82, v83
  v_smfmac_f32_16x16x64_bf16 v[28:31], v[84:87], a[240:247], v1
  s_nop 0
  v_smfmac_f32_16x16x64_bf16 v[28:31], v[88:91], v[176:183], v1
  v_smfmac_f32_16x16x64_bf16 v[32:35], v[84:87], a[248:255], v1
  v_smfmac_f32_16x16x64_bf16 v[32:35], v[88:91], v[184:191], v1
  v_smfmac_f32_16x16x64_bf16 v[36:39], v[84:87], v[112:119], v1
  v_smfmac_f32_16x16x64_bf16 v[36:39], v[88:91], v[192:199], v1
  v_smfmac_f32_16x16x64_bf16 v[40:43], v[84:87], v[120:127], v1
  v_smfmac_f32_16x16x64_bf16 v[40:43], v[88:91], v[200:207], v1
  v_permlane32_swap_b32 v28, v32
  v_permlane32_swap_b32 v29, v33
  v_permlane32_swap_b32 v30, v34
  v_permlane32_swap_b32 v31, v35
  v_pk_add_f32 v[28:29], v[28:29], v[32:33]
  v_pk_add_f32 v[30:31], v[30:31], v[34:35]
  v_smfmac_f32_16x16x64_bf16 v[44:47], v[84:87], v[128:135], v1
  v_cvt_pk_bf16_f32 v96, v28, v29
  v_smfmac_f32_16x16x64_bf16 v[44:47], v[88:91], v[208:215], v1
  v_cvt_pk_bf16_f32 v97, v30, v31
  v_smfmac_f32_16x16x64_bf16 v[48:51], v[84:87], v[136:143], v1
  v_smfmac_f32_16x16x64_bf16 v[48:51], v[88:91], v[216:223], v1
  v_permlane32_swap_b32 v36, v40
  v_permlane32_swap_b32 v37, v41
  v_permlane32_swap_b32 v38, v42
  v_permlane32_swap_b32 v39, v43
  v_pk_add_f32 v[36:37], v[36:37], v[40:41]
  v_pk_add_f32 v[38:39], v[38:39], v[42:43]
  v_smfmac_f32_16x16x64_bf16 v[52:55], v[84:87], v[144:151], v1
  v_cvt_pk_bf16_f32 v98, v36, v37
  v_smfmac_f32_16x16x64_bf16 v[52:55], v[88:91], v[224:231], v1
  v_cvt_pk_bf16_f32 v99, v38, v39
  v_smfmac_f32_16x16x64_bf16 v[56:59], v[84:87], v[152:159], v1
  s_nop 0
  v_smfmac_f32_16x16x64_bf16 v[56:59], v[88:91], v[232:239], v1
  v_permlane16_swap_b32 v96, v98
  v_permlane16_swap_b32 v97, v99
  v_and_or_b32 v96, v96, -2, v19
  buffer_store_dwordx4 v[96:99], v11, s[4:7], s60 offen
  v_permlane32_swap_b32 v44, v48
  v_permlane32_swap_b32 v45, v49
  v_permlane32_swap_b32 v46, v50
  v_permlane32_swap_b32 v47, v51
  v_pk_add_f32 v[44:45], v[44:45], v[48:49]
  v_pk_add_f32 v[46:47], v[46:47], v[50:51]
  v_smfmac_f32_16x16x64_bf16 v[60:63], v[84:87], v[160:167], v1
  v_cvt_pk_bf16_f32 v100, v44, v45
  v_smfmac_f32_16x16x64_bf16 v[60:63], v[88:91], v[240:247], v1
  v_cvt_pk_bf16_f32 v101, v46, v47
  v_smfmac_f32_16x16x64_bf16 v[64:67], v[84:87], v[168:175], v1
  v_smfmac_f32_16x16x64_bf16 v[64:67], v[88:91], v[248:255], v1
  v_permlane32_swap_b32 v52, v56
  v_permlane32_swap_b32 v53, v57
  v_permlane32_swap_b32 v54, v58
  v_permlane32_swap_b32 v55, v59
  v_pk_add_f32 v[52:53], v[52:53], v[56:57]
  v_pk_add_f32 v[54:55], v[54:55], v[58:59]
  v_cvt_pk_bf16_f32 v102, v52, v53
  v_cvt_pk_bf16_f32 v103, v54, v55
  s_nop 0
  v_permlane16_swap_b32 v100, v102
  v_permlane16_swap_b32 v101, v103
  v_and_or_b32 v100, v100, -2, v19
  buffer_store_dwordx4 v[100:103], v12, s[4:7], s60 offen
  v_permlane32_swap_b32 v60, v64
  v_permlane32_swap_b32 v61, v65
  v_permlane32_swap_b32 v62, v66
  v_permlane32_swap_b32 v63, v67
  v_pk_add_f32 v[60:61], v[60:61], v[64:65]
  v_pk_add_f32 v[62:63], v[62:63], v[66:67]
  v_cvt_pk_bf16_f32 v96, v60, v61
  v_cvt_pk_bf16_f32 v97, v62, v63
  v_mov_b32 v98, v96
  v_mov_b32 v99, v97
  s_nop 0
  v_permlane16_swap_b32 v96, v98
  v_permlane16_swap_b32 v97, v99
  v_and_or_b32 v96, v96, -2, v19
  buffer_store_dwordx4 v[96:99], v13, s[4:7], s60 offen
  s_add_u32 s44, s44, 1
  s_cmp_ge_u32 s34, 2
  s_cbranch_scc1 w23_88
  s_add_u32 s63, s61, 5120
  s_lshl_b32 s40, s46, 20
  s_add_u32 s78, s40, s54
  s_add_u32 s79, s78, 16384
  s_cmp_eq_u32 s34, 1
  s_cbranch_scc1 w1_87
  buffer_load_dwordx4 v[92:95], v24, s[4:7], s62 offen offset:0 sc1
  buffer_load_dwordx4 v[96:99], v24, s[4:7], s62 offen offset:1024 sc1
  buffer_load_dwordx4 v[100:103], v24, s[4:7], s62 offen offset:2048 sc1
  buffer_load_dwordx4 v[104:107], v24, s[4:7], s62 offen offset:3072 sc1
  buffer_load_dwordx4 v[60:63], v15, s[4:7], s78 offen offset:0 sc1
  buffer_load_dwordx4 v[64:67], v15, s[4:7], s78 offen offset:1280 sc1
  buffer_load_dwordx4 v[68:71], v15, s[4:7], s78 offen offset:2560 sc1
  buffer_load_dwordx4 v[72:75], v15, s[4:7], s78 offen offset:3840 sc1
  buffer_load_dwordx4 v[76:79], v15, s[4:7], s79 offen offset:0 sc1
  buffer_load_dwordx4 v[80:83], v15, s[4:7], s79 offen offset:1280 sc1
  buffer_load_dwordx4 v[84:87], v15, s[4:7], s79 offen offset:2560 sc1
  buffer_load_dwordx4 v[88:91], v15, s[4:7], s79 offen offset:3840 sc1
  s_mul_i32 s40, s46, 10240
  s_mul_i32 s41, s33, 320
  s_add_u32 s40, s40, s41
  s_add_u32 s76, s40, 524288
  s_lshl_b32 s43, s46, 15
  s_add_u32 s77, s43, s55
  s_sleep 3
  buffer_load_dwordx4 v[28:31], v15, s[4:7], s61 offen offset:0 sc1
  buffer_load_dwordx4 v[32:35], v15, s[4:7], s61 offen offset:1280 sc1
  buffer_load_dwordx4 v[36:39], v15, s[4:7], s61 offen offset:2560 sc1
  buffer_load_dwordx4 v[40:43], v15, s[4:7], s61 offen offset:3840 sc1
  buffer_load_dwordx4 v[44:47], v15, s[4:7], s63 offen offset:0 sc1
  buffer_load_dwordx4 v[48:51], v15, s[4:7], s63 offen offset:1280 sc1
  buffer_load_dwordx4 v[52:55], v15, s[4:7], s63 offen offset:2560 sc1
  buffer_load_dwordx4 v[56:59], v15, s[4:7], s63 offen offset:3840 sc1
  s_waitcnt vmcnt(16)
  v_xor_b32 v25, v19, v92
  v_bitop3_b32 v25, v25, v96, v19 bitop3:0xf6
  v_bitop3_b32 v25, v25, v100, v19 bitop3:0xf6
  v_bitop3_b32 v25, v25, v104, v19 bitop3:0xf6
  s_waitcnt vmcnt(15)
  v_mfma_f32_16x16x32_bf16 v[20:23], v[92:95], v[60:63], 0
  v_bitop3_b32 v25, v25, v60, v19 bitop3:0xf6
  s_waitcnt vmcnt(14)
  v_mfma_f32_16x16x32_bf16 v[108:111], v[92:95], v[64:67], 0
  v_bitop3_b32 v25, v25, v64, v19 bitop3:0xf6
  s_waitcnt vmcnt(13)
  v_mfma_f32_16x16x32_bf16 v[20:23], v[96:99], v[68:71], v[20:23]
  v_bitop3_b32 v25, v25, v68, v19 bitop3:0xf6
  s_waitcnt vmcnt(12)
  v_mfma_f32_16x16x32_bf16 v[108:111], v[96:99], v[72:75], v[108:111]
  v_bitop3_b32 v25, v25, v72, v19 bitop3:0xf6
  s_waitcnt vmcnt(11)
  v_mfma_f32_16x16x32_bf16 v[20:23], v[100:103], v[76:79], v[20:23]
  v_bitop3_b32 v25, v25, v76, v19 bitop3:0xf6
  s_waitcnt vmcnt(10)
  v_mfma_f32_16x16x32_bf16 v[108:111], v[100:103], v[80:83], v[108:111]
  v_bitop3_b32 v25, v25, v80, v19 bitop3:0xf6
  s_waitcnt vmcnt(9)
  v_mfma_f32_16x16x32_bf16 v[20:23], v[104:107], v[84:87], v[20:23]
  v_bitop3_b32 v25, v25, v84, v19 bitop3:0xf6
  s_waitcnt vmcnt(8)
  v_mfma_f32_16x16x32_bf16 v[108:111], v[104:107], v[88:91], v[108:111]
  v_bitop3_b32 v25, v25, v88, v19 bitop3:0xf6
  v_and_b32 v25, 1, v25
  v_cmp_ne_u32 vcc, 0, v25
  s_cbranch_vccz mpok_91
mpl_92:
  buffer_load_dwordx4 v[92:95], v24, s[4:7], s62 offen offset:0 sc1
  buffer_load_dwordx4 v[96:99], v24, s[4:7], s62 offen offset:1024 sc1
  buffer_load_dwordx4 v[100:103], v24, s[4:7], s62 offen offset:2048 sc1
  buffer_load_dwordx4 v[104:107], v24, s[4:7], s62 offen offset:3072 sc1
  buffer_load_dwordx4 v[60:63], v15, s[4:7], s78 offen offset:0 sc1
  buffer_load_dwordx4 v[64:67], v15, s[4:7], s78 offen offset:1280 sc1
  buffer_load_dwordx4 v[68:71], v15, s[4:7], s78 offen offset:2560 sc1
  buffer_load_dwordx4 v[72:75], v15, s[4:7], s78 offen offset:3840 sc1
  buffer_load_dwordx4 v[76:79], v15, s[4:7], s79 offen offset:0 sc1
  buffer_load_dwordx4 v[80:83], v15, s[4:7], s79 offen offset:1280 sc1
  buffer_load_dwordx4 v[84:87], v15, s[4:7], s79 offen offset:2560 sc1
  buffer_load_dwordx4 v[88:91], v15, s[4:7], s79 offen offset:3840 sc1
  s_waitcnt vmcnt(8)
  v_xor_b32 v25, v19, v92
  v_bitop3_b32 v25, v25, v96, v19 bitop3:0xf6
  v_bitop3_b32 v25, v25, v100, v19 bitop3:0xf6
  v_bitop3_b32 v25, v25, v104, v19 bitop3:0xf6
  s_waitcnt vmcnt(7)
  v_mfma_f32_16x16x32_bf16 v[20:23], v[92:95], v[60:63], 0
  v_bitop3_b32 v25, v25, v60, v19 bitop3:0xf6
  s_waitcnt vmcnt(6)
  v_mfma_f32_16x16x32_bf16 v[108:111], v[92:95], v[64:67], 0
  v_bitop3_b32 v25, v25, v64, v19 bitop3:0xf6
  s_waitcnt vmcnt(5)
  v_mfma_f32_16x16x32_bf16 v[20:23], v[96:99], v[68:71], v[20:23]
  v_bitop3_b32 v25, v25, v68, v19 bitop3:0xf6
  s_waitcnt vmcnt(4)
  v_mfma_f32_16x16x32_bf16 v[108:111], v[96:99], v[72:75], v[108:111]
  v_bitop3_b32 v25, v25, v72, v19 bitop3:0xf6
  s_waitcnt vmcnt(3)
  v_mfma_f32_16x16x32_bf16 v[20:23], v[100:103], v[76:79], v[20:23]
  v_bitop3_b32 v25, v25, v76, v19 bitop3:0xf6
  s_waitcnt vmcnt(2)
  v_mfma_f32_16x16x32_bf16 v[108:111], v[100:103], v[80:83], v[108:111]
  v_bitop3_b32 v25, v25, v80, v19 bitop3:0xf6
  s_waitcnt vmcnt(1)
  v_mfma_f32_16x16x32_bf16 v[20:23], v[104:107], v[84:87], v[20:23]
  v_bitop3_b32 v25, v25, v84, v19 bitop3:0xf6
  s_waitcnt vmcnt(0)
  v_mfma_f32_16x16x32_bf16 v[108:111], v[104:107], v[88:91], v[108:111]
  v_bitop3_b32 v25, v25, v88, v19 bitop3:0xf6
  v_and_b32 v25, 1, v25
  v_cmp_ne_u32 vcc, 0, v25
  s_cbranch_vccz mpok_91
  s_add_u32 s35, s35, 1
  s_cmp_lt_u32 s35, 300000
  s_nop 0
  s_cbranch_scc1 mpl_92
mpok_91:
  s_nop 3
  v_permlane32_swap_b32 v108, v92
  v_permlane32_swap_b32 v109, v93
  v_permlane32_swap_b32 v110, v94
  v_permlane32_swap_b32 v111, v95
  v_pk_add_f32 v[20:21], v[20:21], v[92:93]
  v_pk_add_f32 v[22:23], v[22:23], v[94:95]
  s_waitcnt vmcnt(7)
  s_nop 0
  v_mfma_f32_16x16x32_bf16 v[108:111], v[4:7], v[28:31], v[20:23]
  v_xor_b32 v25, v19, v28
  s_waitcnt vmcnt(6)
  v_mfma_f32_16x16x32_bf16 v[108:111], v[4:7], v[32:35], v[108:111]
  v_bitop3_b32 v25, v25, v32, v19 bitop3:0xf6
  s_waitcnt vmcnt(5)
  v_mfma_f32_16x16x32_bf16 v[108:111], v[4:7], v[36:39], v[108:111]
  v_bitop3_b32 v25, v25, v36, v19 bitop3:0xf6
  s_waitcnt vmcnt(4)
  v_mfma_f32_16x16x32_bf16 v[108:111], v[4:7], v[40:43], v[108:111]
  v_bitop3_b32 v25, v25, v40, v19 bitop3:0xf6
  s_waitcnt vmcnt(3)
  v_mfma_f32_16x16x32_bf16 v[108:111], v[4:7], v[44:47], v[108:111]
  v_bitop3_b32 v25, v25, v44, v19 bitop3:0xf6
  s_waitcnt vmcnt(2)
  v_mfma_f32_16x16x32_bf16 v[108:111], v[4:7], v[48:51], v[108:111]
  v_bitop3_b32 v25, v25, v48, v19 bitop3:0xf6
  s_waitcnt vmcnt(1)
  v_mfma_f32_16x16x32_bf16 v[108:111], v[4:7], v[52:55], v[108:111]
  v_bitop3_b32 v25, v25, v52, v19 bitop3:0xf6
  s_waitcnt vmcnt(0)
  v_mfma_f32_16x16x32_bf16 v[108:111], v[4:7], v[56:59], v[108:111]
  v_bitop3_b32 v25, v25, v56, v19 bitop3:0xf6
  v_and_b32 v25, 1, v25
  v_cmp_ne_u32 vcc, 0, v25
  s_cbranch_vccz mxok_93
mxl_94:
  buffer_load_dwordx4 v[28:31], v15, s[4:7], s61 offen offset:0 sc1
  buffer_load_dwordx4 v[32:35], v15, s[4:7], s61 offen offset:1280 sc1
  buffer_load_dwordx4 v[36:39], v15, s[4:7], s61 offen offset:2560 sc1
  buffer_load_dwordx4 v[40:43], v15, s[4:7], s61 offen offset:3840 sc1
  buffer_load_dwordx4 v[44:47], v15, s[4:7], s63 offen offset:0 sc1
  buffer_load_dwordx4 v[48:51], v15, s[4:7], s63 offen offset:1280 sc1
  buffer_load_dwordx4 v[52:55], v15, s[4:7], s63 offen offset:2560 sc1
  buffer_load_dwordx4 v[56:59], v15, s[4:7], s63 offen offset:3840 sc1
  s_waitcnt vmcnt(7)
  v_mfma_f32_16x16x32_bf16 v[108:111], v[4:7], v[28:31], v[20:23]
  v_xor_b32 v25, v19, v28
  s_waitcnt vmcnt(6)
  v_mfma_f32_16x16x32_bf16 v[108:111], v[4:7], v[32:35], v[108:111]
  v_bitop3_b32 v25, v25, v32, v19 bitop3:0xf6
  s_waitcnt vmcnt(5)
  v_mfma_f32_16x16x32_bf16 v[108:111], v[4:7], v[36:39], v[108:111]
  v_bitop3_b32 v25, v25, v36, v19 bitop3:0xf6
  s_waitcnt vmcnt(4)
  v_mfma_f32_16x16x32_bf16 v[108:111], v[4:7], v[40:43], v[108:111]
  v_bitop3_b32 v25, v25, v40, v19 bitop3:0xf6
  s_waitcnt vmcnt(3)
  v_mfma_f32_16x16x32_bf16 v[108:111], v[4:7], v[44:47], v[108:111]
  v_bitop3_b32 v25, v25, v44, v19 bitop3:0xf6
  s_waitcnt vmcnt(2)
  v_mfma_f32_16x16x32_bf16 v[108:111], v[4:7], v[48:51], v[108:111]
  v_bitop3_b32 v25, v25, v48, v19 bitop3:0xf6
  s_waitcnt vmcnt(1)
  v_mfma_f32_16x16x32_bf16 v[108:111], v[4:7], v[52:55], v[108:111]
  v_bitop3_b32 v25, v25, v52, v19 bitop3:0xf6
  s_waitcnt vmcnt(0)
  v_mfma_f32_16x16x32_bf16 v[108:111], v[4:7], v[56:59], v[108:111]
  v_bitop3_b32 v25, v25, v56, v19 bitop3:0xf6
  v_and_b32 v25, 1, v25
  v_cmp_ne_u32 vcc, 0, v25
  s_cbranch_vccz mxok_93
  s_add_u32 s35, s35, 1
  s_cmp_lt_u32 s35, 300000
  s_nop 0
  s_cbranch_scc1 mxl_94
mxok_93:
  s_branch pub_90
w1_87:
  buffer_load_dwordx4 v[92:95], v24, s[4:7], s62 offen offset:0 sc1
  buffer_load_dwordx4 v[96:99], v24, s[4:7], s62 offen offset:1024 sc1
  buffer_load_dwordx4 v[100:103], v24, s[4:7], s62 offen offset:2048 sc1
  buffer_load_dwordx4 v[104:107], v24, s[4:7], s62 offen offset:3072 sc1
  buffer_load_dwordx4 v[60:63], v15, s[4:7], s78 offen sc1
  buffer_load_dwordx4 v[64:67], v15, s[4:7], s79 offen sc1
  s_mul_i32 s40, s46, 10240
  s_mul_i32 s41, s33, 320
  s_add_u32 s40, s40, s41
  s_add_u32 s76, s40, 524288
  s_lshl_b32 s43, s46, 15
  s_add_u32 s77, s43, s55
  s_sleep 3
  buffer_load_dwordx4 v[28:31], v15, s[4:7], s61 offen sc1
  buffer_load_dwordx4 v[32:35], v15, s[4:7], s63 offen sc1
  s_waitcnt vmcnt(4)
  v_xor_b32 v25, v19, v92
  v_bitop3_b32 v25, v25, v96, v19 bitop3:0xf6
  v_bitop3_b32 v25, v25, v100, v19 bitop3:0xf6
  v_bitop3_b32 v25, v25, v104, v19 bitop3:0xf6
  s_waitcnt vmcnt(3)
  v_mfma_f32_16x16x32_bf16 v[68:71], v[92:95], v[60:63], 0
  v_mfma_f32_16x16x32_bf16 v[72:75], v[92:95], v[60:63], 0
  v_mfma_f32_16x16x32_bf16 v[76:79], v[96:99], v[60:63], 0
  v_mfma_f32_16x16x32_bf16 v[80:83], v[96:99], v[60:63], 0
  v_bitop3_b32 v25, v25, v60, v19 bitop3:0xf6
  s_waitcnt vmcnt(2)
  v_mfma_f32_16x16x32_bf16 v[68:71], v[100:103], v[64:67], v[68:71]
  v_mfma_f32_16x16x32_bf16 v[72:75], v[100:103], v[64:67], v[72:75]
  v_mfma_f32_16x16x32_bf16 v[76:79], v[104:107], v[64:67], v[76:79]
  v_mfma_f32_16x16x32_bf16 v[80:83], v[104:107], v[64:67], v[80:83]
  v_bitop3_b32 v25, v25, v64, v19 bitop3:0xf6
  v_and_b32 v25, 1, v25
  v_cmp_ne_u32 vcc, 0, v25
  s_cbranch_vccz epok_95
epl_96:
  buffer_load_dwordx4 v[92:95], v24, s[4:7], s62 offen offset:0 sc1
  buffer_load_dwordx4 v[96:99], v24, s[4:7], s62 offen offset:1024 sc1
  buffer_load_dwordx4 v[100:103], v24, s[4:7], s62 offen offset:2048 sc1
  buffer_load_dwordx4 v[104:107], v24, s[4:7], s62 offen offset:3072 sc1
  buffer_load_dwordx4 v[60:63], v15, s[4:7], s78 offen sc1
  buffer_load_dwordx4 v[64:67], v15, s[4:7], s79 offen sc1
  s_waitcnt vmcnt(2)
  v_xor_b32 v25, v19, v92
  v_bitop3_b32 v25, v25, v96, v19 bitop3:0xf6
  v_bitop3_b32 v25, v25, v100, v19 bitop3:0xf6
  v_bitop3_b32 v25, v25, v104, v19 bitop3:0xf6
  s_waitcnt vmcnt(1)
  v_mfma_f32_16x16x32_bf16 v[68:71], v[92:95], v[60:63], 0
  v_mfma_f32_16x16x32_bf16 v[72:75], v[92:95], v[60:63], 0
  v_mfma_f32_16x16x32_bf16 v[76:79], v[96:99], v[60:63], 0
  v_mfma_f32_16x16x32_bf16 v[80:83], v[96:99], v[60:63], 0
  v_bitop3_b32 v25, v25, v60, v19 bitop3:0xf6
  s_waitcnt vmcnt(0)
  v_mfma_f32_16x16x32_bf16 v[68:71], v[100:103], v[64:67], v[68:71]
  v_mfma_f32_16x16x32_bf16 v[72:75], v[100:103], v[64:67], v[72:75]
  v_mfma_f32_16x16x32_bf16 v[76:79], v[104:107], v[64:67], v[76:79]
  v_mfma_f32_16x16x32_bf16 v[80:83], v[104:107], v[64:67], v[80:83]
  v_bitop3_b32 v25, v25, v64, v19 bitop3:0xf6
  v_and_b32 v25, 1, v25
  v_cmp_ne_u32 vcc, 0, v25
  s_cbranch_vccz epok_95
  s_add_u32 s35, s35, 1
  s_cmp_lt_u32 s35, 300000
  s_nop 0
  s_cbranch_scc1 epl_96
epok_95:
  v_permlane32_swap_b32 v72, v92
  v_permlane32_swap_b32 v73, v93
  v_permlane32_swap_b32 v74, v94
  v_permlane32_swap_b32 v75, v95
  v_permlane32_swap_b32 v80, v96
  v_permlane32_swap_b32 v81, v97
  v_permlane32_swap_b32 v82, v98
  v_permlane32_swap_b32 v83, v99
  v_cndmask_b32 v20, v68, v92, s[84:85]
  v_cndmask_b32 v21, v69, v93, s[84:85]
  v_cndmask_b32 v22, v70, v94, s[84:85]
  v_cndmask_b32 v23, v71, v95, s[84:85]
  v_cndmask_b32 v20, v20, v76, s[86:87]
  v_cndmask_b32 v21, v21, v77, s[86:87]
  v_cndmask_b32 v22, v22, v78, s[86:87]
  v_cndmask_b32 v23, v23, v79, s[86:87]
  v_cndmask_b32 v20, v20, v96, s[88:89]
  v_cndmask_b32 v21, v21, v97, s[88:89]
  v_cndmask_b32 v22, v22, v98, s[88:89]
  v_cndmask_b32 v23, v23, v99, s[88:89]
  s_waitcnt vmcnt(1)
  s_nop 0
  v_mfma_f32_16x16x32_bf16 v[108:111], v[4:7], v[28:31], v[20:23]
  v_xor_b32 v25, v19, v28
  s_waitcnt vmcnt(0)
  v_mfma_f32_16x16x32_bf16 v[108:111], v[4:7], v[32:35], v[108:111]
  v_bitop3_b32 v25, v25, v32, v19 bitop3:0xf6
  v_and_b32 v25, 1, v25
  v_cmp_ne_u32 vcc, 0, v25
  s_cbranch_vccz exok_97
exl_98:
  buffer_load_dwordx4 v[28:31], v15, s[4:7], s61 offen sc1
  buffer_load_dwordx4 v[32:35], v15, s[4:7], s63 offen sc1
  s_waitcnt vmcnt(1)
  s_nop 0
  v_mfma_f32_16x16x32_bf16 v[108:111], v[4:7], v[28:31], v[20:23]
  v_xor_b32 v25, v19, v28
  s_waitcnt vmcnt(0)
  v_mfma_f32_16x16x32_bf16 v[108:111], v[4:7], v[32:35], v[108:111]
  v_bitop3_b32 v25, v25, v32, v19 bitop3:0xf6
  v_and_b32 v25, 1, v25
  v_cmp_ne_u32 vcc, 0, v25
  s_cbranch_vccz exok_97
  s_add_u32 s35, s35, 1
  s_cmp_lt_u32 s35, 300000
  s_nop 0
  s_cbranch_scc1 exl_98
exok_97:
  s_nop 3
  v_add_f32_dpp v108, v108, v108 row_ror:4 row_mask:0xf bank_mask:0xf
  v_add_f32_dpp v109, v109, v109 row_ror:4 row_mask:0xf bank_mask:0xf
  v_add_f32_dpp v110, v110, v110 row_ror:4 row_mask:0xf bank_mask:0xf
  v_add_f32_dpp v111, v111, v111 row_ror:4 row_mask:0xf bank_mask:0xf
  v_add_f32_dpp v108, v108, v108 row_ror:8 row_mask:0xf bank_mask:0xf
  v_add_f32_dpp v109, v109, v109 row_ror:8 row_mask:0xf bank_mask:0xf
  v_add_f32_dpp v110, v110, v110 row_ror:8 row_mask:0xf bank_mask:0xf
  v_add_f32_dpp v111, v111, v111 row_ror:8 row_mask:0xf bank_mask:0xf
pub_90:
  s_nop 2
  v_cvt_pk_bf16_f32 v92, v108, v109
  v_cvt_pk_bf16_f32 v93, v110, v111
  v_mov_b32 v94, v92
  v_mov_b32 v95, v93
  s_nop 0
  v_permlane16_swap_b32 v92, v94
  v_permlane16_swap_b32 v93, v95
  v_and_or_b32 v92, v92, -2, v19
  buffer_store_dwordx4 v[92:95], v16, s[4:7], s76 offen
  buffer_store_dwordx4 v[92:95], v16, s[4:7], s77 offen sc1
  s_branch fin_89
w23_88:
  s_add_u32 s42, s44, 1
  s_min_u32 s42, s42, 64
  s_cmp_ge_u32 s48, s42
  s_cbranch_scc1 seen_99
  v_mov_b32 v20, s67
poll_100:
  buffer_load_dword v21, v20, s[4:7], 0 offen sc1
  s_waitcnt vmcnt(0)
  v_cmp_gt_u32 vcc, s42, v21
  s_cbranch_vccz polled_101
  s_add_u32 s35, s35, 1
  s_cmp_lt_u32 s35, 300000
  s_nop 0
  s_cbranch_scc1 poll_100
polled_101:
  v_readfirstlane_b32 s48, v21
  s_nop 1
  s_min_u32 s48, s48, 64
seen_99:
  s_mov_b32 s65, s74
  s_mov_b32 s66, s75
  s_add_u32 s74, s74, 262144
  s_sub_u32 s40, s75, 16384
  s_xor_b32 s40, s40, 16384
  s_add_u32 s75, s40, 16384
  s_sleep 6
  s_mov_b32 m0, s66
  s_nop 0
  buffer_load_dwordx4 v10, s[4:7], s65 offen offset:0 sc1 lds
  buffer_load_dwordx4 v10, s[4:7], s65 offen offset:1024 sc1 lds
  buffer_load_dwordx4 v10, s[4:7], s65 offen offset:2048 sc1 lds
  buffer_load_dwordx4 v10, s[4:7], s65 offen offset:3072 sc1 lds
  s_add_u32 s65, s65, 4096
  s_add_u32 s66, s66, 4096
  s_mov_b32 m0, s66
  s_nop 0
  buffer_load_dwordx4 v10, s[4:7], s65 offen offset:0 sc1 lds
  buffer_load_dwordx4 v10, s[4:7], s65 offen offset:1024 sc1 lds
  buffer_load_dwordx4 v10, s[4:7], s65 offen offset:2048 sc1 lds
  buffer_load_dwordx4 v10, s[4:7], s65 offen offset:3072 sc1 lds
  s_waitcnt vmcnt(8)
fin_89:
  s_barrier
  ds_read_b128 v[84:87], v26 offset:0
  ds_read_b128 v[88:91], v26 offset:1024
  ds_read_b128 v[92:95], v26 offset:2048
  ds_read_b128 v[96:99], v26 offset:3072
  ds_read_b128 v[100:103], v26 offset:4096
  ds_read_b128 v[104:107], v26 offset:5120
  s_mul_i32 s40, s46, 10240
  s_add_u32 s60, s40, 524288
  v_mov_b64 v[68:69], 0
  v_mov_b64 v[70:71], 0
  v_mov_b64 v[72:73], 0
  v_mov_b64 v[74:75], 0
  v_mov_b64 v[76:77], 0
  v_mov_b64 v[78:79], 0
  v_mov_b64 v[80:81], 0
  v_mov_b64 v[82:83], 0
  s_cmp_ge_u32 s34, 2
  s_cbranch_scc1 g23_102
  s_sleep 2
gat_104:
  buffer_load_dwordx4 v[28:31], v17, s[4:7], s60 offen offset:0 sc1
  buffer_load_dwordx4 v[32:35], v17, s[4:7], s60 offen offset:1024 sc1
  buffer_load_dwordx4 v[36:39], v17, s[4:7], s60 offen offset:2048 sc1
  s_waitcnt vmcnt(0)
  v_xor_b32 v20, v19, v28
  v_bitop3_b32 v20, v20, v32, v19 bitop3:0xf6
  v_bitop3_b32 v20, v20, v36, v19 bitop3:0xf6
  v_and_b32 v20, 1, v20
  v_cmp_ne_u32 vcc, 0, v20
  s_cbranch_vccz gatd_105
  s_add_u32 s35, s35, 1
  s_cmp_lt_u32 s35, 300000
  s_nop 0
  s_cbranch_scc1 gat_104
gatd_105:
  ds_write_b128 v18, v[28:31] offset:0
  ds_write_b128 v18, v[32:35] offset:1024
  ds_write_b128 v18, v[36:39] offset:2048
  s_cmp_lg_u32 s34, 1
  s_cbranch_scc1 nokvf_106
  s_lshl_b32 s40, s47, 8
  s_add_u32 s40, s40, 24576
  v_and_b32 v20, 63, v0
  v_cmp_eq_u32 vcc, 0, v20
  v_mov_b32 v21, 0x7ffffff0
  s_nop 0
  v_cndmask_b32 v20, v21, 0, vcc
  v_mov_b32 v21, s44
  buffer_store_dword v21, v20, s[4:7], s40 offen sc1
nokvf_106:
  s_branch gend_103
g23_102:
  s_sleep 2
gat2_107:
  buffer_load_dwordx4 v[28:31], v17, s[4:7], s60 offen offset:0 sc1
  buffer_load_dwordx4 v[32:35], v17, s[4:7], s60 offen offset:1024 sc1
  s_waitcnt vmcnt(0)
  v_xor_b32 v20, v19, v28
  v_bitop3_b32 v20, v20, v32, v19 bitop3:0xf6
  v_and_b32 v20, 1, v20
  v_cmp_ne_u32 vcc, 0, v20
  s_cbranch_vccz gat2d_108
  s_add_u32 s35, s35, 1
  s_cmp_lt_u32 s35, 300000
  s_nop 0
  s_cbranch_scc1 gat2_107
gat2d_108:
  ds_write_b128 v18, v[28:31] offset:0
  ds_write_b128 v18, v[32:35] offset:1024
gend_103:
  s_waitcnt lgkmcnt(0)
  s_branch A_step
A_last:
  s_waitcnt vmcnt(0)
  s_barrier
  s_cmp_lg_u32 s34, 3
  s_cbranch_scc1 nokvf_109
  s_lshl_b32 s40, s47, 8
  s_add_u32 s40, s40, 24576
  v_and_b32 v20, 63, v0
  v_cmp_eq_u32 vcc, 0, v20
  v_mov_b32 v21, 0x7ffffff0
  s_nop 0
  v_cndmask_b32 v20, v21, 0, vcc
  v_mov_b32 v21, 64
  buffer_store_dword v21, v20, s[4:7], s40 offen sc1
nokvf_109:
  s_mov_b32 s80, 5
  s_branch L_w2
L_role_b:
  s_mov_b32 s47, s33
  s_sub_u32 s40, 0, s4
  s_and_b32 s40, s40, 0x1fffff
  s_add_u32 s49, s40, 163577856
  s_load_dwordx2 s[20:21], s[0:1], 32
  s_mov_b32 s22, 0x500000
  s_mov_b32 s23, 0x00020000
  s_load_dwordx2 s[24:25], s[0:1], 40
  s_mov_b32 s26, 0x500000
  s_mov_b32 s27, 0x00020000
  s_load_dwordx2 s[28:29], s[0:1], 8
  s_mov_b32 s30, 0x2800
  s_mov_b32 s31, 0x00020000
  s_waitcnt lgkmcnt(0)
  v_mov_b32 v44, 0x00010001
  v_mov_b32 v45, 0x00010001
  v_mov_b32 v46, 0x00010001
  v_mov_b32 v47, 0x00010001
  v_lshrrev_b32 v40, 0, v0
  v_mov_b32 v41, 0x0
  v_mad_i32_i24 v41, v40, 16, v41
  s_lshl_b32 s40, s33, 16
  s_add_u32 s40, s40, s49
  buffer_store_dwordx4 v[44:47], v41, s[4:7], s40 offen sc1
  s_add_u32 s40, s40, 4096
  buffer_store_dwordx4 v[44:47], v41, s[4:7], s40 offen sc1
  s_add_u32 s40, s40, 4096
  buffer_store_dwordx4 v[44:47], v41, s[4:7], s40 offen sc1
  s_add_u32 s40, s40, 4096
  buffer_store_dwordx4 v[44:47], v41, s[4:7], s40 offen sc1
  s_add_u32 s40, s40, 4096
  buffer_store_dwordx4 v[44:47], v41, s[4:7], s40 offen sc1
  s_add_u32 s40, s40, 4096
  buffer_store_dwordx4 v[44:47], v41, s[4:7], s40 offen sc1
  s_add_u32 s40, s40, 4096
  buffer_store_dwordx4 v[44:47], v41, s[4:7], s40 offen sc1
  s_add_u32 s40, s40, 4096
  buffer_store_dwordx4 v[44:47], v41, s[4:7], s40 offen sc1
  s_add_u32 s40, s40, 4096
  buffer_store_dwordx4 v[44:47], v41, s[4:7], s40 offen sc1
  s_add_u32 s40, s40, 4096
  buffer_store_dwordx4 v[44:47], v41, s[4:7], s40 offen sc1
  s_add_u32 s40, s40, 4096
  buffer_store_dwordx4 v[44:47], v41, s[4:7], s40 offen sc1
  s_add_u32 s40, s40, 4096
  buffer_store_dwordx4 v[44:47], v41, s[4:7], s40 offen sc1
  s_add_u32 s40, s40, 4096
  buffer_store_dwordx4 v[44:47], v41, s[4:7], s40 offen sc1
  s_add_u32 s40, s40, 4096
  buffer_store_dwordx4 v[44:47], v41, s[4:7], s40 offen sc1
  s_add_u32 s40, s40, 4096
  buffer_store_dwordx4 v[44:47], v41, s[4:7], s40 offen sc1
  s_add_u32 s40, s40, 4096
  buffer_store_dwordx4 v[44:47], v41, s[4:7], s40 offen sc1
  v_and_b32 v58, 63, v0
  v_mov_b32 v60, 0x0
  v_mad_i32_i24 v60, v58, 16, v60
  s_mul_i32 s41, s47, 163840
  s_add_u32 s41, s41, 0
  s_mul_i32 s42, s34, 20480
  s_add_u32 s41, s41, s42
  s_add_u32 s42, s42, 0
  s_mov_b32 m0, s42
  s_nop 0
  buffer_load_dwordx4 v60, s[24:27], s41 offen lds
  s_add_u32 s41, s41, 1024
  s_add_u32 s42, s42, 1024
  s_mov_b32 m0, s42
  s_nop 0
  buffer_load_dwordx4 v60, s[24:27], s41 offen lds
  s_add_u32 s41, s41, 1024
  s_add_u32 s42, s42, 1024
  s_mov_b32 m0, s42
  s_nop 0
  buffer_load_dwordx4 v60, s[24:27], s41 offen lds
  s_add_u32 s41, s41, 1024
  s_add_u32 s42, s42, 1024
  s_mov_b32 m0, s42
  s_nop 0
  buffer_load_dwordx4 v60, s[24:27], s41 offen lds
  s_add_u32 s41, s41, 1024
  s_add_u32 s42, s42, 1024
  s_mov_b32 m0, s42
  s_nop 0
  buffer_load_dwordx4 v60, s[24:27], s41 offen lds
  s_add_u32 s41, s41, 1024
  s_add_u32 s42, s42, 1024
  s_mov_b32 m0, s42
  s_nop 0
  buffer_load_dwordx4 v60, s[24:27], s41 offen lds
  s_add_u32 s41, s41, 1024
  s_add_u32 s42, s42, 1024
  s_mov_b32 m0, s42
  s_nop 0
  buffer_load_dwordx4 v60, s[24:27], s41 offen lds
  s_add_u32 s41, s41, 1024
  s_add_u32 s42, s42, 1024
  s_mov_b32 m0, s42
  s_nop 0
  buffer_load_dwordx4 v60, s[24:27], s41 offen lds
  s_add_u32 s41, s41, 1024
  s_add_u32 s42, s42, 1024
  s_mov_b32 m0, s42
  s_nop 0
  buffer_load_dwordx4 v60, s[24:27], s41 offen lds
  s_add_u32 s41, s41, 1024
  s_add_u32 s42, s42, 1024
  s_mov_b32 m0, s42
  s_nop 0
  buffer_load_dwordx4 v60, s[24:27], s41 offen lds
  s_add_u32 s41, s41, 1024
  s_add_u32 s42, s42, 1024
  s_mov_b32 m0, s42
  s_nop 0
  buffer_load_dwordx4 v60, s[24:27], s41 offen lds
  s_add_u32 s41, s41, 1024
  s_add_u32 s42, s42, 1024
  s_mov_b32 m0, s42
  s_nop 0
  buffer_load_dwordx4 v60, s[24:27], s41 offen lds
  s_add_u32 s41, s41, 1024
  s_add_u32 s42, s42, 1024
  s_mov_b32 m0, s42
  s_nop 0
  buffer_load_dwordx4 v60, s[24:27], s41 offen lds
  s_add_u32 s41, s41, 1024
  s_add_u32 s42, s42, 1024
  s_mov_b32 m0, s42
  s_nop 0
  buffer_load_dwordx4 v60, s[24:27], s41 offen lds
  s_add_u32 s41, s41, 1024
  s_add_u32 s42, s42, 1024
  s_mov_b32 m0, s42
  s_nop 0
  buffer_load_dwordx4 v60, s[24:27], s41 offen lds
  s_add_u32 s41, s41, 1024
  s_add_u32 s42, s42, 1024
  s_mov_b32 m0, s42
  s_nop 0
  buffer_load_dwordx4 v60, s[24:27], s41 offen lds
  s_add_u32 s41, s41, 1024
  s_add_u32 s42, s42, 1024
  s_mov_b32 m0, s42
  s_nop 0
  buffer_load_dwordx4 v60, s[24:27], s41 offen lds
  s_add_u32 s41, s41, 1024
  s_add_u32 s42, s42, 1024
  s_mov_b32 m0, s42
  s_nop 0
  buffer_load_dwordx4 v60, s[24:27], s41 offen lds
  s_add_u32 s41, s41, 1024
  s_add_u32 s42, s42, 1024
  s_mov_b32 m0, s42
  s_nop 0
  buffer_load_dwordx4 v60, s[24:27], s41 offen lds
  s_add_u32 s41, s41, 1024
  s_add_u32 s42, s42, 1024
  s_mov_b32 m0, s42
  s_nop 0
  buffer_load_dwordx4 v60, s[24:27], s41 offen lds
  s_mul_i32 s41, s47, 163840
  s_add_u32 s41, s41, 81920
  s_mul_i32 s42, s34, 20480
  s_add_u32 s41, s41, s42
  s_add_u32 s42, s42, 81920
  s_mov_b32 m0, s42
  s_nop 0
  buffer_load_dwordx4 v60, s[24:27], s41 offen lds
  s_add_u32 s41, s41, 1024
  s_add_u32 s42, s42, 1024
  s_mov_b32 m0, s42
  s_nop 0
  buffer_load_dwordx4 v60, s[24:27], s41 offen lds
  s_add_u32 s41, s41, 1024
  s_add_u32 s42, s42, 1024
  s_mov_b32 m0, s42
  s_nop 0
  buffer_load_dwordx4 v60, s[24:27], s41 offen lds
  s_add_u32 s41, s41, 1024
  s_add_u32 s42, s42, 1024
  s_mov_b32 m0, s42
  s_nop 0
  buffer_load_dwordx4 v60, s[24:27], s41 offen lds
  s_add_u32 s41, s41, 1024
  s_add_u32 s42, s42, 1024
  s_mov_b32 m0, s42
  s_nop 0
  buffer_load_dwordx4 v60, s[24:27], s41 offen lds
  s_add_u32 s41, s41, 1024
  s_add_u32 s42, s42, 1024
  s_mov_b32 m0, s42
  s_nop 0
  buffer_load_dwordx4 v60, s[24:27], s41 offen lds
  s_add_u32 s41, s41, 1024
  s_add_u32 s42, s42, 1024
  s_mov_b32 m0, s42
  s_nop 0
  buffer_load_dwordx4 v60, s[24:27], s41 offen lds
  s_add_u32 s41, s41, 1024
  s_add_u32 s42, s42, 1024
  s_mov_b32 m0, s42
  s_nop 0
  buffer_load_dwordx4 v60, s[24:27], s41 offen lds
  s_add_u32 s41, s41, 1024
  s_add_u32 s42, s42, 1024
  s_mov_b32 m0, s42
  s_nop 0
  buffer_load_dwordx4 v60, s[24:27], s41 offen lds
  s_add_u32 s41, s41, 1024
  s_add_u32 s42, s42, 1024
  s_mov_b32 m0, s42
  s_nop 0
  buffer_load_dwordx4 v60, s[24:27], s41 offen lds
  s_add_u32 s41, s41, 1024
  s_add_u32 s42, s42, 1024
  s_mov_b32 m0, s42
  s_nop 0
  buffer_load_dwordx4 v60, s[24:27], s41 offen lds
  s_add_u32 s41, s41, 1024
  s_add_u32 s42, s42, 1024
  s_mov_b32 m0, s42
  s_nop 0
  buffer_load_dwordx4 v60, s[24:27], s41 offen lds
  s_add_u32 s41, s41, 1024
  s_add_u32 s42, s42, 1024
  s_mov_b32 m0, s42
  s_nop 0
  buffer_load_dwordx4 v60, s[24:27], s41 offen lds
  s_add_u32 s41, s41, 1024
  s_add_u32 s42, s42, 1024
  s_mov_b32 m0, s42
  s_nop 0
  buffer_load_dwordx4 v60, s[24:27], s41 offen lds
  s_add_u32 s41, s41, 1024
  s_add_u32 s42, s42, 1024
  s_mov_b32 m0, s42
  s_nop 0
  buffer_load_dwordx4 v60, s[24:27], s41 offen lds
  s_add_u32 s41, s41, 1024
  s_add_u32 s42, s42, 1024
  s_mov_b32 m0, s42
  s_nop 0
  buffer_load_dwordx4 v60, s[24:27], s41 offen lds
  s_add_u32 s41, s41, 1024
  s_add_u32 s42, s42, 1024
  s_mov_b32 m0, s42
  s_nop 0
  buffer_load_dwordx4 v60, s[24:27], s41 offen lds
  s_add_u32 s41, s41, 1024
  s_add_u32 s42, s42, 1024
  s_mov_b32 m0, s42
  s_nop 0
  buffer_load_dwordx4 v60, s[24:27], s41 offen lds
  s_add_u32 s41, s41, 1024
  s_add_u32 s42, s42, 1024
  s_mov_b32 m0, s42
  s_nop 0
  buffer_load_dwordx4 v60, s[24:27], s41 offen lds
  s_add_u32 s41, s41, 1024
  s_add_u32 s42, s42, 1024
  s_mov_b32 m0, s42
  s_nop 0
  buffer_load_dwordx4 v60, s[24:27], s41 offen lds
  v_bfe_u32 v58, v0, 4, 2
  v_mov_b32 v52, 0x0
  s_mov_b32 s36, 0x2000
  v_mad_i32_i24 v52, v58, s36, v52
  v_and_b32 v58, 15, v0
  v_mov_b32 v53, 0x0
  v_mad_i32_i24 v53, v58, 16, v53
  v_bfe_u32 v59, v0, 4, 2
  v_mov_b32 v58, 0x0
  v_mad_i32_i24 v58, v59, 32, v58
  v_xor_b32 v53, v53, v58
  v_add_u32 v52, v52, v53
  v_xor_b32 v53, 128, v52
  v_bfe_u32 v58, v0, 1, 1
  v_mov_b32 v54, 0x0
  v_mad_i32_i24 v54, v58, 1, v54
  v_lshrrev_b32 v58, 6, v0
  v_mad_i32_i24 v54, v58, 4, v54
  v_bfe_u32 v58, v0, 2, 3
  v_mov_b32 v55, 0x0
  v_mad_i32_i24 v55, v58, 2, v55
  v_xor_b32 v54, v54, v55
  v_lshlrev_b32 v54, 4, v54
  v_and_b32 v58, 1, v0
  v_mov_b32 v55, 0x0
  v_mad_i32_i24 v55, v58, 8, v55
  v_bfe_u32 v58, v0, 2, 2
  s_mov_b32 s36, 0x100
  v_mad_i32_i24 v55, v58, s36, v55
  v_bfe_u32 v58, v0, 4, 2
  s_mov_b32 s36, 0x800
  v_mad_i32_i24 v55, v58, s36, v55
  v_add_u32 v54, v54, v55
  v_xor_b32 v55, 32, v54
  v_add_u32 v56, 0x10000, v54
  v_add_u32 v57, 0x10000, v55
  s_waitcnt vmcnt(20)
  s_barrier
  s_cmp_lg_u32 s34, 0
  s_cbranch_scc1 cinit_110
  v_and_b32 v25, 63, v0
  v_cmp_eq_u32 vcc, 0, v25
  v_mov_b32 v26, 0x7ffffff0
  v_mov_b32 v25, 64
  v_cndmask_b32 v25, v26, v25, vcc
  v_mov_b32 v26, 1
  buffer_atomic_add v26, v25, s[8:11], 0 offen
cinit_110:
  v_and_b32 v63, 3, v0
  v_mov_b32 v61, 0x0
  v_mad_i32_i24 v61, v63, 8, v61
  v_bfe_u32 v63, v0, 2, 2
  s_mov_b32 s36, 0x500
  v_mad_i32_i24 v61, v63, s36, v61
  v_bfe_u32 v63, v0, 4, 2
  s_mov_b32 s36, 0x2800
  v_mad_i32_i24 v61, v63, s36, v61
  v_lshrrev_b32 v63, 6, v0
  s_mov_b32 s36, 0x140
  v_mad_i32_i24 v61, v63, s36, v61
  ds_read_b64_tr_b16 a[160:161], v61 offset:0
  ds_read_b64_tr_b16 a[168:169], v61 offset:32
  ds_read_b64_tr_b16 a[176:177], v61 offset:64
  ds_read_b64_tr_b16 a[184:185], v61 offset:96
  ds_read_b64_tr_b16 a[192:193], v61 offset:128
  ds_read_b64_tr_b16 a[200:201], v61 offset:160
  ds_read_b64_tr_b16 a[208:209], v61 offset:192
  ds_read_b64_tr_b16 a[216:217], v61 offset:224
  ds_read_b64_tr_b16 a[224:225], v61 offset:256
  ds_read_b64_tr_b16 a[232:233], v61 offset:288
  v_and_b32 v63, 3, v0
  v_mov_b32 v62, 0x1400
  v_mad_i32_i24 v62, v63, 8, v62
  v_bfe_u32 v63, v0, 2, 2
  s_mov_b32 s36, 0x500
  v_mad_i32_i24 v62, v63, s36, v62
  v_bfe_u32 v63, v0, 4, 2
  s_mov_b32 s36, 0x2800
  v_mad_i32_i24 v62, v63, s36, v62
  v_lshrrev_b32 v63, 6, v0
  s_mov_b32 s36, 0x140
  v_mad_i32_i24 v62, v63, s36, v62
  ds_read_b64_tr_b16 a[162:163], v62 offset:0
  ds_read_b64_tr_b16 a[170:171], v62 offset:32
  ds_read_b64_tr_b16 a[178:179], v62 offset:64
  ds_read_b64_tr_b16 a[186:187], v62 offset:96
  ds_read_b64_tr_b16 a[194:195], v62 offset:128
  ds_read_b64_tr_b16 a[202:203], v62 offset:160
  ds_read_b64_tr_b16 a[210:211], v62 offset:192
  ds_read_b64_tr_b16 a[218:219], v62 offset:224
  ds_read_b64_tr_b16 a[226:227], v62 offset:256
  ds_read_b64_tr_b16 a[234:235], v62 offset:288
  s_waitcnt lgkmcnt(0)
  v_and_b32 v63, 3, v0
  v_mov_b32 v61, 0xa000
  v_mad_i32_i24 v61, v63, 8, v61
  v_bfe_u32 v63, v0, 2, 2
  s_mov_b32 s36, 0x500
  v_mad_i32_i24 v61, v63, s36, v61
  v_bfe_u32 v63, v0, 4, 2
  s_mov_b32 s36, 0x2800
  v_mad_i32_i24 v61, v63, s36, v61
  v_lshrrev_b32 v63, 6, v0
  s_mov_b32 s36, 0x140
  v_mad_i32_i24 v61, v63, s36, v61
  ds_read_b64_tr_b16 a[164:165], v61 offset:0
  ds_read_b64_tr_b16 a[172:173], v61 offset:32
  ds_read_b64_tr_b16 a[180:181], v61 offset:64
  ds_read_b64_tr_b16 a[188:189], v61 offset:96
  ds_read_b64_tr_b16 a[196:197], v61 offset:128
  ds_read_b64_tr_b16 a[204:205], v61 offset:160
  ds_read_b64_tr_b16 a[212:213], v61 offset:192
  ds_read_b64_tr_b16 a[220:221], v61 offset:224
  ds_read_b64_tr_b16 a[228:229], v61 offset:256
  ds_read_b64_tr_b16 a[236:237], v61 offset:288
  v_and_b32 v63, 3, v0
  v_mov_b32 v62, 0xb400
  v_mad_i32_i24 v62, v63, 8, v62
  v_bfe_u32 v63, v0, 2, 2
  s_mov_b32 s36, 0x500
  v_mad_i32_i24 v62, v63, s36, v62
  v_bfe_u32 v63, v0, 4, 2
  s_mov_b32 s36, 0x2800
  v_mad_i32_i24 v62, v63, s36, v62
  v_lshrrev_b32 v63, 6, v0
  s_mov_b32 s36, 0x140
  v_mad_i32_i24 v62, v63, s36, v62
  ds_read_b64_tr_b16 a[166:167], v62 offset:0
  ds_read_b64_tr_b16 a[174:175], v62 offset:32
  ds_read_b64_tr_b16 a[182:183], v62 offset:64
  ds_read_b64_tr_b16 a[190:191], v62 offset:96
  ds_read_b64_tr_b16 a[198:199], v62 offset:128
  ds_read_b64_tr_b16 a[206:207], v62 offset:160
  ds_read_b64_tr_b16 a[214:215], v62 offset:192
  ds_read_b64_tr_b16 a[222:223], v62 offset:224
  ds_read_b64_tr_b16 a[230:231], v62 offset:256
  ds_read_b64_tr_b16 a[238:239], v62 offset:288
  s_waitcnt lgkmcnt(0)
  s_waitcnt lgkmcnt(0)
  s_barrier
  s_lshl_b32 s41, s47, 8
  s_mul_i32 s42, s34, 262144
  s_add_u32 s41, s41, s42
  s_add_u32 s41, s41, 0
  s_lshl_b32 s42, s34, 13
  s_add_u32 s42, s42, 0
  s_mov_b32 m0, s42
  s_nop 0
  buffer_load_dwordx4 v52, s[20:23], s41 offen lds
  s_add_u32 s41, s41, 32768
  s_add_u32 s42, s42, 1024
  s_mov_b32 m0, s42
  s_nop 0
  buffer_load_dwordx4 v52, s[20:23], s41 offen lds
  s_add_u32 s41, s41, 32768
  s_add_u32 s42, s42, 1024
  s_mov_b32 m0, s42
  s_nop 0
  buffer_load_dwordx4 v53, s[20:23], s41 offen lds
  s_add_u32 s41, s41, 32768
  s_add_u32 s42, s42, 1024
  s_mov_b32 m0, s42
  s_nop 0
  buffer_load_dwordx4 v53, s[20:23], s41 offen lds
  s_add_u32 s41, s41, 32768
  s_add_u32 s42, s42, 1024
  s_mov_b32 m0, s42
  s_nop 0
  buffer_load_dwordx4 v52, s[20:23], s41 offen lds
  s_add_u32 s41, s41, 32768
  s_add_u32 s42, s42, 1024
  s_mov_b32 m0, s42
  s_nop 0
  buffer_load_dwordx4 v52, s[20:23], s41 offen lds
  s_add_u32 s41, s41, 32768
  s_add_u32 s42, s42, 1024
  s_mov_b32 m0, s42
  s_nop 0
  buffer_load_dwordx4 v53, s[20:23], s41 offen lds
  s_add_u32 s41, s41, 32768
  s_add_u32 s42, s42, 1024
  s_mov_b32 m0, s42
  s_nop 0
  buffer_load_dwordx4 v53, s[20:23], s41 offen lds
  s_lshl_b32 s41, s47, 8
  s_mul_i32 s42, s34, 262144
  s_add_u32 s41, s41, s42
  s_add_u32 s41, s41, 1048576
  s_lshl_b32 s42, s34, 13
  s_add_u32 s42, s42, 32768
  s_mov_b32 m0, s42
  s_nop 0
  buffer_load_dwordx4 v52, s[20:23], s41 offen lds
  s_add_u32 s41, s41, 32768
  s_add_u32 s42, s42, 1024
  s_mov_b32 m0, s42
  s_nop 0
  buffer_load_dwordx4 v52, s[20:23], s41 offen lds
  s_add_u32 s41, s41, 32768
  s_add_u32 s42, s42, 1024
  s_mov_b32 m0, s42
  s_nop 0
  buffer_load_dwordx4 v53, s[20:23], s41 offen lds
  s_add_u32 s41, s41, 32768
  s_add_u32 s42, s42, 1024
  s_mov_b32 m0, s42
  s_nop 0
  buffer_load_dwordx4 v53, s[20:23], s41 offen lds
  s_add_u32 s41, s41, 32768
  s_add_u32 s42, s42, 1024
  s_mov_b32 m0, s42
  s_nop 0
  buffer_load_dwordx4 v52, s[20:23], s41 offen lds
  s_add_u32 s41, s41, 32768
  s_add_u32 s42, s42, 1024
  s_mov_b32 m0, s42
  s_nop 0
  buffer_load_dwordx4 v52, s[20:23], s41 offen lds
  s_add_u32 s41, s41, 32768
  s_add_u32 s42, s42, 1024
  s_mov_b32 m0, s42
  s_nop 0
  buffer_load_dwordx4 v53, s[20:23], s41 offen lds
  s_add_u32 s41, s41, 32768
  s_add_u32 s42, s42, 1024
  s_mov_b32 m0, s42
  s_nop 0
  buffer_load_dwordx4 v53, s[20:23], s41 offen lds
  s_waitcnt vmcnt(16)
  s_barrier
  v_and_b32 v63, 3, v0
  v_mov_b32 v61, 0x14000
  v_mad_i32_i24 v61, v63, 8, v61
  v_bfe_u32 v63, v0, 2, 2
  s_mov_b32 s36, 0x500
  v_mad_i32_i24 v61, v63, s36, v61
  v_bfe_u32 v63, v0, 4, 2
  s_mov_b32 s36, 0x2800
  v_mad_i32_i24 v61, v63, s36, v61
  v_lshrrev_b32 v63, 6, v0
  s_mov_b32 s36, 0x140
  v_mad_i32_i24 v61, v63, s36, v61
  ds_read_b64_tr_b16 a[240:241], v61 offset:0
  ds_read_b64_tr_b16 a[248:249], v61 offset:32
  ds_read_b64_tr_b16 v[192:193], v61 offset:64
  ds_read_b64_tr_b16 v[200:201], v61 offset:96
  ds_read_b64_tr_b16 v[208:209], v61 offset:128
  ds_read_b64_tr_b16 v[216:217], v61 offset:160
  ds_read_b64_tr_b16 v[224:225], v61 offset:192
  ds_read_b64_tr_b16 v[232:233], v61 offset:224
  ds_read_b64_tr_b16 v[240:241], v61 offset:256
  ds_read_b64_tr_b16 v[248:249], v61 offset:288
  v_and_b32 v63, 3, v0
  v_mov_b32 v62, 0x15400
  v_mad_i32_i24 v62, v63, 8, v62
  v_bfe_u32 v63, v0, 2, 2
  s_mov_b32 s36, 0x500
  v_mad_i32_i24 v62, v63, s36, v62
  v_bfe_u32 v63, v0, 4, 2
  s_mov_b32 s36, 0x2800
  v_mad_i32_i24 v62, v63, s36, v62
  v_lshrrev_b32 v63, 6, v0
  s_mov_b32 s36, 0x140
  v_mad_i32_i24 v62, v63, s36, v62
  ds_read_b64_tr_b16 a[242:243], v62 offset:0
  ds_read_b64_tr_b16 a[250:251], v62 offset:32
  ds_read_b64_tr_b16 v[194:195], v62 offset:64
  ds_read_b64_tr_b16 v[202:203], v62 offset:96
  ds_read_b64_tr_b16 v[210:211], v62 offset:128
  ds_read_b64_tr_b16 v[218:219], v62 offset:160
  ds_read_b64_tr_b16 v[226:227], v62 offset:192
  ds_read_b64_tr_b16 v[234:235], v62 offset:224
  ds_read_b64_tr_b16 v[242:243], v62 offset:256
  ds_read_b64_tr_b16 v[250:251], v62 offset:288
  s_waitcnt lgkmcnt(0)
  v_and_b32 v63, 3, v0
  v_mov_b32 v61, 0x1e000
  v_mad_i32_i24 v61, v63, 8, v61
  v_bfe_u32 v63, v0, 2, 2
  s_mov_b32 s36, 0x500
  v_mad_i32_i24 v61, v63, s36, v61
  v_bfe_u32 v63, v0, 4, 2
  s_mov_b32 s36, 0x2800
  v_mad_i32_i24 v61, v63, s36, v61
  v_lshrrev_b32 v63, 6, v0
  s_mov_b32 s36, 0x140
  v_mad_i32_i24 v61, v63, s36, v61
  ds_read_b64_tr_b16 a[244:245], v61 offset:0
  ds_read_b64_tr_b16 a[252:253], v61 offset:32
  ds_read_b64_tr_b16 v[196:197], v61 offset:64
  ds_read_b64_tr_b16 v[204:205], v61 offset:96
  ds_read_b64_tr_b16 v[212:213], v61 offset:128
  ds_read_b64_tr_b16 v[220:221], v61 offset:160
  ds_read_b64_tr_b16 v[228:229], v61 offset:192
  ds_read_b64_tr_b16 v[236:237], v61 offset:224
  ds_read_b64_tr_b16 v[244:245], v61 offset:256
  ds_read_b64_tr_b16 v[252:253], v61 offset:288
  v_and_b32 v63, 3, v0
  v_mov_b32 v62, 0x1f400
  v_mad_i32_i24 v62, v63, 8, v62
  v_bfe_u32 v63, v0, 2, 2
  s_mov_b32 s36, 0x500
  v_mad_i32_i24 v62, v63, s36, v62
  v_bfe_u32 v63, v0, 4, 2
  s_mov_b32 s36, 0x2800
  v_mad_i32_i24 v62, v63, s36, v62
  v_lshrrev_b32 v63, 6, v0
  s_mov_b32 s36, 0x140
  v_mad_i32_i24 v62, v63, s36, v62
  ds_read_b64_tr_b16 a[246:247], v62 offset:0
  ds_read_b64_tr_b16 a[254:255], v62 offset:32
  ds_read_b64_tr_b16 v[198:199], v62 offset:64
  ds_read_b64_tr_b16 v[206:207], v62 offset:96
  ds_read_b64_tr_b16 v[214:215], v62 offset:128
  ds_read_b64_tr_b16 v[222:223], v62 offset:160
  ds_read_b64_tr_b16 v[230:231], v62 offset:192
  ds_read_b64_tr_b16 v[238:239], v62 offset:224
  ds_read_b64_tr_b16 v[246:247], v62 offset:256
  ds_read_b64_tr_b16 v[254:255], v62 offset:288
  s_waitcnt lgkmcnt(0)
  s_waitcnt lgkmcnt(0)
  s_barrier
  s_lshl_b32 s41, s47, 8
  s_mul_i32 s42, s34, 262144
  s_add_u32 s41, s41, s42
  s_add_u32 s41, s41, 2097152
  s_lshl_b32 s42, s34, 13
  s_add_u32 s42, s42, 65536
  s_mov_b32 m0, s42
  s_nop 0
  buffer_load_dwordx4 v52, s[20:23], s41 offen lds
  s_add_u32 s41, s41, 32768
  s_add_u32 s42, s42, 1024
  s_mov_b32 m0, s42
  s_nop 0
  buffer_load_dwordx4 v52, s[20:23], s41 offen lds
  s_add_u32 s41, s41, 32768
  s_add_u32 s42, s42, 1024
  s_mov_b32 m0, s42
  s_nop 0
  buffer_load_dwordx4 v53, s[20:23], s41 offen lds
  s_add_u32 s41, s41, 32768
  s_add_u32 s42, s42, 1024
  s_mov_b32 m0, s42
  s_nop 0
  buffer_load_dwordx4 v53, s[20:23], s41 offen lds
  s_add_u32 s41, s41, 32768
  s_add_u32 s42, s42, 1024
  s_mov_b32 m0, s42
  s_nop 0
  buffer_load_dwordx4 v52, s[20:23], s41 offen lds
  s_add_u32 s41, s41, 32768
  s_add_u32 s42, s42, 1024
  s_mov_b32 m0, s42
  s_nop 0
  buffer_load_dwordx4 v52, s[20:23], s41 offen lds
  s_add_u32 s41, s41, 32768
  s_add_u32 s42, s42, 1024
  s_mov_b32 m0, s42
  s_nop 0
  buffer_load_dwordx4 v53, s[20:23], s41 offen lds
  s_add_u32 s41, s41, 32768
  s_add_u32 s42, s42, 1024
  s_mov_b32 m0, s42
  s_nop 0
  buffer_load_dwordx4 v53, s[20:23], s41 offen lds
  s_lshl_b32 s41, s47, 8
  s_mul_i32 s42, s34, 262144
  s_add_u32 s41, s41, s42
  s_add_u32 s41, s41, 3145728
  s_lshl_b32 s42, s34, 13
  s_add_u32 s42, s42, 98304
  s_mov_b32 m0, s42
  s_nop 0
  buffer_load_dwordx4 v52, s[20:23], s41 offen lds
  s_add_u32 s41, s41, 32768
  s_add_u32 s42, s42, 1024
  s_mov_b32 m0, s42
  s_nop 0
  buffer_load_dwordx4 v52, s[20:23], s41 offen lds
  s_add_u32 s41, s41, 32768
  s_add_u32 s42, s42, 1024
  s_mov_b32 m0, s42
  s_nop 0
  buffer_load_dwordx4 v53, s[20:23], s41 offen lds
  s_add_u32 s41, s41, 32768
  s_add_u32 s42, s42, 1024
  s_mov_b32 m0, s42
  s_nop 0
  buffer_load_dwordx4 v53, s[20:23], s41 offen lds
  s_add_u32 s41, s41, 32768
  s_add_u32 s42, s42, 1024
  s_mov_b32 m0, s42
  s_nop 0
  buffer_load_dwordx4 v52, s[20:23], s41 offen lds
  s_add_u32 s41, s41, 32768
  s_add_u32 s42, s42, 1024
  s_mov_b32 m0, s42
  s_nop 0
  buffer_load_dwordx4 v52, s[20:23], s41 offen lds
  s_add_u32 s41, s41, 32768
  s_add_u32 s42, s42, 1024
  s_mov_b32 m0, s42
  s_nop 0
  buffer_load_dwordx4 v53, s[20:23], s41 offen lds
  s_add_u32 s41, s41, 32768
  s_add_u32 s42, s42, 1024
  s_mov_b32 m0, s42
  s_nop 0
  buffer_load_dwordx4 v53, s[20:23], s41 offen lds
  s_lshl_b32 s41, s47, 8
  s_mul_i32 s42, s34, 262144
  s_add_u32 s41, s41, s42
  s_add_u32 s41, s41, 4194304
  s_lshl_b32 s42, s34, 13
  s_add_u32 s42, s42, 131072
  s_mov_b32 m0, s42
  s_nop 0
  buffer_load_dwordx4 v52, s[20:23], s41 offen lds
  s_add_u32 s41, s41, 32768
  s_add_u32 s42, s42, 1024
  s_mov_b32 m0, s42
  s_nop 0
  buffer_load_dwordx4 v52, s[20:23], s41 offen lds
  s_add_u32 s41, s41, 32768
  s_add_u32 s42, s42, 1024
  s_mov_b32 m0, s42
  s_nop 0
  buffer_load_dwordx4 v53, s[20:23], s41 offen lds
  s_add_u32 s41, s41, 32768
  s_add_u32 s42, s42, 1024
  s_mov_b32 m0, s42
  s_nop 0
  buffer_load_dwordx4 v53, s[20:23], s41 offen lds
  s_add_u32 s41, s41, 32768
  s_add_u32 s42, s42, 1024
  s_mov_b32 m0, s42
  s_nop 0
  buffer_load_dwordx4 v52, s[20:23], s41 offen lds
  s_add_u32 s41, s41, 32768
  s_add_u32 s42, s42, 1024
  s_mov_b32 m0, s42
  s_nop 0
  buffer_load_dwordx4 v52, s[20:23], s41 offen lds
  s_add_u32 s41, s41, 32768
  s_add_u32 s42, s42, 1024
  s_mov_b32 m0, s42
  s_nop 0
  buffer_load_dwordx4 v53, s[20:23], s41 offen lds
  s_add_u32 s41, s41, 32768
  s_add_u32 s42, s42, 1024
  s_mov_b32 m0, s42
  s_nop 0
  buffer_load_dwordx4 v53, s[20:23], s41 offen lds
  s_waitcnt vmcnt(32)
  s_barrier
  v_add_u32 v58, 0, v54
  v_add_u32 v59, 0, v55
  ds_read_b64_tr_b16 a[0:1], v58 offset:0
  ds_read_b64_tr_b16 a[2:3], v58 offset:1024
  ds_read_b64_tr_b16 a[4:5], v58 offset:8192
  ds_read_b64_tr_b16 a[6:7], v58 offset:9216
  ds_read_b64_tr_b16 a[80:81], v59 offset:0
  ds_read_b64_tr_b16 a[82:83], v59 offset:1024
  ds_read_b64_tr_b16 a[84:85], v59 offset:8192
  ds_read_b64_tr_b16 a[86:87], v59 offset:9216
  ds_read_b64_tr_b16 a[8:9], v58 offset:16384
  ds_read_b64_tr_b16 a[10:11], v58 offset:17408
  ds_read_b64_tr_b16 a[12:13], v58 offset:24576
  ds_read_b64_tr_b16 a[14:15], v58 offset:25600
  ds_read_b64_tr_b16 a[88:89], v59 offset:16384
  ds_read_b64_tr_b16 a[90:91], v59 offset:17408
  ds_read_b64_tr_b16 a[92:93], v59 offset:24576
  ds_read_b64_tr_b16 a[94:95], v59 offset:25600
  s_waitcnt lgkmcnt(0)
  s_barrier
  s_waitcnt vmcnt(24)
  s_barrier
  v_add_u32 v58, 32768, v54
  v_add_u32 v59, 32768, v55
  ds_read_b64_tr_b16 a[16:17], v58 offset:0
  ds_read_b64_tr_b16 a[18:19], v58 offset:1024
  ds_read_b64_tr_b16 a[20:21], v58 offset:8192
  ds_read_b64_tr_b16 a[22:23], v58 offset:9216
  ds_read_b64_tr_b16 a[96:97], v59 offset:0
  ds_read_b64_tr_b16 a[98:99], v59 offset:1024
  ds_read_b64_tr_b16 a[100:101], v59 offset:8192
  ds_read_b64_tr_b16 a[102:103], v59 offset:9216
  ds_read_b64_tr_b16 a[24:25], v58 offset:16384
  ds_read_b64_tr_b16 a[26:27], v58 offset:17408
  ds_read_b64_tr_b16 a[28:29], v58 offset:24576
  ds_read_b64_tr_b16 a[30:31], v58 offset:25600
  ds_read_b64_tr_b16 a[104:105], v59 offset:16384
  ds_read_b64_tr_b16 a[106:107], v59 offset:17408
  ds_read_b64_tr_b16 a[108:109], v59 offset:24576
  ds_read_b64_tr_b16 a[110:111], v59 offset:25600
  s_waitcnt lgkmcnt(0)
  s_barrier
  s_waitcnt vmcnt(16)
  s_barrier
  v_add_u32 v58, 65536, v54
  v_add_u32 v59, 65536, v55
  ds_read_b64_tr_b16 a[32:33], v58 offset:0
  ds_read_b64_tr_b16 a[34:35], v58 offset:1024
  ds_read_b64_tr_b16 a[36:37], v58 offset:8192
  ds_read_b64_tr_b16 a[38:39], v58 offset:9216
  ds_read_b64_tr_b16 a[112:113], v59 offset:0
  ds_read_b64_tr_b16 a[114:115], v59 offset:1024
  ds_read_b64_tr_b16 a[116:117], v59 offset:8192
  ds_read_b64_tr_b16 a[118:119], v59 offset:9216
  ds_read_b64_tr_b16 a[40:41], v58 offset:16384
  ds_read_b64_tr_b16 a[42:43], v58 offset:17408
  ds_read_b64_tr_b16 a[44:45], v58 offset:24576
  ds_read_b64_tr_b16 a[46:47], v58 offset:25600
  ds_read_b64_tr_b16 a[120:121], v59 offset:16384
  ds_read_b64_tr_b16 a[122:123], v59 offset:17408
  ds_read_b64_tr_b16 a[124:125], v59 offset:24576
  ds_read_b64_tr_b16 a[126:127], v59 offset:25600
  s_waitcnt lgkmcnt(0)
  s_barrier
  s_waitcnt vmcnt(8)
  s_barrier
  v_add_u32 v58, 98304, v54
  v_add_u32 v59, 98304, v55
  ds_read_b64_tr_b16 a[48:49], v58 offset:0
  ds_read_b64_tr_b16 a[50:51], v58 offset:1024
  ds_read_b64_tr_b16 a[52:53], v58 offset:8192
  ds_read_b64_tr_b16 a[54:55], v58 offset:9216
  ds_read_b64_tr_b16 a[128:129], v59 offset:0
  ds_read_b64_tr_b16 a[130:131], v59 offset:1024
  ds_read_b64_tr_b16 a[132:133], v59 offset:8192
  ds_read_b64_tr_b16 a[134:135], v59 offset:9216
  ds_read_b64_tr_b16 a[56:57], v58 offset:16384
  ds_read_b64_tr_b16 a[58:59], v58 offset:17408
  ds_read_b64_tr_b16 a[60:61], v58 offset:24576
  ds_read_b64_tr_b16 a[62:63], v58 offset:25600
  ds_read_b64_tr_b16 a[136:137], v59 offset:16384
  ds_read_b64_tr_b16 a[138:139], v59 offset:17408
  ds_read_b64_tr_b16 a[140:141], v59 offset:24576
  ds_read_b64_tr_b16 a[142:143], v59 offset:25600
  s_waitcnt lgkmcnt(0)
  s_barrier
  v_lshrrev_b32 v30, 0, v0
  v_mov_b32 v28, 0x0
  v_mad_i32_i24 v28, v30, 4, v28
  s_mov_b32 s40, 0
  buffer_load_dword v1, v28, s[28:31], s40 offen
  s_mov_b32 s40, 1280
  buffer_load_dword v2, v28, s[28:31], s40 offen
  s_mov_b32 s40, 2560
  buffer_load_dword v3, v28, s[28:31], s40 offen
  s_mov_b32 s40, 3840
  buffer_load_dword v4, v28, s[28:31], s40 offen
  s_mov_b32 s40, 5120
  buffer_load_dword v5, v28, s[28:31], s40 offen
  s_mov_b32 s40, 6400
  buffer_load_dword v6, v28, s[28:31], s40 offen
  s_mov_b32 s40, 7680
  buffer_load_dword v7, v28, s[28:31], s40 offen
  s_mov_b32 s40, 8960
  buffer_load_dword v8, v28, s[28:31], s40 offen
  v_lshrrev_b32 v30, 0, v0
  v_mov_b32 v29, 0x400
  v_mad_i32_i24 v29, v30, 4, v29
  v_cmp_gt_u32 vcc, 64, v0
  v_mov_b32 v30, 0x7ff00000
  s_nop 0
  v_cndmask_b32 v29, v30, v29, vcc
  s_mov_b32 s40, 0
  buffer_load_dword v9, v29, s[28:31], s40 offen
  s_mov_b32 s40, 1280
  buffer_load_dword v10, v29, s[28:31], s40 offen
  s_mov_b32 s40, 2560
  buffer_load_dword v11, v29, s[28:31], s40 offen
  s_mov_b32 s40, 3840
  buffer_load_dword v24, v29, s[28:31], s40 offen
  s_mov_b32 s40, 5120
  buffer_load_dword v25, v29, s[28:31], s40 offen
  s_mov_b32 s40, 6400
  buffer_load_dword v31, v29, s[28:31], s40 offen
  s_mov_b32 s40, 7680
  buffer_load_dword v12, v29, s[28:31], s40 offen
  s_mov_b32 s40, 8960
  buffer_load_dword v13, v29, s[28:31], s40 offen
  s_waitcnt vmcnt(16)
  s_barrier
  v_add_u32 v58, 131072, v54
  v_add_u32 v59, 131072, v55
  ds_read_b64_tr_b16 a[64:65], v58 offset:0
  ds_read_b64_tr_b16 a[66:67], v58 offset:1024
  ds_read_b64_tr_b16 a[68:69], v58 offset:8192
  ds_read_b64_tr_b16 a[70:71], v58 offset:9216
  ds_read_b64_tr_b16 a[144:145], v59 offset:0
  ds_read_b64_tr_b16 a[146:147], v59 offset:1024
  ds_read_b64_tr_b16 a[148:149], v59 offset:8192
  ds_read_b64_tr_b16 a[150:151], v59 offset:9216
  ds_read_b64_tr_b16 a[72:73], v58 offset:16384
  ds_read_b64_tr_b16 a[74:75], v58 offset:17408
  ds_read_b64_tr_b16 a[76:77], v58 offset:24576
  ds_read_b64_tr_b16 a[78:79], v58 offset:25600
  ds_read_b64_tr_b16 a[152:153], v59 offset:16384
  ds_read_b64_tr_b16 a[154:155], v59 offset:17408
  ds_read_b64_tr_b16 a[156:157], v59 offset:24576
  ds_read_b64_tr_b16 a[158:159], v59 offset:25600
  s_waitcnt lgkmcnt(0)
  s_barrier
  s_waitcnt vmcnt(0)
  s_mov_b32 s40, 0x05040100
  s_mov_b32 s41, 0x07060302
  v_perm_b32 v32, v2, v1, s40
  v_perm_b32 v36, v2, v1, s41
  v_perm_b32 v33, v4, v3, s40
  v_perm_b32 v37, v4, v3, s41
  v_perm_b32 v34, v6, v5, s40
  v_perm_b32 v38, v6, v5, s41
  v_perm_b32 v35, v8, v7, s40
  v_perm_b32 v39, v8, v7, s41
  v_lshrrev_b32 v29, 0, v0
  v_mov_b32 v28, 0x0
  v_mad_i32_i24 v28, v29, 32, v28
  v_bfe_u32 v29, v0, 3, 1
  v_lshlrev_b32 v29, 7, v29
  v_xor_b32 v28, v28, v29
  ds_write_b128 v28, v[32:35]
  ds_write_b128 v28, v[36:39] offset:16
  v_perm_b32 v32, v10, v9, s40
  v_perm_b32 v36, v10, v9, s41
  v_perm_b32 v33, v24, v11, s40
  v_perm_b32 v37, v24, v11, s41
  v_perm_b32 v34, v31, v25, s40
  v_perm_b32 v38, v31, v25, s41
  v_perm_b32 v35, v13, v12, s40
  v_perm_b32 v39, v13, v12, s41
  v_lshrrev_b32 v29, 0, v0
  v_mov_b32 v28, 0x2000
  v_mad_i32_i24 v28, v29, 32, v28
  v_bfe_u32 v29, v0, 3, 1
  v_lshlrev_b32 v29, 7, v29
  v_xor_b32 v28, v28, v29
  v_cmp_gt_u32 vcc, 64, v0
  v_mov_b32 v29, 10752
  s_nop 0
  v_cndmask_b32 v28, v29, v28, vcc
  ds_write_b128 v28, v[32:35]
  ds_write_b128 v28, v[36:39] offset:16
  s_cmp_lg_u32 s33, 0
  s_cbranch_scc1 cal_111
  s_cmp_lg_u32 s34, 3
  s_cbranch_scc1 cal_111
  s_mov_b32 s60, 0x7fffffff
  s_mov_b32 s61, 0x7fffffff
  s_add_u32 s40, s49, 5376
  s_memtime s[88:89]
  s_waitcnt lgkmcnt(0)
  buffer_load_dword v50, off, s[4:7], s40 sc1
  s_waitcnt vmcnt(0)
  s_memtime s[90:91]
  s_waitcnt lgkmcnt(0)
  s_sub_u32 s41, s90, s88
  s_min_u32 s60, s60, s41
  s_add_u32 s40, s49, 13568
  s_memtime s[88:89]
  s_waitcnt lgkmcnt(0)
  buffer_load_dword v50, off, s[4:7], s40 sc1
  s_waitcnt vmcnt(0)
  s_memtime s[90:91]
  s_waitcnt lgkmcnt(0)
  s_sub_u32 s41, s90, s88
  s_min_u32 s61, s61, s41
  s_add_u32 s40, s49, 5632
  s_memtime s[88:89]
  s_waitcnt lgkmcnt(0)
  buffer_load_dword v50, off, s[4:7], s40 sc1
  s_waitcnt vmcnt(0)
  s_memtime s[90:91]
  s_waitcnt lgkmcnt(0)
  s_sub_u32 s41, s90, s88
  s_min_u32 s60, s60, s41
  s_add_u32 s40, s49, 13824
  s_memtime s[88:89]
  s_waitcnt lgkmcnt(0)
  buffer_load_dword v50, off, s[4:7], s40 sc1
  s_waitcnt vmcnt(0)
  s_memtime s[90:91]
  s_waitcnt lgkmcnt(0)
  s_sub_u32 s41, s90, s88
  s_min_u32 s61, s61, s41
  s_add_u32 s40, s49, 5888
  s_memtime s[88:89]
  s_waitcnt lgkmcnt(0)
  buffer_load_dword v50, off, s[4:7], s40 sc1
  s_waitcnt vmcnt(0)
  s_memtime s[90:91]
  s_waitcnt lgkmcnt(0)
  s_sub_u32 s41, s90, s88
  s_min_u32 s60, s60, s41
  s_add_u32 s40, s49, 14080
  s_memtime s[88:89]
  s_waitcnt lgkmcnt(0)
  buffer_load_dword v50, off, s[4:7], s40 sc1
  s_waitcnt vmcnt(0)
  s_memtime s[90:91]
  s_waitcnt lgkmcnt(0)
  s_sub_u32 s41, s90, s88
  s_min_u32 s61, s61, s41
  s_add_u32 s40, s49, 6144
  s_memtime s[88:89]
  s_waitcnt lgkmcnt(0)
  buffer_load_dword v50, off, s[4:7], s40 sc1
  s_waitcnt vmcnt(0)
  s_memtime s[90:91]
  s_waitcnt lgkmcnt(0)
  s_sub_u32 s41, s90, s88
  s_min_u32 s60, s60, s41
  s_add_u32 s40, s49, 14336
  s_memtime s[88:89]
  s_waitcnt lgkmcnt(0)
  buffer_load_dword v50, off, s[4:7], s40 sc1
  s_waitcnt vmcnt(0)
  s_memtime s[90:91]
  s_waitcnt lgkmcnt(0)
  s_sub_u32 s41, s90, s88
  s_min_u32 s61, s61, s41
  s_add_u32 s40, s49, 6400
  s_memtime s[88:89]
  s_waitcnt lgkmcnt(0)
  buffer_load_dword v50, off, s[4:7], s40 sc1
  s_waitcnt vmcnt(0)
  s_memtime s[90:91]
  s_waitcnt lgkmcnt(0)
  s_sub_u32 s41, s90, s88
  s_min_u32 s60, s60, s41
  s_add_u32 s40, s49, 14592
  s_memtime s[88:89]
  s_waitcnt lgkmcnt(0)
  buffer_load_dword v50, off, s[4:7], s40 sc1
  s_waitcnt vmcnt(0)
  s_memtime s[90:91]
  s_waitcnt lgkmcnt(0)
  s_sub_u32 s41, s90, s88
  s_min_u32 s61, s61, s41
  s_cmp_lt_u32 s61, s60
  s_cselect_b32 s41, 2, 1
  v_and_b32 v50, 63, v0
  v_cmp_eq_u32 vcc, 0, v50
  v_mov_b32 v51, 0x7ffffff0
  v_mov_b32 v50, 192
  v_cndmask_b32 v50, v51, v50, vcc
  v_mov_b32 v51, s41
  buffer_store_dword v51, v50, s[8:11], 0 offen sc1
cal_111:
  v_and_b32 v40, 8, v0
  v_cmp_eq_u32 vcc, 0, v40
  v_mov_b32 v40, 0xeeee
  v_mov_b32 v41, 0x4444
  v_cndmask_b32 v1, v40, v41, vcc
  v_and_b32 v40, 1, v0
  v_mov_b32 v2, 0x0
  v_mad_i32_i24 v2, v40, 8, v2
  v_bfe_u32 v40, v0, 1, 1
  v_mad_i32_i24 v2, v40, 32, v2
  v_bfe_u32 v40, v0, 2, 1
  v_mad_i32_i24 v2, v40, 16, v2
  v_bfe_u32 v40, v0, 3, 1
  v_mad_i32_i24 v2, v40, 64, v2
  v_bfe_u32 v40, v0, 4, 2
  s_mov_b32 s36, 0x100
  v_mad_i32_i24 v2, v40, s36, v2
  v_bfe_u32 v40, v0, 4, 1
  v_mov_b32 v41, 0x0
  s_mov_b32 s36, 0x80
  v_mad_i32_i24 v41, v40, s36, v41
  v_xor_b32 v2, v2, v41
  v_xor_b32 v3, 128, v2
  v_and_b32 v40, 1, v0
  v_mov_b32 v5, 0x3000
  v_mad_i32_i24 v5, v40, 8, v5
  v_bfe_u32 v40, v0, 1, 1
  v_mad_i32_i24 v5, v40, 32, v5
  v_bfe_u32 v40, v0, 2, 1
  v_mad_i32_i24 v5, v40, 16, v5
  v_bfe_u32 v40, v0, 3, 1
  v_mad_i32_i24 v5, v40, 64, v5
  v_bfe_u32 v40, v0, 4, 2
  s_mov_b32 s36, 0x100
  v_mad_i32_i24 v5, v40, s36, v5
  v_bfe_u32 v40, v0, 4, 1
  v_mov_b32 v41, 0x0
  s_mov_b32 s36, 0x80
  v_mad_i32_i24 v41, v40, s36, v41
  v_xor_b32 v5, v5, v41
  v_xor_b32 v6, 128, v5
  v_and_b32 v40, 15, v0
  v_mov_b32 v4, 0x3000
  v_mad_i32_i24 v4, v40, 16, v4
  v_bfe_u32 v40, v0, 4, 1
  v_mad_i32_i24 v4, v40, 8, v4
  v_lshrrev_b32 v40, 5, v0
  s_mov_b32 s36, 0x100
  v_mad_i32_i24 v4, v40, s36, v4
  v_bfe_u32 v40, v0, 5, 1
  v_mov_b32 v41, 0x0
  s_mov_b32 s36, 0x80
  v_mad_i32_i24 v41, v40, s36, v41
  v_xor_b32 v4, v4, v41
  v_and_b32 v40, 63, v0
  v_mov_b32 v7, 0x0
  v_mad_i32_i24 v7, v40, 8, v7
  v_lshrrev_b32 v40, 6, v0
  s_mov_b32 s36, 0x400
  v_mad_i32_i24 v7, v40, s36, v7
  v_and_b32 v40, 15, v0
  v_mov_b32 v41, 0x0
  v_mad_i32_i24 v41, v40, 1, v41
  v_bfe_u32 v40, v0, 4, 1
  v_mad_i32_i24 v41, v40, 32, v41
  v_bfe_u32 v40, v0, 5, 1
  v_mad_i32_i24 v41, v40, 16, v41
  v_lshrrev_b32 v40, 6, v0
  s_mov_b32 s36, 0xa0
  v_mad_i32_i24 v41, v40, s36, v41
  s_mov_b32 s40, 3277
  v_mul_u32_u24 v40, s40, v41
  v_lshrrev_b32 v40, 16, v40
  v_mul_u32_u24 v16, 20, v40
  v_sub_u32 v41, v41, v16
  s_mov_b32 s40, 32768
  v_mul_u32_u24 v40, s40, v40
  v_lshl_add_u32 v8, v41, 4, v40
  v_and_b32 v40, 15, v0
  v_mov_b32 v41, 0x40
  v_mad_i32_i24 v41, v40, 1, v41
  v_bfe_u32 v40, v0, 4, 1
  v_mad_i32_i24 v41, v40, 32, v41
  v_bfe_u32 v40, v0, 5, 1
  v_mad_i32_i24 v41, v40, 16, v41
  v_lshrrev_b32 v40, 6, v0
  s_mov_b32 s36, 0xa0
  v_mad_i32_i24 v41, v40, s36, v41
  s_mov_b32 s40, 3277
  v_mul_u32_u24 v40, s40, v41
  v_lshrrev_b32 v40, 16, v40
  v_mul_u32_u24 v16, 20, v40
  v_sub_u32 v41, v41, v16
  s_mov_b32 s40, 32768
  v_mul_u32_u24 v40, s40, v40
  v_lshl_add_u32 v9, v41, 4, v40
  v_and_b32 v40, 15, v0
  v_mov_b32 v41, 0x80
  v_mad_i32_i24 v41, v40, 1, v41
  v_bfe_u32 v40, v0, 4, 1
  v_mad_i32_i24 v41, v40, 32, v41
  v_bfe_u32 v40, v0, 5, 1
  v_mad_i32_i24 v41, v40, 16, v41
  v_lshrrev_b32 v40, 6, v0
  s_mov_b32 s36, 0xa0
  v_mad_i32_i24 v41, v40, s36, v41
  s_mov_b32 s40, 3277
  v_mul_u32_u24 v40, s40, v41
  v_lshrrev_b32 v40, 16, v40
  v_mul_u32_u24 v16, 20, v40
  v_sub_u32 v41, v41, v16
  s_mov_b32 s40, 32768
  v_mul_u32_u24 v40, s40, v40
  v_lshl_add_u32 v10, v41, 4, v40
  v_bfe_u32 v40, v0, 4, 1
  v_cmp_eq_u32 vcc, 0, v40
  v_mov_b32 v40, 0x7ffffff0
  s_nop 0
  v_cndmask_b32 v10, v40, v10, vcc
  v_and_b32 v40, 63, v0
  v_mov_b32 v11, 0x0
  v_mad_i32_i24 v11, v40, 16, v11
  v_bfe_u32 v40, v0, 6, 1
  s_mov_b32 s36, 0xa00
  v_mad_i32_i24 v11, v40, s36, v11
  v_lshrrev_b32 v40, 7, v0
  s_mov_b32 s36, 0x4000
  v_mad_i32_i24 v11, v40, s36, v11
  v_and_b32 v40, 63, v0
  v_mov_b32 v12, 0x0
  v_mad_i32_i24 v12, v40, 16, v12
  v_lshrrev_b32 v40, 6, v0
  s_mov_b32 s36, 0xa00
  v_mad_i32_i24 v12, v40, s36, v12
  v_lshrrev_b32 v40, 1, v12
  v_and_b32 v40, 128, v40
  v_xor_b32 v12, v12, v40
  v_and_b32 v40, 32, v0
  v_cmp_eq_u32 vcc, 0, v40
  v_mov_b32 v41, 0x7ff00000
  s_nop 0
  v_cndmask_b32 v14, v41, v11, vcc
  v_add_u32 v40, 2048, v12
  v_mov_b32 v41, 16384
  v_cndmask_b32 v15, v41, v40, vcc
  v_mov_b32 v41, 0
  v_mov_b32 v40, -1
  v_cndmask_b32 v21, v41, v40, vcc
  s_cmp_lg_u32 s34, 0
  s_cbranch_scc1 pd_112
  v_mov_b32 v40, 64
poll_113:
  buffer_load_dword v41, v40, s[8:11], 0 offen sc1
  s_waitcnt vmcnt(0)
  v_cmp_gt_u32 vcc, 64, v41
  s_cbranch_vccz polled_114
  s_sleep 3
  s_add_u32 s35, s35, 1
  s_cmp_lt_u32 s35, 300000
  s_cbranch_scc1 poll_113
polled_114:
pd_112:
  s_barrier
  v_mov_b32 v40, 192
poll_116:
  buffer_load_dword v41, v40, s[8:11], 0 offen sc1
  s_waitcnt vmcnt(0)
  v_cmp_gt_u32 vcc, 1, v41
  s_cbranch_vccz polled_117
  s_sleep 3
  s_add_u32 s35, s35, 1
  s_cmp_lt_u32 s35, 300000
  s_cbranch_scc1 poll_116
polled_117:
pd_115:
  v_readfirstlane_b32 s40, v41
  s_nop 1
  s_sub_u32 s40, s40, 1
  s_and_b32 s40, s40, 1
  s_lshl_b32 s50, s40, 13
  s_add_u32 s53, s49, s50
  s_lshr_b32 s40, s47, 4
  s_lshl_b32 s40, s40, 14
  s_add_u32 s53, s53, s40
  s_and_b32 s40, s47, 15
  s_mul_i32 s40, s40, 320
  s_add_u32 s53, s53, s40
  s_xor_b32 s40, s50, 8192
  s_add_u32 s56, s49, s40
  s_add_u32 s56, s56, 0x200000
  s_cmp_lg_u32 s34, 0
  s_cbranch_scc1 pd_118
  v_mov_b32 v40, 32
poll_119:
  buffer_load_dword v41, v40, s[8:11], 0 offen sc1
  s_waitcnt vmcnt(0)
  v_cmp_gt_u32 vcc, 40, v41
  s_cbranch_vccz polled_120
  s_sleep 3
  s_add_u32 s35, s35, 1
  s_cmp_lt_u32 s35, 300000
  s_cbranch_scc1 poll_119
polled_120:
pd_118:
  s_barrier
  s_mov_b32 s44, 0
  v_mov_b32 v64, 0
  v_mov_b32 v65, 0
  v_mov_b32 v66, 0
  v_mov_b32 v67, 0
  v_mov_b32 v68, 0
  v_mov_b32 v69, 0
  v_mov_b32 v70, 0
  v_mov_b32 v71, 0
  v_mov_b32 v80, 0
  v_mov_b32 v81, 0
  v_mov_b32 v82, 0
  v_mov_b32 v83, 0
  v_mov_b32 v84, 0
  v_mov_b32 v85, 0
  v_mov_b32 v86, 0
  v_mov_b32 v87, 0
  v_mov_b32 v88, 0
  v_mov_b32 v89, 0
  v_mov_b32 v90, 0
  v_mov_b32 v91, 0
  v_mov_b32 v92, 0
  v_mov_b32 v93, 0
  v_mov_b32 v94, 0
  v_mov_b32 v95, 0
  v_mov_b32 v96, 0
  v_mov_b32 v97, 0
  v_mov_b32 v98, 0
  v_mov_b32 v99, 0
  v_mov_b32 v100, 0
  v_mov_b32 v101, 0
  v_mov_b32 v102, 0
  v_mov_b32 v103, 0
  v_mov_b32 v104, 0
  v_mov_b32 v105, 0
  v_mov_b32 v106, 0
  v_mov_b32 v107, 0
  v_mov_b32 v108, 0
  v_mov_b32 v109, 0
  v_mov_b32 v110, 0
  v_mov_b32 v111, 0
  v_mov_b32 v112, 0
  v_mov_b32 v113, 0
  v_mov_b32 v114, 0
  v_mov_b32 v115, 0
  v_mov_b32 v116, 0
  v_mov_b32 v117, 0
  v_mov_b32 v118, 0
  v_mov_b32 v119, 0
  s_waitcnt vmcnt(0) lgkmcnt(0)
B_step:
  s_barrier
  ds_read_b64_tr_b16 v[24:25], v2 offset:0
  ds_read_b64_tr_b16 v[26:27], v3 offset:0
  ds_read_b64_tr_b16 v[28:29], v2 offset:1024
  ds_read_b64_tr_b16 v[30:31], v3 offset:1024
  ds_read_b64_tr_b16 v[32:33], v2 offset:2048
  ds_read_b64_tr_b16 v[34:35], v3 offset:2048
  ds_read_b64_tr_b16 v[36:37], v2 offset:3072
  ds_read_b64_tr_b16 v[38:39], v3 offset:3072
  ds_read_b64_tr_b16 v[40:41], v2 offset:4096
  ds_read_b64_tr_b16 v[42:43], v3 offset:4096
  ds_read_b64_tr_b16 v[44:45], v2 offset:5120
  ds_read_b64_tr_b16 v[46:47], v3 offset:5120
  s_lshr_b32 s45, s44, 1
  s_and_b32 s45, s45, 1
  s_and_b32 s46, s44, 1
  v_mov_b32 v13, s45
  s_waitcnt lgkmcnt(10)
  v_smfmac_f32_16x16x64_bf16 v[64:67], v[24:27], a[0:7], v1
  ds_read_b64_tr_b16 v[48:49], v2 offset:6144
  v_smfmac_f32_16x16x64_bf16 v[68:71], v[24:27], a[80:87], v1
  ds_read_b64_tr_b16 v[50:51], v3 offset:6144
  s_waitcnt lgkmcnt(10)
  v_smfmac_f32_16x16x64_bf16 v[64:67], v[28:31], a[8:15], v1
  ds_read_b64_tr_b16 v[52:53], v2 offset:7168
  v_smfmac_f32_16x16x64_bf16 v[68:71], v[28:31], a[88:95], v1
  ds_read_b64_tr_b16 v[54:55], v3 offset:7168
  s_waitcnt lgkmcnt(10)
  v_smfmac_f32_16x16x64_bf16 v[64:67], v[32:35], a[16:23], v1
  ds_read_b64_tr_b16 v[56:57], v2 offset:8192
  v_smfmac_f32_16x16x64_bf16 v[68:71], v[32:35], a[96:103], v1
  ds_read_b64_tr_b16 v[58:59], v3 offset:8192
  s_waitcnt lgkmcnt(10)
  v_smfmac_f32_16x16x64_bf16 v[64:67], v[36:39], a[24:31], v1
  ds_read_b64_tr_b16 v[60:61], v2 offset:9216
  v_smfmac_f32_16x16x64_bf16 v[68:71], v[36:39], a[104:111], v1
  ds_read_b64_tr_b16 v[62:63], v3 offset:9216
  s_waitcnt lgkmcnt(10)
  v_smfmac_f32_16x16x64_bf16 v[64:67], v[40:43], a[32:39], v1
  v_smfmac_f32_16x16x64_bf16 v[68:71], v[40:43], a[112:119], v1
  s_waitcnt lgkmcnt(8)
  v_smfmac_f32_16x16x64_bf16 v[64:67], v[44:47], a[40:47], v1
  v_smfmac_f32_16x16x64_bf16 v[68:71], v[44:47], a[120:127], v1
  s_waitcnt lgkmcnt(6)
  v_smfmac_f32_16x16x64_bf16 v[64:67], v[48:51], a[48:55], v1
  v_smfmac_f32_16x16x64_bf16 v[68:71], v[48:51], a[128:135], v1
  s_waitcnt lgkmcnt(4)
  v_smfmac_f32_16x16x64_bf16 v[64:67], v[52:55], a[56:63], v1
  v_smfmac_f32_16x16x64_bf16 v[68:71], v[52:55], a[136:143], v1
  s_waitcnt lgkmcnt(2)
  v_smfmac_f32_16x16x64_bf16 v[64:67], v[56:59], a[64:71], v1
  v_smfmac_f32_16x16x64_bf16 v[68:71], v[56:59], a[144:151], v1
  s_waitcnt lgkmcnt(0)
  v_smfmac_f32_16x16x64_bf16 v[64:67], v[60:63], a[72:79], v1
  v_smfmac_f32_16x16x64_bf16 v[68:71], v[60:63], a[152:159], v1
  s_lshl_b32 s40, s44, 5
  s_add_u32 s40, s40, s47
  s_lshl_b32 s40, s40, 12
  s_add_u32 s62, s40, 100663296
  v_cvt_pk_bf16_f32 v72, v64, v65
  v_cvt_pk_bf16_f32 v73, v66, v67
  s_nop 1
  v_cvt_pk_bf16_f32 v74, v68, v69
  v_cvt_pk_bf16_f32 v75, v70, v71
  v_permlane32_swap_b32 v64, v68
  v_permlane32_swap_b32 v65, v69
  v_permlane32_swap_b32 v66, v70
  v_permlane32_swap_b32 v67, v71
  v_pk_add_f32 v[64:65], v[64:65], v[68:69]
  v_pk_add_f32 v[66:67], v[66:67], v[70:71]
  v_cvt_pk_bf16_f32 v16, v64, v65
  v_cvt_pk_bf16_f32 v17, v66, v67
  ds_write_b64 v4, v[16:17]
  s_cmp_eq_u32 s44, 63
  s_cbranch_scc1 B_last
  s_lshl_b32 s40, s46, 20
  s_add_u32 s60, s40, s53
  s_waitcnt lgkmcnt(0)
  s_barrier
  ds_read_b64_tr_b16 v[24:25], v5 offset:0
  ds_read_b64_tr_b16 v[26:27], v6 offset:0
  ds_read_b64_tr_b16 v[28:29], v5 offset:1024
  ds_read_b64_tr_b16 v[30:31], v6 offset:1024
  s_waitcnt lgkmcnt(0)
  v_smfmac_f32_16x16x64_bf16 v[80:83], v[24:27], a[160:167], v1
  v_smfmac_f32_16x16x64_bf16 v[80:83], v[28:31], a[240:247], v1
  v_smfmac_f32_16x16x64_bf16 v[84:87], v[24:27], a[168:175], v1
  v_smfmac_f32_16x16x64_bf16 v[84:87], v[28:31], a[248:255], v1
  v_smfmac_f32_16x16x64_bf16 v[88:91], v[24:27], a[176:183], v1
  v_smfmac_f32_16x16x64_bf16 v[88:91], v[28:31], v[192:199], v1
  v_smfmac_f32_16x16x64_bf16 v[92:95], v[24:27], a[184:191], v1
  v_smfmac_f32_16x16x64_bf16 v[92:95], v[28:31], v[200:207], v1
  v_permlane32_swap_b32 v80, v84
  v_permlane32_swap_b32 v81, v85
  v_permlane32_swap_b32 v82, v86
  v_permlane32_swap_b32 v83, v87
  v_pk_add_f32 v[80:81], v[80:81], v[84:85]
  v_pk_add_f32 v[82:83], v[82:83], v[86:87]
  v_smfmac_f32_16x16x64_bf16 v[96:99], v[24:27], a[192:199], v1
  v_cvt_pk_bf16_f32 v120, v80, v81
  v_smfmac_f32_16x16x64_bf16 v[96:99], v[28:31], v[208:215], v1
  v_cvt_pk_bf16_f32 v121, v82, v83
  v_smfmac_f32_16x16x64_bf16 v[100:103], v[24:27], a[200:207], v1
  v_smfmac_f32_16x16x64_bf16 v[100:103], v[28:31], v[216:223], v1
  v_permlane32_swap_b32 v88, v92
  v_permlane32_swap_b32 v89, v93
  v_permlane32_swap_b32 v90, v94
  v_permlane32_swap_b32 v91, v95
  v_pk_add_f32 v[88:89], v[88:89], v[92:93]
  v_pk_add_f32 v[90:91], v[90:91], v[94:95]
  v_smfmac_f32_16x16x64_bf16 v[104:107], v[24:27], a[208:215], v1
  v_cvt_pk_bf16_f32 v122, v88, v89
  v_smfmac_f32_16x16x64_bf16 v[104:107], v[28:31], v[224:231], v1
  v_cvt_pk_bf16_f32 v123, v90, v91
  v_smfmac_f32_16x16x64_bf16 v[108:111], v[24:27], a[216:223], v1
  s_nop 0
  v_smfmac_f32_16x16x64_bf16 v[108:111], v[28:31], v[232:239], v1
  v_permlane16_swap_b32 v120, v122
  v_permlane16_swap_b32 v121, v123
  v_and_or_b32 v120, v120, -2, v13
  buffer_store_dwordx4 v[120:123], v8, s[4:7], s60 offen sc1
  v_permlane32_swap_b32 v96, v100
  v_permlane32_swap_b32 v97, v101
  v_permlane32_swap_b32 v98, v102
  v_permlane32_swap_b32 v99, v103
  v_pk_add_f32 v[96:97], v[96:97], v[100:101]
  v_pk_add_f32 v[98:99], v[98:99], v[102:103]
  v_smfmac_f32_16x16x64_bf16 v[112:115], v[24:27], a[224:231], v1
  v_cvt_pk_bf16_f32 v124, v96, v97
  v_smfmac_f32_16x16x64_bf16 v[112:115], v[28:31], v[240:247], v1
  v_cvt_pk_bf16_f32 v125, v98, v99
  v_smfmac_f32_16x16x64_bf16 v[116:119], v[24:27], a[232:239], v1
  v_smfmac_f32_16x16x64_bf16 v[116:119], v[28:31], v[248:255], v1
  v_permlane32_swap_b32 v104, v108
  v_permlane32_swap_b32 v105, v109
  v_permlane32_swap_b32 v106, v110
  v_permlane32_swap_b32 v107, v111
  v_pk_add_f32 v[104:105], v[104:105], v[108:109]
  v_pk_add_f32 v[106:107], v[106:107], v[110:111]
  v_cvt_pk_bf16_f32 v126, v104, v105
  v_cvt_pk_bf16_f32 v127, v106, v107
  s_nop 0
  v_permlane16_swap_b32 v124, v126
  v_permlane16_swap_b32 v125, v127
  v_and_or_b32 v124, v124, -2, v13
  buffer_store_dwordx4 v[124:127], v9, s[4:7], s60 offen sc1
  v_permlane32_swap_b32 v112, v116
  v_permlane32_swap_b32 v113, v117
  v_permlane32_swap_b32 v114, v118
  v_permlane32_swap_b32 v115, v119
  v_pk_add_f32 v[112:113], v[112:113], v[116:117]
  v_pk_add_f32 v[114:115], v[114:115], v[118:119]
  v_cvt_pk_bf16_f32 v120, v112, v113
  v_cvt_pk_bf16_f32 v121, v114, v115
  v_mov_b32 v122, v120
  v_mov_b32 v123, v121
  s_nop 0
  v_permlane16_swap_b32 v120, v122
  v_permlane16_swap_b32 v121, v123
  v_and_or_b32 v120, v120, -2, v13
  buffer_store_dwordx4 v[120:123], v10, s[4:7], s60 offen sc1
  buffer_store_dwordx2 v[72:73], v7, s[4:7], s62 offen offset:0 sc1
  buffer_store_dwordx2 v[74:75], v7, s[4:7], s62 offen offset:512 sc1
  s_add_u32 s44, s44, 1
  v_mov_b64 v[64:65], 0
  v_mov_b64 v[66:67], 0
  v_mov_b64 v[68:69], 0
  v_mov_b64 v[70:71], 0
  v_mov_b64 v[80:81], 0
  v_mov_b64 v[82:83], 0
  v_mov_b64 v[84:85], 0
  v_mov_b64 v[86:87], 0
  v_mov_b64 v[88:89], 0
  v_mov_b64 v[90:91], 0
  v_mov_b64 v[92:93], 0
  v_mov_b64 v[94:95], 0
  v_mov_b64 v[96:97], 0
  v_mov_b64 v[98:99], 0
  v_mov_b64 v[100:101], 0
  v_mov_b64 v[102:103], 0
  v_mov_b64 v[104:105], 0
  v_mov_b64 v[106:107], 0
  v_mov_b64 v[108:109], 0
  v_mov_b64 v[110:111], 0
  v_mov_b64 v[112:113], 0
  v_mov_b64 v[114:115], 0
  v_mov_b64 v[116:117], 0
  v_mov_b64 v[118:119], 0
  s_lshl_b32 s40, s46, 15
  s_add_u32 s60, s40, s56
  s_waitcnt vmcnt(0)
  s_barrier
  s_cmp_lg_u32 s34, 3
  s_cbranch_scc1 novf_121
  s_lshl_b32 s40, s47, 8
  s_add_u32 s40, s40, 24704
  v_and_b32 v16, 63, v0
  v_cmp_eq_u32 vcc, 0, v16
  v_mov_b32 v17, 0x7ffffff0
  s_nop 0
  v_cndmask_b32 v16, v17, 0, vcc
  v_mov_b32 v17, s44
  buffer_store_dword v17, v16, s[4:7], s40 offen sc1
novf_121:
  s_sleep 8
bgat_122:
  buffer_load_dwordx4 v[128:131], v11, s[4:7], s60 offen offset:0 sc1
  buffer_load_dwordx4 v[132:135], v11, s[4:7], s60 offen offset:1024 sc1
  buffer_load_dwordx4 v[136:139], v14, s[4:7], s60 offen offset:2048 sc1
  s_waitcnt vmcnt(0)
  v_xor_b32 v16, v13, v128
  v_bitop3_b32 v16, v16, v132, v13 bitop3:0xf6
  v_xor_b32 v17, v13, v136
  v_and_b32 v17, v21, v17
  v_or_b32 v16, v16, v17
  v_and_b32 v16, 1, v16
  v_cmp_ne_u32 vcc, 0, v16
  s_sleep 1
  s_cbranch_vccz bgatd_123
  s_add_u32 s35, s35, 1
  s_cmp_lt_u32 s35, 300000
  s_cbranch_scc1 bgat_122
bgatd_123:
  ds_write_b128 v12, v[128:131] offset:0
  ds_write_b128 v12, v[132:135] offset:1024
  ds_write_b128 v15, v[136:139]
  s_waitcnt lgkmcnt(0)
  s_branch B_step
B_last:
  buffer_store_dwordx2 v[72:73], v7, s[4:7], s62 offen offset:0 sc1
  buffer_store_dwordx2 v[74:75], v7, s[4:7], s62 offen offset:512 sc1
  s_waitcnt vmcnt(0) lgkmcnt(0)
  s_barrier
  s_cmp_lg_u32 s34, 3
  s_cbranch_scc1 novf_124
  s_lshl_b32 s40, s47, 8
  s_add_u32 s40, s40, 24704
  v_and_b32 v16, 63, v0
  v_cmp_eq_u32 vcc, 0, v16
  v_mov_b32 v17, 0x7ffffff0
  s_nop 0
  v_cndmask_b32 v16, v17, 0, vcc
  v_mov_b32 v17, 64
  buffer_store_dword v17, v16, s[4:7], s40 offen sc1
novf_124:
  s_mov_b32 s80, 5
L_w2:
  s_lshr_b32 s44, s32, 1
  s_lshl_b32 s44, s44, 3
  s_lshr_b32 s40, s33, 2
  s_add_u32 s44, s44, s40
  s_and_b32 s45, s32, 1
  s_lshl_b32 s45, s45, 2
  s_and_b32 s40, s33, 3
  s_add_u32 s45, s45, s40
  s_mul_i32 s46, s34, 14
  s_cmp_eq_u32 s34, 3
  s_cselect_b32 s40, 1, 0
  s_sub_u32 s46, s46, s40
  s_load_dwordx2 s[12:13], s[0:1], 80
  s_mov_b32 s14, 0x6c0000
  s_mov_b32 s15, 0x00020000
  s_barrier
  v_and_b32 v13, 7, v0
  v_mov_b32 v8, 0x0
  v_mad_i32_i24 v8, v13, 16, v8
  v_bfe_u32 v13, v0, 4, 2
  v_mov_b32 v9, 0x0
  v_mad_i32_i24 v9, v13, 32, v9
  v_xor_b32 v8, v8, v9
  v_bfe_u32 v13, v0, 3, 3
  v_mov_b32 v9, 0x0
  s_mov_b32 s36, 0x1000
  v_mad_i32_i24 v9, v13, s36, v9
  v_add_u32 v8, v8, v9
  v_and_b32 v13, 3, v0
  v_mov_b32 v9, 0x0
  v_mad_i32_i24 v9, v13, 8, v9
  v_bfe_u32 v13, v0, 2, 4
  s_mov_b32 s36, 0x80
  v_mad_i32_i24 v9, v13, s36, v9
  v_lshrrev_b32 v13, 6, v0
  s_mov_b32 s36, 0x8000
  v_mad_i32_i24 v9, v13, s36, v9
  v_bfe_u32 v13, v0, 3, 2
  v_mov_b32 v10, 0x0
  v_mad_i32_i24 v10, v13, 32, v10
  v_add_u32 v9, v9, v10
  v_xor_b32 v10, 32, v9
  v_xor_b32 v11, 64, v9
  v_xor_b32 v12, 96, v9
  s_mul_i32 s41, s46, 131072
  s_lshl_b32 s40, s44, 7
  s_add_u32 s41, s41, s40
  s_waitcnt lgkmcnt(0)
  s_mul_i32 s42, s34, 32768
  s_mov_b32 m0, s42
  s_nop 0
  buffer_load_dwordx4 v8, s[12:15], s41 offen lds
  s_add_u32 s41, s41, 32768
  s_add_u32 s42, s42, 1024
  s_mov_b32 m0, s42
  s_nop 0
  buffer_load_dwordx4 v8, s[12:15], s41 offen lds
  s_add_u32 s41, s41, 32768
  s_add_u32 s42, s42, 1024
  s_mov_b32 m0, s42
  s_nop 0
  buffer_load_dwordx4 v8, s[12:15], s41 offen lds
  s_add_u32 s41, s41, 32768
  s_add_u32 s42, s42, 1024
  s_mov_b32 m0, s42
  s_nop 0
  buffer_load_dwordx4 v8, s[12:15], s41 offen lds
  s_add_u32 s41, s41, 32768
  s_add_u32 s42, s42, 1024
  s_mov_b32 m0, s42
  s_nop 0
  buffer_load_dwordx4 v8, s[12:15], s41 offen lds
  s_add_u32 s41, s41, 32768
  s_add_u32 s42, s42, 1024
  s_mov_b32 m0, s42
  s_nop 0
  buffer_load_dwordx4 v8, s[12:15], s41 offen lds
  s_add_u32 s41, s41, 32768
  s_add_u32 s42, s42, 1024
  s_mov_b32 m0, s42
  s_nop 0
  buffer_load_dwordx4 v8, s[12:15], s41 offen lds
  s_add_u32 s41, s41, 32768
  s_add_u32 s42, s42, 1024
  s_mov_b32 m0, s42
  s_nop 0
  buffer_load_dwordx4 v8, s[12:15], s41 offen lds
  s_add_u32 s41, s41, 32768
  s_add_u32 s42, s42, 1024
  s_mov_b32 m0, s42
  s_nop 0
  buffer_load_dwordx4 v8, s[12:15], s41 offen lds
  s_add_u32 s41, s41, 32768
  s_add_u32 s42, s42, 1024
  s_mov_b32 m0, s42
  s_nop 0
  buffer_load_dwordx4 v8, s[12:15], s41 offen lds
  s_add_u32 s41, s41, 32768
  s_add_u32 s42, s42, 1024
  s_mov_b32 m0, s42
  s_nop 0
  buffer_load_dwordx4 v8, s[12:15], s41 offen lds
  s_add_u32 s41, s41, 32768
  s_add_u32 s42, s42, 1024
  s_mov_b32 m0, s42
  s_nop 0
  buffer_load_dwordx4 v8, s[12:15], s41 offen lds
  s_add_u32 s41, s41, 32768
  s_add_u32 s42, s42, 1024
  s_mov_b32 m0, s42
  s_nop 0
  buffer_load_dwordx4 v8, s[12:15], s41 offen lds
  s_add_u32 s41, s41, 32768
  s_add_u32 s42, s42, 1024
  s_mov_b32 m0, s42
  s_nop 0
  buffer_load_dwordx4 v8, s[12:15], s41 offen lds
  s_add_u32 s41, s41, 32768
  s_add_u32 s42, s42, 1024
  s_mov_b32 m0, s42
  s_nop 0
  buffer_load_dwordx4 v8, s[12:15], s41 offen lds
  s_add_u32 s41, s41, 32768
  s_add_u32 s42, s42, 1024
  s_mov_b32 m0, s42
  s_nop 0
  buffer_load_dwordx4 v8, s[12:15], s41 offen lds
  s_add_u32 s41, s41, 32768
  s_add_u32 s42, s42, 1024
  s_mov_b32 m0, s42
  s_nop 0
  buffer_load_dwordx4 v8, s[12:15], s41 offen lds
  s_add_u32 s41, s41, 32768
  s_add_u32 s42, s42, 1024
  s_mov_b32 m0, s42
  s_nop 0
  buffer_load_dwordx4 v8, s[12:15], s41 offen lds
  s_add_u32 s41, s41, 32768
  s_add_u32 s42, s42, 1024
  s_mov_b32 m0, s42
  s_nop 0
  buffer_load_dwordx4 v8, s[12:15], s41 offen lds
  s_add_u32 s41, s41, 32768
  s_add_u32 s42, s42, 1024
  s_mov_b32 m0, s42
  s_nop 0
  buffer_load_dwordx4 v8, s[12:15], s41 offen lds
  s_add_u32 s41, s41, 32768
  s_add_u32 s42, s42, 1024
  s_mov_b32 m0, s42
  s_nop 0
  buffer_load_dwordx4 v8, s[12:15], s41 offen lds
  s_add_u32 s41, s41, 32768
  s_add_u32 s42, s42, 1024
  s_mov_b32 m0, s42
  s_nop 0
  buffer_load_dwordx4 v8, s[12:15], s41 offen lds
  s_add_u32 s41, s41, 32768
  s_add_u32 s42, s42, 1024
  s_mov_b32 m0, s42
  s_nop 0
  buffer_load_dwordx4 v8, s[12:15], s41 offen lds
  s_add_u32 s41, s41, 32768
  s_add_u32 s42, s42, 1024
  s_mov_b32 m0, s42
  s_nop 0
  buffer_load_dwordx4 v8, s[12:15], s41 offen lds
  s_add_u32 s41, s41, 32768
  s_add_u32 s42, s42, 1024
  s_mov_b32 m0, s42
  s_nop 0
  buffer_load_dwordx4 v8, s[12:15], s41 offen lds
  s_add_u32 s41, s41, 32768
  s_add_u32 s42, s42, 1024
  s_mov_b32 m0, s42
  s_nop 0
  buffer_load_dwordx4 v8, s[12:15], s41 offen lds
  s_add_u32 s41, s41, 32768
  s_add_u32 s42, s42, 1024
  s_mov_b32 m0, s42
  s_nop 0
  buffer_load_dwordx4 v8, s[12:15], s41 offen lds
  s_add_u32 s41, s41, 32768
  s_add_u32 s42, s42, 1024
  s_mov_b32 m0, s42
  s_nop 0
  buffer_load_dwordx4 v8, s[12:15], s41 offen lds
  s_add_u32 s41, s41, 32768
  s_add_u32 s42, s42, 1024
  s_waitcnt vmcnt(0)
  ds_read_b64_tr_b16 a[0:1], v9 offset:0
  ds_read_b64_tr_b16 a[2:3], v9 offset:2048
  ds_read_b64_tr_b16 a[56:57], v10 offset:0
  ds_read_b64_tr_b16 a[58:59], v10 offset:2048
  ds_read_b64_tr_b16 a[112:113], v11 offset:0
  ds_read_b64_tr_b16 a[114:115], v11 offset:2048
  ds_read_b64_tr_b16 a[168:169], v12 offset:0
  ds_read_b64_tr_b16 a[170:171], v12 offset:2048
  ds_read_b64_tr_b16 a[4:5], v9 offset:4096
  ds_read_b64_tr_b16 a[6:7], v9 offset:6144
  ds_read_b64_tr_b16 a[60:61], v10 offset:4096
  ds_read_b64_tr_b16 a[62:63], v10 offset:6144
  ds_read_b64_tr_b16 a[116:117], v11 offset:4096
  ds_read_b64_tr_b16 a[118:119], v11 offset:6144
  ds_read_b64_tr_b16 a[172:173], v12 offset:4096
  ds_read_b64_tr_b16 a[174:175], v12 offset:6144
  ds_read_b64_tr_b16 a[8:9], v9 offset:8192
  ds_read_b64_tr_b16 a[10:11], v9 offset:10240
  ds_read_b64_tr_b16 a[64:65], v10 offset:8192
  ds_read_b64_tr_b16 a[66:67], v10 offset:10240
  ds_read_b64_tr_b16 a[120:121], v11 offset:8192
  ds_read_b64_tr_b16 a[122:123], v11 offset:10240
  ds_read_b64_tr_b16 a[176:177], v12 offset:8192
  ds_read_b64_tr_b16 a[178:179], v12 offset:10240
  ds_read_b64_tr_b16 a[12:13], v9 offset:12288
  ds_read_b64_tr_b16 a[14:15], v9 offset:14336
  ds_read_b64_tr_b16 a[68:69], v10 offset:12288
  ds_read_b64_tr_b16 a[70:71], v10 offset:14336
  ds_read_b64_tr_b16 a[124:125], v11 offset:12288
  ds_read_b64_tr_b16 a[126:127], v11 offset:14336
  ds_read_b64_tr_b16 a[180:181], v12 offset:12288
  ds_read_b64_tr_b16 a[182:183], v12 offset:14336
  ds_read_b64_tr_b16 a[16:17], v9 offset:16384
  ds_read_b64_tr_b16 a[18:19], v9 offset:18432
  ds_read_b64_tr_b16 a[72:73], v10 offset:16384
  ds_read_b64_tr_b16 a[74:75], v10 offset:18432
  ds_read_b64_tr_b16 a[128:129], v11 offset:16384
  ds_read_b64_tr_b16 a[130:131], v11 offset:18432
  ds_read_b64_tr_b16 a[184:185], v12 offset:16384
  ds_read_b64_tr_b16 a[186:187], v12 offset:18432
  ds_read_b64_tr_b16 a[20:21], v9 offset:20480
  ds_read_b64_tr_b16 a[22:23], v9 offset:22528
  ds_read_b64_tr_b16 a[76:77], v10 offset:20480
  ds_read_b64_tr_b16 a[78:79], v10 offset:22528
  ds_read_b64_tr_b16 a[132:133], v11 offset:20480
  ds_read_b64_tr_b16 a[134:135], v11 offset:22528
  ds_read_b64_tr_b16 a[188:189], v12 offset:20480
  ds_read_b64_tr_b16 a[190:191], v12 offset:22528
  ds_read_b64_tr_b16 a[24:25], v9 offset:24576
  ds_read_b64_tr_b16 a[26:27], v9 offset:26624
  ds_read_b64_tr_b16 a[80:81], v10 offset:24576
  ds_read_b64_tr_b16 a[82:83], v10 offset:26624
  ds_read_b64_tr_b16 a[136:137], v11 offset:24576
  ds_read_b64_tr_b16 a[138:139], v11 offset:26624
  ds_read_b64_tr_b16 a[192:193], v12 offset:24576
  ds_read_b64_tr_b16 a[194:195], v12 offset:26624
  s_waitcnt lgkmcnt(0)
  s_mul_i32 s42, s34, 32768
  s_mov_b32 m0, s42
  s_nop 0
  buffer_load_dwordx4 v8, s[12:15], s41 offen lds
  s_add_u32 s41, s41, 32768
  s_add_u32 s42, s42, 1024
  s_mov_b32 m0, s42
  s_nop 0
  buffer_load_dwordx4 v8, s[12:15], s41 offen lds
  s_add_u32 s41, s41, 32768
  s_add_u32 s42, s42, 1024
  s_mov_b32 m0, s42
  s_nop 0
  buffer_load_dwordx4 v8, s[12:15], s41 offen lds
  s_add_u32 s41, s41, 32768
  s_add_u32 s42, s42, 1024
  s_mov_b32 m0, s42
  s_nop 0
  buffer_load_dwordx4 v8, s[12:15], s41 offen lds
  s_add_u32 s41, s41, 32768
  s_add_u32 s42, s42, 1024
  s_mov_b32 m0, s42
  s_nop 0
  buffer_load_dwordx4 v8, s[12:15], s41 offen lds
  s_add_u32 s41, s41, 32768
  s_add_u32 s42, s42, 1024
  s_mov_b32 m0, s42
  s_nop 0
  buffer_load_dwordx4 v8, s[12:15], s41 offen lds
  s_add_u32 s41, s41, 32768
  s_add_u32 s42, s42, 1024
  s_mov_b32 m0, s42
  s_nop 0
  buffer_load_dwordx4 v8, s[12:15], s41 offen lds
  s_add_u32 s41, s41, 32768
  s_add_u32 s42, s42, 1024
  s_mov_b32 m0, s42
  s_nop 0
  buffer_load_dwordx4 v8, s[12:15], s41 offen lds
  s_add_u32 s41, s41, 32768
  s_add_u32 s42, s42, 1024
  s_mov_b32 m0, s42
  s_nop 0
  buffer_load_dwordx4 v8, s[12:15], s41 offen lds
  s_add_u32 s41, s41, 32768
  s_add_u32 s42, s42, 1024
  s_mov_b32 m0, s42
  s_nop 0
  buffer_load_dwordx4 v8, s[12:15], s41 offen lds
  s_add_u32 s41, s41, 32768
  s_add_u32 s42, s42, 1024
  s_mov_b32 m0, s42
  s_nop 0
  buffer_load_dwordx4 v8, s[12:15], s41 offen lds
  s_add_u32 s41, s41, 32768
  s_add_u32 s42, s42, 1024
  s_mov_b32 m0, s42
  s_nop 0
  buffer_load_dwordx4 v8, s[12:15], s41 offen lds
  s_add_u32 s41, s41, 32768
  s_add_u32 s42, s42, 1024
  s_mov_b32 m0, s42
  s_nop 0
  buffer_load_dwordx4 v8, s[12:15], s41 offen lds
  s_add_u32 s41, s41, 32768
  s_add_u32 s42, s42, 1024
  s_mov_b32 m0, s42
  s_nop 0
  buffer_load_dwordx4 v8, s[12:15], s41 offen lds
  s_add_u32 s41, s41, 32768
  s_add_u32 s42, s42, 1024
  s_mov_b32 m0, s42
  s_nop 0
  buffer_load_dwordx4 v8, s[12:15], s41 offen lds
  s_add_u32 s41, s41, 32768
  s_add_u32 s42, s42, 1024
  s_mov_b32 m0, s42
  s_nop 0
  buffer_load_dwordx4 v8, s[12:15], s41 offen lds
  s_add_u32 s41, s41, 32768
  s_add_u32 s42, s42, 1024
  s_mov_b32 m0, s42
  s_nop 0
  buffer_load_dwordx4 v8, s[12:15], s41 offen lds
  s_add_u32 s41, s41, 32768
  s_add_u32 s42, s42, 1024
  s_mov_b32 m0, s42
  s_nop 0
  buffer_load_dwordx4 v8, s[12:15], s41 offen lds
  s_add_u32 s41, s41, 32768
  s_add_u32 s42, s42, 1024
  s_mov_b32 m0, s42
  s_nop 0
  buffer_load_dwordx4 v8, s[12:15], s41 offen lds
  s_add_u32 s41, s41, 32768
  s_add_u32 s42, s42, 1024
  s_mov_b32 m0, s42
  s_nop 0
  buffer_load_dwordx4 v8, s[12:15], s41 offen lds
  s_add_u32 s41, s41, 32768
  s_add_u32 s42, s42, 1024
  s_mov_b32 m0, s42
  s_nop 0
  buffer_load_dwordx4 v8, s[12:15], s41 offen lds
  s_add_u32 s41, s41, 32768
  s_add_u32 s42, s42, 1024
  s_mov_b32 m0, s42
  s_nop 0
  buffer_load_dwordx4 v8, s[12:15], s41 offen lds
  s_add_u32 s41, s41, 32768
  s_add_u32 s42, s42, 1024
  s_mov_b32 m0, s42
  s_nop 0
  buffer_load_dwordx4 v8, s[12:15], s41 offen lds
  s_add_u32 s41, s41, 32768
  s_add_u32 s42, s42, 1024
  s_mov_b32 m0, s42
  s_nop 0
  buffer_load_dwordx4 v8, s[12:15], s41 offen lds
  s_add_u32 s41, s41, 32768
  s_add_u32 s42, s42, 1024
  s_mov_b32 m0, s42
  s_nop 0
  buffer_load_dwordx4 v8, s[12:15], s41 offen lds
  s_add_u32 s41, s41, 32768
  s_add_u32 s42, s42, 1024
  s_mov_b32 m0, s42
  s_nop 0
  buffer_load_dwordx4 v8, s[12:15], s41 offen lds
  s_add_u32 s41, s41, 32768
  s_add_u32 s42, s42, 1024
  s_mov_b32 m0, s42
  s_nop 0
  buffer_load_dwordx4 v8, s[12:15], s41 offen lds
  s_add_u32 s41, s41, 32768
  s_add_u32 s42, s42, 1024
  s_mov_b32 m0, s42
  s_nop 0
  buffer_load_dwordx4 v8, s[12:15], s41 offen lds
  s_add_u32 s41, s41, 32768
  s_add_u32 s42, s42, 1024
  s_waitcnt vmcnt(0)
  ds_read_b64_tr_b16 a[28:29], v9 offset:0
  ds_read_b64_tr_b16 a[30:31], v9 offset:2048
  ds_read_b64_tr_b16 a[84:85], v10 offset:0
  ds_read_b64_tr_b16 a[86:87], v10 offset:2048
  ds_read_b64_tr_b16 a[140:141], v11 offset:0
  ds_read_b64_tr_b16 a[142:143], v11 offset:2048
  ds_read_b64_tr_b16 a[196:197], v12 offset:0
  ds_read_b64_tr_b16 a[198:199], v12 offset:2048
  ds_read_b64_tr_b16 a[32:33], v9 offset:4096
  ds_read_b64_tr_b16 a[34:35], v9 offset:6144
  ds_read_b64_tr_b16 a[88:89], v10 offset:4096
  ds_read_b64_tr_b16 a[90:91], v10 offset:6144
  ds_read_b64_tr_b16 a[144:145], v11 offset:4096
  ds_read_b64_tr_b16 a[146:147], v11 offset:6144
  ds_read_b64_tr_b16 a[200:201], v12 offset:4096
  ds_read_b64_tr_b16 a[202:203], v12 offset:6144
  ds_read_b64_tr_b16 a[36:37], v9 offset:8192
  ds_read_b64_tr_b16 a[38:39], v9 offset:10240
  ds_read_b64_tr_b16 a[92:93], v10 offset:8192
  ds_read_b64_tr_b16 a[94:95], v10 offset:10240
  ds_read_b64_tr_b16 a[148:149], v11 offset:8192
  ds_read_b64_tr_b16 a[150:151], v11 offset:10240
  ds_read_b64_tr_b16 a[204:205], v12 offset:8192
  ds_read_b64_tr_b16 a[206:207], v12 offset:10240
  ds_read_b64_tr_b16 a[40:41], v9 offset:12288
  ds_read_b64_tr_b16 a[42:43], v9 offset:14336
  ds_read_b64_tr_b16 a[96:97], v10 offset:12288
  ds_read_b64_tr_b16 a[98:99], v10 offset:14336
  ds_read_b64_tr_b16 a[152:153], v11 offset:12288
  ds_read_b64_tr_b16 a[154:155], v11 offset:14336
  ds_read_b64_tr_b16 a[208:209], v12 offset:12288
  ds_read_b64_tr_b16 a[210:211], v12 offset:14336
  ds_read_b64_tr_b16 a[44:45], v9 offset:16384
  ds_read_b64_tr_b16 a[46:47], v9 offset:18432
  ds_read_b64_tr_b16 a[100:101], v10 offset:16384
  ds_read_b64_tr_b16 a[102:103], v10 offset:18432
  ds_read_b64_tr_b16 a[156:157], v11 offset:16384
  ds_read_b64_tr_b16 a[158:159], v11 offset:18432
  ds_read_b64_tr_b16 a[212:213], v12 offset:16384
  ds_read_b64_tr_b16 a[214:215], v12 offset:18432
  ds_read_b64_tr_b16 a[48:49], v9 offset:20480
  ds_read_b64_tr_b16 a[50:51], v9 offset:22528
  ds_read_b64_tr_b16 a[104:105], v10 offset:20480
  ds_read_b64_tr_b16 a[106:107], v10 offset:22528
  ds_read_b64_tr_b16 a[160:161], v11 offset:20480
  ds_read_b64_tr_b16 a[162:163], v11 offset:22528
  ds_read_b64_tr_b16 a[216:217], v12 offset:20480
  ds_read_b64_tr_b16 a[218:219], v12 offset:22528
  ds_read_b64_tr_b16 a[52:53], v9 offset:24576
  ds_read_b64_tr_b16 a[54:55], v9 offset:26624
  ds_read_b64_tr_b16 a[108:109], v10 offset:24576
  ds_read_b64_tr_b16 a[110:111], v10 offset:26624
  ds_read_b64_tr_b16 a[164:165], v11 offset:24576
  ds_read_b64_tr_b16 a[166:167], v11 offset:26624
  ds_read_b64_tr_b16 a[220:221], v12 offset:24576
  ds_read_b64_tr_b16 a[222:223], v12 offset:26624
  s_waitcnt lgkmcnt(0)
  s_barrier
  s_cmp_eq_u32 s80, 3
  s_cbranch_scc1 L_op_loop
  s_cmp_eq_u32 s80, 4
  s_cbranch_scc1 L_attn
  s_cmp_eq_u32 s80, 0
  s_cbranch_scc1 L_g2
  s_cmp_eq_u32 s80, 5
  s_cbranch_scc1 L_g2
  s_cmp_eq_u32 s80, 1
  s_cbranch_scc1 L_g1
  s_load_dwordx2 s[12:13], s[0:1], 0
  s_mov_b32 s14, 0x280000
  s_mov_b32 s15, 0x00020000
  s_lshl_b32 s45, s54, 2
  s_add_u32 s45, s45, s34
  v_and_b32 v12, 63, v0
  v_mov_b32 v8, 0x0
  v_mad_i32_i24 v8, v12, 16, v8
  v_and_b32 v12, 32, v0
  v_cmp_eq_u32 vcc, 0, v12
  v_mov_b32 v13, 0x7ff00000
  s_nop 0
  v_cndmask_b32 v9, v13, v8, vcc
  v_mov_b32 v13, 0
  v_mov_b32 v14, 1.0
  v_cndmask_b32 v16, v13, v14, vcc
  v_and_b32 v12, 63, v0
  v_min_u32 v12, 39, v12
  v_lshlrev_b32 v12, 7, v12
  v_add_u32 v15, 0x9000, v12
  s_cmp_lg_u32 s34, 0
  s_cbranch_scc1 pd_125
  v_mov_b32 v12, 32
poll_126:
  buffer_load_dword v13, v12, s[8:11], 0 offen sc1
  s_waitcnt vmcnt(0)
  v_cmp_gt_u32 vcc, 40, v13
  s_cbranch_vccz polled_127
  s_sleep 3
  s_add_u32 s35, s35, 1
  s_cmp_lt_u32 s35, 300000
  s_cbranch_scc1 poll_126
polled_127:
pd_125:
  s_barrier
  s_cmp_lg_u32 s34, 0
  s_cbranch_scc1 pd_128
  v_mov_b32 v12, 160
poll_129:
  buffer_load_dword v13, v12, s[8:11], 0 offen sc1
  s_waitcnt vmcnt(0)
  v_cmp_gt_u32 vcc, 80, v13
  s_cbranch_vccz polled_130
  s_sleep 3
  s_add_u32 s35, s35, 1
  s_cmp_lt_u32 s35, 300000
  s_cbranch_scc1 poll_129
polled_130:
pd_128:
  s_barrier
  s_mov_b32 s40, 70656
  buffer_load_dwordx4 v[32:35], v8, s[4:7], s40 offen offset:0 sc1
  buffer_load_dwordx4 v[36:39], v8, s[4:7], s40 offen offset:1024 sc1
  buffer_load_dwordx4 v[40:43], v9, s[4:7], s40 offen offset:2048 sc1
  s_mov_b32 s40, 73216
  buffer_load_dwordx4 v[44:47], v8, s[4:7], s40 offen offset:0 sc1
  buffer_load_dwordx4 v[48:51], v8, s[4:7], s40 offen offset:1024 sc1
  buffer_load_dwordx4 v[52:55], v9, s[4:7], s40 offen offset:2048 sc1
  s_mov_b32 s40, 75776
  buffer_load_dwordx4 v[56:59], v8, s[4:7], s40 offen offset:0 sc1
  buffer_load_dwordx4 v[60:63], v8, s[4:7], s40 offen offset:1024 sc1
  buffer_load_dwordx4 v[64:67], v9, s[4:7], s40 offen offset:2048 sc1
  s_waitcnt lgkmcnt(0)
  s_waitcnt vmcnt(0)
  v_add_f32 v56, 1.0, v56
  v_add_f32 v57, 1.0, v57
  v_add_f32 v58, 1.0, v58
  v_add_f32 v59, 1.0, v59
  v_add_f32 v60, 1.0, v60
  v_add_f32 v61, 1.0, v61
  v_add_f32 v62, 1.0, v62
  v_add_f32 v63, 1.0, v63
  v_add_f32 v64, 1.0, v64
  v_add_f32 v65, 1.0, v65
  v_add_f32 v66, 1.0, v66
  v_add_f32 v67, 1.0, v67
  s_mov_b32 s44, 0
LN2_loop:
  s_add_u32 s43, s44, 1
  s_lshl_b32 s40, s44, 5
  s_add_u32 s40, s40, s45
  s_mul_i32 s41, s40, 1280
  v_lshrrev_b32 v10, 1, v8
  v_lshrrev_b32 v11, 1, v9
  v_and_b32 v12, 32, v0
  v_cmp_eq_u32 vcc, 0, v12
  s_nop 1
  v_cndmask_b32 v11, v9, v11, vcc
  buffer_load_dwordx2 v[120:121], v10, s[12:15], s41 offen offset:0
  buffer_load_dwordx2 v[122:123], v10, s[12:15], s41 offen offset:512
  buffer_load_dwordx2 v[124:125], v11, s[12:15], s41 offen offset:1024
poll_131:
  buffer_load_dword v13, v15, s[4:7], 0 offen sc1
  s_waitcnt vmcnt(0)
  v_cmp_gt_u32 vcc, s43, v13
  s_cbranch_vccz polled_132
  s_sleep 2
  s_add_u32 s35, s35, 1
  s_cmp_lt_u32 s35, 300000
  s_cbranch_scc1 poll_131
polled_132:
  s_lshl_b32 s42, s44, 2
  s_add_u32 s42, s42, 0
  s_lshl_b32 s42, s42, 5
  s_add_u32 s42, s42, s45
  s_mul_i32 s42, s42, 2560
  s_add_u32 s42, s42, 117440512
  buffer_load_dwordx4 v[72:75], v8, s[4:7], s42 offen offset:0 sc1
  buffer_load_dwordx4 v[76:79], v8, s[4:7], s42 offen offset:1024 sc1
  buffer_load_dwordx4 v[80:83], v9, s[4:7], s42 offen offset:2048 sc1
  s_lshl_b32 s42, s44, 2
  s_add_u32 s42, s42, 1
  s_lshl_b32 s42, s42, 5
  s_add_u32 s42, s42, s45
  s_mul_i32 s42, s42, 2560
  s_add_u32 s42, s42, 117440512
  buffer_load_dwordx4 v[84:87], v8, s[4:7], s42 offen offset:0 sc1
  buffer_load_dwordx4 v[88:91], v8, s[4:7], s42 offen offset:1024 sc1
  buffer_load_dwordx4 v[92:95], v9, s[4:7], s42 offen offset:2048 sc1
  s_lshl_b32 s42, s44, 2
  s_add_u32 s42, s42, 2
  s_lshl_b32 s42, s42, 5
  s_add_u32 s42, s42, s45
  s_mul_i32 s42, s42, 2560
  s_add_u32 s42, s42, 117440512
  buffer_load_dwordx4 v[96:99], v8, s[4:7], s42 offen offset:0 sc1
  buffer_load_dwordx4 v[100:103], v8, s[4:7], s42 offen offset:1024 sc1
  buffer_load_dwordx4 v[104:107], v9, s[4:7], s42 offen offset:2048 sc1
  s_lshl_b32 s42, s44, 2
  s_add_u32 s42, s42, 3
  s_lshl_b32 s42, s42, 5
  s_add_u32 s42, s42, s45
  s_mul_i32 s42, s42, 2560
  s_add_u32 s42, s42, 117440512
  buffer_load_dwordx4 v[108:111], v8, s[4:7], s42 offen offset:0 sc1
  buffer_load_dwordx4 v[112:115], v8, s[4:7], s42 offen offset:1024 sc1
  buffer_load_dwordx4 v[116:119], v9, s[4:7], s42 offen offset:2048 sc1
  s_waitcnt vmcnt(0)
  v_add_f32 v72, v72, v84
  v_add_f32 v96, v96, v108
  v_add_f32 v72, v72, v96
  v_add_f32 v73, v73, v85
  v_add_f32 v97, v97, v109
  v_add_f32 v73, v73, v97
  v_add_f32 v74, v74, v86
  v_add_f32 v98, v98, v110
  v_add_f32 v74, v74, v98
  v_add_f32 v75, v75, v87
  v_add_f32 v99, v99, v111
  v_add_f32 v75, v75, v99
  v_add_f32 v76, v76, v88
  v_add_f32 v100, v100, v112
  v_add_f32 v76, v76, v100
  v_add_f32 v77, v77, v89
  v_add_f32 v101, v101, v113
  v_add_f32 v77, v77, v101
  v_add_f32 v78, v78, v90
  v_add_f32 v102, v102, v114
  v_add_f32 v78, v78, v102
  v_add_f32 v79, v79, v91
  v_add_f32 v103, v103, v115
  v_add_f32 v79, v79, v103
  v_add_f32 v80, v80, v92
  v_add_f32 v104, v104, v116
  v_add_f32 v80, v80, v104
  v_add_f32 v81, v81, v93
  v_add_f32 v105, v105, v117
  v_add_f32 v81, v81, v105
  v_add_f32 v82, v82, v94
  v_add_f32 v106, v106, v118
  v_add_f32 v82, v82, v106
  v_add_f32 v83, v83, v95
  v_add_f32 v107, v107, v119
  v_add_f32 v83, v83, v107
  v_lshlrev_b32 v128, 16, v120
  v_and_b32 v129, 0xffff0000, v120
  v_lshlrev_b32 v130, 16, v121
  v_and_b32 v131, 0xffff0000, v121
  v_lshlrev_b32 v132, 16, v122
  v_and_b32 v133, 0xffff0000, v122
  v_lshlrev_b32 v134, 16, v123
  v_and_b32 v135, 0xffff0000, v123
  v_lshlrev_b32 v136, 16, v124
  v_and_b32 v137, 0xffff0000, v124
  v_lshlrev_b32 v138, 16, v125
  v_and_b32 v139, 0xffff0000, v125
  v_fmac_f32 v128, v32, v72
  v_fmac_f32 v129, v33, v73
  v_fmac_f32 v130, v34, v74
  v_fmac_f32 v131, v35, v75
  v_fmac_f32 v132, v36, v76
  v_fmac_f32 v133, v37, v77
  v_fmac_f32 v134, v38, v78
  v_fmac_f32 v135, v39, v79
  v_fmac_f32 v136, v40, v80
  v_fmac_f32 v137, v41, v81
  v_fmac_f32 v138, v42, v82
  v_fmac_f32 v139, v43, v83
  s_mul_i32 s42, s40, 2560
  s_add_u32 s42, s42, 14680064
  buffer_store_dwordx4 v[128:131], v8, s[4:7], s42 offen offset:0 sc1
  buffer_store_dwordx4 v[132:135], v8, s[4:7], s42 offen offset:1024 sc1
  buffer_store_dwordx4 v[136:139], v9, s[4:7], s42 offen offset:2048 sc1
  v_add_f32 v12, v128, v129
  v_add_f32 v12, v12, v130
  v_add_f32 v12, v12, v131
  v_add_f32 v12, v12, v132
  v_add_f32 v12, v12, v133
  v_add_f32 v12, v12, v134
  v_add_f32 v12, v12, v135
  v_add_f32 v12, v12, v136
  v_add_f32 v12, v12, v137
  v_add_f32 v12, v12, v138
  v_add_f32 v12, v12, v139
  s_nop 1
  v_add_f32_dpp v12, v12, v12 row_ror:1 row_mask:0xf bank_mask:0xf
  s_nop 1
  v_add_f32_dpp v12, v12, v12 row_ror:2 row_mask:0xf bank_mask:0xf
  s_nop 1
  v_add_f32_dpp v12, v12, v12 row_ror:4 row_mask:0xf bank_mask:0xf
  s_nop 1
  v_add_f32_dpp v12, v12, v12 row_ror:8 row_mask:0xf bank_mask:0xf
  v_mov_b32 v13, v12
  s_nop 1
  v_permlane16_swap_b32 v12, v13
  v_add_f32 v12, v12, v13
  v_mov_b32 v13, v12
  s_nop 1
  v_permlane32_swap_b32 v12, v13
  v_add_f32 v12, v12, v13
  v_mul_f32 v12, 0x3acccccd, v12
  v_sub_f32 v72, v128, v12
  v_sub_f32 v73, v129, v12
  v_sub_f32 v74, v130, v12
  v_sub_f32 v75, v131, v12
  v_sub_f32 v76, v132, v12
  v_sub_f32 v77, v133, v12
  v_sub_f32 v78, v134, v12
  v_sub_f32 v79, v135, v12
  v_sub_f32 v80, v136, v12
  v_sub_f32 v81, v137, v12
  v_sub_f32 v82, v138, v12
  v_sub_f32 v83, v139, v12
  v_mul_f32 v80, v80, v16
  v_mul_f32 v81, v81, v16
  v_mul_f32 v82, v82, v16
  v_mul_f32 v83, v83, v16
  v_mul_f32 v12, v72, v72
  v_fmac_f32 v12, v73, v73
  v_fmac_f32 v12, v74, v74
  v_fmac_f32 v12, v75, v75
  v_fmac_f32 v12, v76, v76
  v_fmac_f32 v12, v77, v77
  v_fmac_f32 v12, v78, v78
  v_fmac_f32 v12, v79, v79
  v_fmac_f32 v12, v80, v80
  v_fmac_f32 v12, v81, v81
  v_fmac_f32 v12, v82, v82
  v_fmac_f32 v12, v83, v83
  s_nop 1
  v_add_f32_dpp v12, v12, v12 row_ror:1 row_mask:0xf bank_mask:0xf
  s_nop 1
  v_add_f32_dpp v12, v12, v12 row_ror:2 row_mask:0xf bank_mask:0xf
  s_nop 1
  v_add_f32_dpp v12, v12, v12 row_ror:4 row_mask:0xf bank_mask:0xf
  s_nop 1
  v_add_f32_dpp v12, v12, v12 row_ror:8 row_mask:0xf bank_mask:0xf
  v_mov_b32 v13, v12
  s_nop 1
  v_permlane16_swap_b32 v12, v13
  v_add_f32 v12, v12, v13
  v_mov_b32 v13, v12
  s_nop 1
  v_permlane32_swap_b32 v12, v13
  v_add_f32 v12, v12, v13
  v_mov_b32 v13, 0x3727c5ac
  v_fmac_f32 v13, 0x3acccccd, v12
  v_rsq_f32 v13, v13
  s_nop 0
  v_mul_f32 v72, v72, v13
  v_fma_f32 v72, v72, v56, v44
  v_mul_f32 v73, v73, v13
  v_fma_f32 v73, v73, v57, v45
  v_mul_f32 v74, v74, v13
  v_fma_f32 v74, v74, v58, v46
  v_mul_f32 v75, v75, v13
  v_fma_f32 v75, v75, v59, v47
  v_mul_f32 v76, v76, v13
  v_fma_f32 v76, v76, v60, v48
  v_mul_f32 v77, v77, v13
  v_fma_f32 v77, v77, v61, v49
  v_mul_f32 v78, v78, v13
  v_fma_f32 v78, v78, v62, v50
  v_mul_f32 v79, v79, v13
  v_fma_f32 v79, v79, v63, v51
  v_mul_f32 v80, v80, v13
  v_fma_f32 v80, v80, v64, v52
  v_mul_f32 v81, v81, v13
  v_fma_f32 v81, v81, v65, v53
  v_mul_f32 v82, v82, v13
  v_fma_f32 v82, v82, v66, v54
  v_mul_f32 v83, v83, v13
  v_fma_f32 v83, v83, v67, v55
  v_cvt_pk_bf16_f32 v120, v72, v73
  v_cvt_pk_bf16_f32 v121, v74, v75
  v_cvt_pk_bf16_f32 v122, v76, v77
  v_cvt_pk_bf16_f32 v123, v78, v79
  v_cvt_pk_bf16_f32 v124, v80, v81
  v_cvt_pk_bf16_f32 v125, v82, v83
  s_add_u32 s42, s41, 10485760
  buffer_store_dwordx2 v[120:121], v10, s[4:7], s42 offen offset:0 sc1
  buffer_store_dwordx2 v[122:123], v10, s[4:7], s42 offen offset:512 sc1
  buffer_store_dwordx2 v[124:125], v11, s[4:7], s42 offen offset:1024 sc1
  s_waitcnt vmcnt(0)
  s_lshl_b32 s40, s45, 7
  s_add_u32 s40, s40, 41984
  v_and_b32 v12, 63, v0
  v_cmp_eq_u32 vcc, 0, v12
  v_mov_b32 v13, 0x7ffffff0
  s_nop 0
  v_cndmask_b32 v12, v13, 0, vcc
  v_mov_b32 v13, s43
  buffer_store_dword v13, v12, s[4:7], s40 offen sc1
  s_add_u32 s44, s44, 1
  s_cmp_lt_u32 s44, 64
  s_cbranch_scc1 LN2_loop
  s_branch L_g2
L_g1:
  s_load_dwordx2 s[12:13], s[0:1], 64
  s_mov_b32 s14, 0x6c0000
  s_mov_b32 s15, 0x00020000
  s_load_dwordx2 s[16:17], s[0:1], 72
  s_mov_b32 s18, 0xd80
  s_mov_b32 s19, 0x00020000
  s_mul_i32 s45, s54, 57
  s_lshr_b32 s45, s45, 9
  s_mul_i32 s40, s45, 9
  s_sub_u32 s46, s54, s40
  v_lshrrev_b32 v17, 0, v0
  v_mov_b32 v16, 0x0
  v_mad_i32_i24 v16, v17, 1, v16
  s_mov_b32 s40, 2731
  v_mul_u32_u24 v17, s40, v16
  v_lshrrev_b32 v17, 16, v17
  v_mul_u32_u24 v18, 24, v17
  v_sub_u32 v18, v16, v18
  s_mov_b32 s40, 3456
  v_mul_u32_u24 v17, s40, v17
  v_lshl_add_u32 v8, v18, 4, v17
  v_lshrrev_b32 v17, 0, v0
  v_mov_b32 v16, 0x100
  v_mad_i32_i24 v16, v17, 1, v16
  s_mov_b32 s40, 2731
  v_mul_u32_u24 v17, s40, v16
  v_lshrrev_b32 v17, 16, v17
  v_mul_u32_u24 v18, 24, v17
  v_sub_u32 v18, v16, v18
  s_mov_b32 s40, 3456
  v_mul_u32_u24 v17, s40, v17
  v_lshl_add_u32 v9, v18, 4, v17
  v_lshrrev_b32 v17, 0, v0
  v_mov_b32 v16, 0x200
  v_mad_i32_i24 v16, v17, 1, v16
  s_mov_b32 s40, 2731
  v_mul_u32_u24 v17, s40, v16
  v_lshrrev_b32 v17, 16, v17
  v_mul_u32_u24 v18, 24, v17
  v_sub_u32 v18, v16, v18
  s_mov_b32 s40, 3456
  v_mul_u32_u24 v17, s40, v17
  v_lshl_add_u32 v10, v18, 4, v17
  v_and_b32 v16, 7, v0
  v_mov_b32 v13, 0x0
  v_mad_i32_i24 v13, v16, 16, v13
  v_lshrrev_b32 v16, 3, v0
  s_mov_b32 s36, 0x500
  v_mad_i32_i24 v13, v16, s36, v13
  v_and_b32 v16, 3, v0
  v_mov_b32 v14, 0x0
  v_mad_i32_i24 v14, v16, 8, v14
  v_bfe_u32 v16, v0, 2, 2
  s_mov_b32 s36, 0x180
  v_mad_i32_i24 v14, v16, s36, v14
  v_bfe_u32 v16, v0, 4, 2
  s_mov_b32 s36, 0xc00
  v_mad_i32_i24 v14, v16, s36, v14
  v_and_b32 v16, 3, v0
  v_mov_b32 v15, 0x3000
  v_mad_i32_i24 v15, v16, 8, v15
  v_bfe_u32 v16, v0, 2, 2
  s_mov_b32 s36, 0x80
  v_mad_i32_i24 v15, v16, s36, v15
  v_bfe_u32 v16, v0, 4, 2
  s_mov_b32 s36, 0x400
  v_mad_i32_i24 v15, v16, s36, v15
  v_lshrrev_b32 v16, 6, v0
  v_mad_i32_i24 v15, v16, 32, v15
  v_and_b32 v16, 63, v0
  v_min_u32 v16, 31, v16
  v_lshlrev_b32 v16, 7, v16
  v_add_u32 v19, 0xa400, v16
  s_waitcnt lgkmcnt(0)
  v_mov_b64 v[32:33], 0
  v_mov_b64 v[34:35], 0
  v_mov_b64 v[36:37], 0
  v_mov_b64 v[38:39], 0
  v_mov_b64 v[40:41], 0
  v_mov_b64 v[42:43], 0
  v_mov_b64 v[44:45], 0
  v_mov_b64 v[46:47], 0
  v_mov_b64 v[48:49], 0
  v_mov_b64 v[50:51], 0
  v_mov_b64 v[52:53], 0
  v_mov_b64 v[54:55], 0
  v_mov_b64 v[56:57], 0
  v_mov_b64 v[58:59], 0
  v_mov_b64 v[60:61], 0
  v_mov_b64 v[62:63], 0
  v_mov_b64 v[64:65], 0
  v_mov_b64 v[66:67], 0
  v_mov_b64 v[68:69], 0
  v_mov_b64 v[70:71], 0
  v_mov_b64 v[72:73], 0
  v_mov_b64 v[74:75], 0
  v_mov_b64 v[76:77], 0
  v_mov_b64 v[78:79], 0
  v_bfe_u32 v17, v0, 4, 2
  v_mov_b32 v16, 0x0
  v_mad_i32_i24 v16, v17, 8, v16
  s_mul_i32 s40, s46, 384
  buffer_load_dwordx2 v[192:193], v16, s[16:19], s40 offen offset:0
  buffer_load_dwordx2 v[194:195], v16, s[16:19], s40 offen offset:32
  buffer_load_dwordx2 v[196:197], v16, s[16:19], s40 offen offset:64
  buffer_load_dwordx2 v[198:199], v16, s[16:19], s40 offen offset:96
  buffer_load_dwordx2 v[200:201], v16, s[16:19], s40 offen offset:128
  buffer_load_dwordx2 v[202:203], v16, s[16:19], s40 offen offset:160
  buffer_load_dwordx2 v[204:205], v16, s[16:19], s40 offen offset:192
  buffer_load_dwordx2 v[206:207], v16, s[16:19], s40 offen offset:224
  buffer_load_dwordx2 v[208:209], v16, s[16:19], s40 offen offset:256
  buffer_load_dwordx2 v[210:211], v16, s[16:19], s40 offen offset:288
  buffer_load_dwordx2 v[212:213], v16, s[16:19], s40 offen offset:320
  buffer_load_dwordx2 v[214:215], v16, s[16:19], s40 offen offset:352
  s_mov_b32 s44, 0
  s_mov_b32 s47, 0
  s_mov_b32 s48, 0
  s_mul_i32 s41, s44, 110592
  s_mul_i32 s40, s46, 384
  s_add_u32 s41, s41, s40
  s_lshl_b32 s42, s34, 10
  s_add_u32 s42, s42, 0
  s_add_u32 s42, s42, s48
  s_mov_b32 m0, s42
  s_nop 0
  buffer_load_dwordx4 v8, s[12:15], s41 offen lds
  s_lshl_b32 s42, s34, 10
  s_add_u32 s42, s42, 4096
  s_add_u32 s42, s42, s48
  s_mov_b32 m0, s42
  s_nop 0
  buffer_load_dwordx4 v9, s[12:15], s41 offen lds
  s_lshl_b32 s42, s34, 10
  s_add_u32 s42, s42, 8192
  s_add_u32 s42, s42, s48
  s_mov_b32 m0, s42
  s_nop 0
  buffer_load_dwordx4 v10, s[12:15], s41 offen lds
G1_loop:
  s_add_u32 s43, s44, 1
  s_cmp_ge_u32 s47, s43
  s_cbranch_scc1 g1seen_133
poll_134:
  buffer_load_dword v17, v19, s[4:7], 0 offen sc1
  s_waitcnt vmcnt(0)
  v_cmp_gt_u32 vcc, s43, v17
  s_cbranch_vccz polled_135
  s_sleep 1
  s_add_u32 s35, s35, 1
  s_cmp_lt_u32 s35, 300000
  s_cbranch_scc1 poll_134
polled_135:
  v_mov_b32 v18, v17
  s_nop 1
  v_min_u32_dpp v18, v18, v18 row_ror:1 row_mask:0xf bank_mask:0xf
  s_nop 1
  v_min_u32_dpp v18, v18, v18 row_ror:2 row_mask:0xf bank_mask:0xf
  s_nop 1
  v_min_u32_dpp v18, v18, v18 row_ror:4 row_mask:0xf bank_mask:0xf
  s_nop 1
  v_min_u32_dpp v18, v18, v18 row_ror:8 row_mask:0xf bank_mask:0xf
  v_mov_b32 v17, v18
  s_nop 1
  v_permlane16_swap_b32 v18, v17
  v_min_u32 v18, v18, v17
  s_nop 0
  v_readfirstlane_b32 s47, v18
  s_nop 1
  s_min_u32 s47, s47, 64
g1seen_133:
  s_mul_i32 s41, s44, 40960
  s_lshl_b32 s40, s45, 7
  s_add_u32 s41, s41, s40
  s_add_u32 s41, s41, 10485760
  s_lshl_b32 s42, s34, 10
  s_add_u32 s42, s42, 12288
  s_add_u32 s42, s42, s48
  s_mov_b32 m0, s42
  s_nop 0
  buffer_load_dwordx4 v13, s[4:7], s41 offen sc1 lds
  s_waitcnt vmcnt(0)
  s_barrier
  v_add_u32 v16, s48, v15
  v_add_u32 v17, s48, v14
  s_xor_b32 s48, s48, 16384
  s_cmp_ge_u32 s43, 64
  s_cbranch_scc1 g1nx_136
  s_mov_b32 s49, s43
  s_mul_i32 s41, s49, 110592
  s_mul_i32 s40, s46, 384
  s_add_u32 s41, s41, s40
  s_lshl_b32 s42, s34, 10
  s_add_u32 s42, s42, 0
  s_add_u32 s42, s42, s48
  s_mov_b32 m0, s42
  s_nop 0
  buffer_load_dwordx4 v8, s[12:15], s41 offen lds
  s_lshl_b32 s42, s34, 10
  s_add_u32 s42, s42, 4096
  s_add_u32 s42, s42, s48
  s_mov_b32 m0, s42
  s_nop 0
  buffer_load_dwordx4 v9, s[12:15], s41 offen lds
  s_lshl_b32 s42, s34, 10
  s_add_u32 s42, s42, 8192
  s_add_u32 s42, s42, s48
  s_mov_b32 m0, s42
  s_nop 0
  buffer_load_dwordx4 v10, s[12:15], s41 offen lds
g1nx_136:
  ds_read_b64_tr_b16 v[176:177], v16 offset:0
  ds_read_b64_tr_b16 v[178:179], v16 offset:512
  ds_read_b64_tr_b16 v[104:105], v17 offset:0
  ds_read_b64_tr_b16 v[106:107], v17 offset:1536
  ds_read_b64_tr_b16 v[108:109], v17 offset:32
  ds_read_b64_tr_b16 v[110:111], v17 offset:1568
  ds_read_b64_tr_b16 v[112:113], v17 offset:64
  ds_read_b64_tr_b16 v[114:115], v17 offset:1600
  ds_read_b64_tr_b16 v[116:117], v17 offset:96
  ds_read_b64_tr_b16 v[118:119], v17 offset:1632
  ds_read_b64_tr_b16 v[120:121], v17 offset:128
  ds_read_b64_tr_b16 v[122:123], v17 offset:1664
  ds_read_b64_tr_b16 v[124:125], v17 offset:160
  ds_read_b64_tr_b16 v[126:127], v17 offset:1696
  s_waitcnt lgkmcnt(10)
  v_mfma_f32_16x16x32_bf16 v[32:35], v[104:107], v[176:179], v[32:35]
  ds_read_b64_tr_b16 v[128:129], v17 offset:192
  ds_read_b64_tr_b16 v[130:131], v17 offset:1728
  s_waitcnt lgkmcnt(10)
  v_mfma_f32_16x16x32_bf16 v[36:39], v[108:111], v[176:179], v[36:39]
  ds_read_b64_tr_b16 v[132:133], v17 offset:224
  ds_read_b64_tr_b16 v[134:135], v17 offset:1760
  s_waitcnt lgkmcnt(10)
  v_mfma_f32_16x16x32_bf16 v[40:43], v[112:115], v[176:179], v[40:43]
  ds_read_b64_tr_b16 v[136:137], v17 offset:256
  ds_read_b64_tr_b16 v[138:139], v17 offset:1792
  s_waitcnt lgkmcnt(10)
  v_mfma_f32_16x16x32_bf16 v[44:47], v[116:119], v[176:179], v[44:47]
  ds_read_b64_tr_b16 v[140:141], v17 offset:288
  ds_read_b64_tr_b16 v[142:143], v17 offset:1824
  s_waitcnt lgkmcnt(10)
  v_mfma_f32_16x16x32_bf16 v[48:51], v[120:123], v[176:179], v[48:51]
  ds_read_b64_tr_b16 v[144:145], v17 offset:320
  ds_read_b64_tr_b16 v[146:147], v17 offset:1856
  s_waitcnt lgkmcnt(10)
  v_mfma_f32_16x16x32_bf16 v[52:55], v[124:127], v[176:179], v[52:55]
  ds_read_b64_tr_b16 v[148:149], v17 offset:352
  ds_read_b64_tr_b16 v[150:151], v17 offset:1888
  s_waitcnt lgkmcnt(10)
  v_mfma_f32_16x16x32_bf16 v[56:59], v[128:131], v[176:179], v[56:59]
  s_waitcnt lgkmcnt(8)
  v_mfma_f32_16x16x32_bf16 v[60:63], v[132:135], v[176:179], v[60:63]
  s_waitcnt lgkmcnt(6)
  v_mfma_f32_16x16x32_bf16 v[64:67], v[136:139], v[176:179], v[64:67]
  s_waitcnt lgkmcnt(4)
  v_mfma_f32_16x16x32_bf16 v[68:71], v[140:143], v[176:179], v[68:71]
  s_waitcnt lgkmcnt(2)
  v_mfma_f32_16x16x32_bf16 v[72:75], v[144:147], v[176:179], v[72:75]
  s_waitcnt lgkmcnt(0)
  v_mfma_f32_16x16x32_bf16 v[76:79], v[148:151], v[176:179], v[76:79]
  s_add_u32 s44, s44, 1
  s_cmp_lt_u32 s44, 64
  s_cbranch_scc0 g1last_137
  s_nop 3
  s_branch G1_loop
g1last_137:
  v_mov_b32 v180, 0xc0135761
  v_mov_b32 v181, 0xc0135761
  v_mov_b32 v182, 0xbdd2d3e8
  v_mov_b32 v183, 0xbdd2d3e8
  v_and_b32 v17, 63, v0
  v_mov_b32 v20, 0x0
  v_mad_i32_i24 v20, v17, 16, v20
  v_lshrrev_b32 v17, 6, v0
  s_mov_b32 s36, 0xd800
  v_mad_i32_i24 v20, v17, s36, v20
  s_lshl_b32 s40, s45, 2
  s_mul_i32 s40, s40, 55296
  s_mul_i32 s41, s46, 6144
  s_add_u32 s40, s40, s41
  s_add_u32 s40, s40, 6815744
  v_lshlrev_b32 v184, 16, v192
  v_and_b32 v185, 0xffff0000, v192
  v_pk_add_f32 v[32:33], v[32:33], v[184:185]
  v_pk_mul_f32 v[184:185], v[32:33], v[32:33]
  v_pk_fma_f32 v[184:185], v[184:185], v[182:183], v[180:181]
  v_pk_mul_f32 v[184:185], v[184:185], v[32:33]
  v_exp_f32 v184, v184
  v_exp_f32 v185, v185
  s_nop 0
  v_pk_add_f32 v[184:185], v[184:185], 1.0 op_sel_hi:[1,0]
  v_rcp_f32 v184, v184
  v_rcp_f32 v185, v185
  s_nop 0
  v_pk_mul_f32 v[32:33], v[32:33], v[184:185]
  v_lshlrev_b32 v184, 16, v193
  v_and_b32 v185, 0xffff0000, v193
  v_pk_add_f32 v[34:35], v[34:35], v[184:185]
  v_pk_mul_f32 v[184:185], v[34:35], v[34:35]
  v_pk_fma_f32 v[184:185], v[184:185], v[182:183], v[180:181]
  v_pk_mul_f32 v[184:185], v[184:185], v[34:35]
  v_exp_f32 v184, v184
  v_exp_f32 v185, v185
  s_nop 0
  v_pk_add_f32 v[184:185], v[184:185], 1.0 op_sel_hi:[1,0]
  v_rcp_f32 v184, v184
  v_rcp_f32 v185, v185
  s_nop 0
  v_pk_mul_f32 v[34:35], v[34:35], v[184:185]
  v_lshlrev_b32 v184, 16, v194
  v_and_b32 v185, 0xffff0000, v194
  v_pk_add_f32 v[36:37], v[36:37], v[184:185]
  v_pk_mul_f32 v[184:185], v[36:37], v[36:37]
  v_pk_fma_f32 v[184:185], v[184:185], v[182:183], v[180:181]
  v_pk_mul_f32 v[184:185], v[184:185], v[36:37]
  v_exp_f32 v184, v184
  v_exp_f32 v185, v185
  s_nop 0
  v_pk_add_f32 v[184:185], v[184:185], 1.0 op_sel_hi:[1,0]
  v_rcp_f32 v184, v184
  v_rcp_f32 v185, v185
  s_nop 0
  v_pk_mul_f32 v[36:37], v[36:37], v[184:185]
  v_lshlrev_b32 v184, 16, v195
  v_and_b32 v185, 0xffff0000, v195
  v_pk_add_f32 v[38:39], v[38:39], v[184:185]
  v_pk_mul_f32 v[184:185], v[38:39], v[38:39]
  v_pk_fma_f32 v[184:185], v[184:185], v[182:183], v[180:181]
  v_pk_mul_f32 v[184:185], v[184:185], v[38:39]
  v_exp_f32 v184, v184
  v_exp_f32 v185, v185
  s_nop 0
  v_pk_add_f32 v[184:185], v[184:185], 1.0 op_sel_hi:[1,0]
  v_rcp_f32 v184, v184
  v_rcp_f32 v185, v185
  s_nop 0
  v_pk_mul_f32 v[38:39], v[38:39], v[184:185]
  v_cvt_pk_bf16_f32 v152, v32, v33
  v_cvt_pk_bf16_f32 v153, v34, v35
  v_cvt_pk_bf16_f32 v154, v36, v37
  v_cvt_pk_bf16_f32 v155, v38, v39
  buffer_store_dwordx4 v[152:155], v20, s[4:7], s40 offen sc1
  s_add_u32 s40, s40, 1024
  v_lshlrev_b32 v184, 16, v196
  v_and_b32 v185, 0xffff0000, v196
  v_pk_add_f32 v[40:41], v[40:41], v[184:185]
  v_pk_mul_f32 v[184:185], v[40:41], v[40:41]
  v_pk_fma_f32 v[184:185], v[184:185], v[182:183], v[180:181]
  v_pk_mul_f32 v[184:185], v[184:185], v[40:41]
  v_exp_f32 v184, v184
  v_exp_f32 v185, v185
  s_nop 0
  v_pk_add_f32 v[184:185], v[184:185], 1.0 op_sel_hi:[1,0]
  v_rcp_f32 v184, v184
  v_rcp_f32 v185, v185
  s_nop 0
  v_pk_mul_f32 v[40:41], v[40:41], v[184:185]
  v_lshlrev_b32 v184, 16, v197
  v_and_b32 v185, 0xffff0000, v197
  v_pk_add_f32 v[42:43], v[42:43], v[184:185]
  v_pk_mul_f32 v[184:185], v[42:43], v[42:43]
  v_pk_fma_f32 v[184:185], v[184:185], v[182:183], v[180:181]
  v_pk_mul_f32 v[184:185], v[184:185], v[42:43]
  v_exp_f32 v184, v184
  v_exp_f32 v185, v185
  s_nop 0
  v_pk_add_f32 v[184:185], v[184:185], 1.0 op_sel_hi:[1,0]
  v_rcp_f32 v184, v184
  v_rcp_f32 v185, v185
  s_nop 0
  v_pk_mul_f32 v[42:43], v[42:43], v[184:185]
  v_lshlrev_b32 v184, 16, v198
  v_and_b32 v185, 0xffff0000, v198
  v_pk_add_f32 v[44:45], v[44:45], v[184:185]
  v_pk_mul_f32 v[184:185], v[44:45], v[44:45]
  v_pk_fma_f32 v[184:185], v[184:185], v[182:183], v[180:181]
  v_pk_mul_f32 v[184:185], v[184:185], v[44:45]
  v_exp_f32 v184, v184
  v_exp_f32 v185, v185
  s_nop 0
  v_pk_add_f32 v[184:185], v[184:185], 1.0 op_sel_hi:[1,0]
  v_rcp_f32 v184, v184
  v_rcp_f32 v185, v185
  s_nop 0
  v_pk_mul_f32 v[44:45], v[44:45], v[184:185]
  v_lshlrev_b32 v184, 16, v199
  v_and_b32 v185, 0xffff0000, v199
  v_pk_add_f32 v[46:47], v[46:47], v[184:185]
  v_pk_mul_f32 v[184:185], v[46:47], v[46:47]
  v_pk_fma_f32 v[184:185], v[184:185], v[182:183], v[180:181]
  v_pk_mul_f32 v[184:185], v[184:185], v[46:47]
  v_exp_f32 v184, v184
  v_exp_f32 v185, v185
  s_nop 0
  v_pk_add_f32 v[184:185], v[184:185], 1.0 op_sel_hi:[1,0]
  v_rcp_f32 v184, v184
  v_rcp_f32 v185, v185
  s_nop 0
  v_pk_mul_f32 v[46:47], v[46:47], v[184:185]
  v_cvt_pk_bf16_f32 v156, v40, v41
  v_cvt_pk_bf16_f32 v157, v42, v43
  v_cvt_pk_bf16_f32 v158, v44, v45
  v_cvt_pk_bf16_f32 v159, v46, v47
  buffer_store_dwordx4 v[156:159], v20, s[4:7], s40 offen sc1
  s_add_u32 s40, s40, 1024
  v_lshlrev_b32 v184, 16, v200
  v_and_b32 v185, 0xffff0000, v200
  v_pk_add_f32 v[48:49], v[48:49], v[184:185]
  v_pk_mul_f32 v[184:185], v[48:49], v[48:49]
  v_pk_fma_f32 v[184:185], v[184:185], v[182:183], v[180:181]
  v_pk_mul_f32 v[184:185], v[184:185], v[48:49]
  v_exp_f32 v184, v184
  v_exp_f32 v185, v185
  s_nop 0
  v_pk_add_f32 v[184:185], v[184:185], 1.0 op_sel_hi:[1,0]
  v_rcp_f32 v184, v184
  v_rcp_f32 v185, v185
  s_nop 0
  v_pk_mul_f32 v[48:49], v[48:49], v[184:185]
  v_lshlrev_b32 v184, 16, v201
  v_and_b32 v185, 0xffff0000, v201
  v_pk_add_f32 v[50:51], v[50:51], v[184:185]
  v_pk_mul_f32 v[184:185], v[50:51], v[50:51]
  v_pk_fma_f32 v[184:185], v[184:185], v[182:183], v[180:181]
  v_pk_mul_f32 v[184:185], v[184:185], v[50:51]
  v_exp_f32 v184, v184
  v_exp_f32 v185, v185
  s_nop 0
  v_pk_add_f32 v[184:185], v[184:185], 1.0 op_sel_hi:[1,0]
  v_rcp_f32 v184, v184
  v_rcp_f32 v185, v185
  s_nop 0
  v_pk_mul_f32 v[50:51], v[50:51], v[184:185]
  v_lshlrev_b32 v184, 16, v202
  v_and_b32 v185, 0xffff0000, v202
  v_pk_add_f32 v[52:53], v[52:53], v[184:185]
  v_pk_mul_f32 v[184:185], v[52:53], v[52:53]
  v_pk_fma_f32 v[184:185], v[184:185], v[182:183], v[180:181]
  v_pk_mul_f32 v[184:185], v[184:185], v[52:53]
  v_exp_f32 v184, v184
  v_exp_f32 v185, v185
  s_nop 0
  v_pk_add_f32 v[184:185], v[184:185], 1.0 op_sel_hi:[1,0]
  v_rcp_f32 v184, v184
  v_rcp_f32 v185, v185
  s_nop 0
  v_pk_mul_f32 v[52:53], v[52:53], v[184:185]
  v_lshlrev_b32 v184, 16, v203
  v_and_b32 v185, 0xffff0000, v203
  v_pk_add_f32 v[54:55], v[54:55], v[184:185]
  v_pk_mul_f32 v[184:185], v[54:55], v[54:55]
  v_pk_fma_f32 v[184:185], v[184:185], v[182:183], v[180:181]
  v_pk_mul_f32 v[184:185], v[184:185], v[54:55]
  v_exp_f32 v184, v184
  v_exp_f32 v185, v185
  s_nop 0
  v_pk_add_f32 v[184:185], v[184:185], 1.0 op_sel_hi:[1,0]
  v_rcp_f32 v184, v184
  v_rcp_f32 v185, v185
  s_nop 0
  v_pk_mul_f32 v[54:55], v[54:55], v[184:185]
  v_cvt_pk_bf16_f32 v160, v48, v49
  v_cvt_pk_bf16_f32 v161, v50, v51
  v_cvt_pk_bf16_f32 v162, v52, v53
  v_cvt_pk_bf16_f32 v163, v54, v55
  buffer_store_dwordx4 v[160:163], v20, s[4:7], s40 offen sc1
  s_add_u32 s40, s40, 1024
  v_lshlrev_b32 v184, 16, v204
  v_and_b32 v185, 0xffff0000, v204
  v_pk_add_f32 v[56:57], v[56:57], v[184:185]
  v_pk_mul_f32 v[184:185], v[56:57], v[56:57]
  v_pk_fma_f32 v[184:185], v[184:185], v[182:183], v[180:181]
  v_pk_mul_f32 v[184:185], v[184:185], v[56:57]
  v_exp_f32 v184, v184
  v_exp_f32 v185, v185
  s_nop 0
  v_pk_add_f32 v[184:185], v[184:185], 1.0 op_sel_hi:[1,0]
  v_rcp_f32 v184, v184
  v_rcp_f32 v185, v185
  s_nop 0
  v_pk_mul_f32 v[56:57], v[56:57], v[184:185]
  v_lshlrev_b32 v184, 16, v205
  v_and_b32 v185, 0xffff0000, v205
  v_pk_add_f32 v[58:59], v[58:59], v[184:185]
  v_pk_mul_f32 v[184:185], v[58:59], v[58:59]
  v_pk_fma_f32 v[184:185], v[184:185], v[182:183], v[180:181]
  v_pk_mul_f32 v[184:185], v[184:185], v[58:59]
  v_exp_f32 v184, v184
  v_exp_f32 v185, v185
  s_nop 0
  v_pk_add_f32 v[184:185], v[184:185], 1.0 op_sel_hi:[1,0]
  v_rcp_f32 v184, v184
  v_rcp_f32 v185, v185
  s_nop 0
  v_pk_mul_f32 v[58:59], v[58:59], v[184:185]
  v_lshlrev_b32 v184, 16, v206
  v_and_b32 v185, 0xffff0000, v206
  v_pk_add_f32 v[60:61], v[60:61], v[184:185]
  v_pk_mul_f32 v[184:185], v[60:61], v[60:61]
  v_pk_fma_f32 v[184:185], v[184:185], v[182:183], v[180:181]
  v_pk_mul_f32 v[184:185], v[184:185], v[60:61]
  v_exp_f32 v184, v184
  v_exp_f32 v185, v185
  s_nop 0
  v_pk_add_f32 v[184:185], v[184:185], 1.0 op_sel_hi:[1,0]
  v_rcp_f32 v184, v184
  v_rcp_f32 v185, v185
  s_nop 0
  v_pk_mul_f32 v[60:61], v[60:61], v[184:185]
  v_lshlrev_b32 v184, 16, v207
  v_and_b32 v185, 0xffff0000, v207
  v_pk_add_f32 v[62:63], v[62:63], v[184:185]
  v_pk_mul_f32 v[184:185], v[62:63], v[62:63]
  v_pk_fma_f32 v[184:185], v[184:185], v[182:183], v[180:181]
  v_pk_mul_f32 v[184:185], v[184:185], v[62:63]
  v_exp_f32 v184, v184
  v_exp_f32 v185, v185
  s_nop 0
  v_pk_add_f32 v[184:185], v[184:185], 1.0 op_sel_hi:[1,0]
  v_rcp_f32 v184, v184
  v_rcp_f32 v185, v185
  s_nop 0
  v_pk_mul_f32 v[62:63], v[62:63], v[184:185]
  v_cvt_pk_bf16_f32 v164, v56, v57
  v_cvt_pk_bf16_f32 v165, v58, v59
  v_cvt_pk_bf16_f32 v166, v60, v61
  v_cvt_pk_bf16_f32 v167, v62, v63
  buffer_store_dwordx4 v[164:167], v20, s[4:7], s40 offen sc1
  s_add_u32 s40, s40, 1024
  v_lshlrev_b32 v184, 16, v208
  v_and_b32 v185, 0xffff0000, v208
  v_pk_add_f32 v[64:65], v[64:65], v[184:185]
  v_pk_mul_f32 v[184:185], v[64:65], v[64:65]
  v_pk_fma_f32 v[184:185], v[184:185], v[182:183], v[180:181]
  v_pk_mul_f32 v[184:185], v[184:185], v[64:65]
  v_exp_f32 v184, v184
  v_exp_f32 v185, v185
  s_nop 0
  v_pk_add_f32 v[184:185], v[184:185], 1.0 op_sel_hi:[1,0]
  v_rcp_f32 v184, v184
  v_rcp_f32 v185, v185
  s_nop 0
  v_pk_mul_f32 v[64:65], v[64:65], v[184:185]
  v_lshlrev_b32 v184, 16, v209
  v_and_b32 v185, 0xffff0000, v209
  v_pk_add_f32 v[66:67], v[66:67], v[184:185]
  v_pk_mul_f32 v[184:185], v[66:67], v[66:67]
  v_pk_fma_f32 v[184:185], v[184:185], v[182:183], v[180:181]
  v_pk_mul_f32 v[184:185], v[184:185], v[66:67]
  v_exp_f32 v184, v184
  v_exp_f32 v185, v185
  s_nop 0
  v_pk_add_f32 v[184:185], v[184:185], 1.0 op_sel_hi:[1,0]
  v_rcp_f32 v184, v184
  v_rcp_f32 v185, v185
  s_nop 0
  v_pk_mul_f32 v[66:67], v[66:67], v[184:185]
  v_lshlrev_b32 v184, 16, v210
  v_and_b32 v185, 0xffff0000, v210
  v_pk_add_f32 v[68:69], v[68:69], v[184:185]
  v_pk_mul_f32 v[184:185], v[68:69], v[68:69]
  v_pk_fma_f32 v[184:185], v[184:185], v[182:183], v[180:181]
  v_pk_mul_f32 v[184:185], v[184:185], v[68:69]
  v_exp_f32 v184, v184
  v_exp_f32 v185, v185
  s_nop 0
  v_pk_add_f32 v[184:185], v[184:185], 1.0 op_sel_hi:[1,0]
  v_rcp_f32 v184, v184
  v_rcp_f32 v185, v185
  s_nop 0
  v_pk_mul_f32 v[68:69], v[68:69], v[184:185]
  v_lshlrev_b32 v184, 16, v211
  v_and_b32 v185, 0xffff0000, v211
  v_pk_add_f32 v[70:71], v[70:71], v[184:185]
  v_pk_mul_f32 v[184:185], v[70:71], v[70:71]
  v_pk_fma_f32 v[184:185], v[184:185], v[182:183], v[180:181]
  v_pk_mul_f32 v[184:185], v[184:185], v[70:71]
  v_exp_f32 v184, v184
  v_exp_f32 v185, v185
  s_nop 0
  v_pk_add_f32 v[184:185], v[184:185], 1.0 op_sel_hi:[1,0]
  v_rcp_f32 v184, v184
  v_rcp_f32 v185, v185
  s_nop 0
  v_pk_mul_f32 v[70:71], v[70:71], v[184:185]
  v_cvt_pk_bf16_f32 v168, v64, v65
  v_cvt_pk_bf16_f32 v169, v66, v67
  v_cvt_pk_bf16_f32 v170, v68, v69
  v_cvt_pk_bf16_f32 v171, v70, v71
  buffer_store_dwordx4 v[168:171], v20, s[4:7], s40 offen sc1
  s_add_u32 s40, s40, 1024
  v_lshlrev_b32 v184, 16, v212
  v_and_b32 v185, 0xffff0000, v212
  v_pk_add_f32 v[72:73], v[72:73], v[184:185]
  v_pk_mul_f32 v[184:185], v[72:73], v[72:73]
  v_pk_fma_f32 v[184:185], v[184:185], v[182:183], v[180:181]
  v_pk_mul_f32 v[184:185], v[184:185], v[72:73]
  v_exp_f32 v184, v184
  v_exp_f32 v185, v185
  s_nop 0
  v_pk_add_f32 v[184:185], v[184:185], 1.0 op_sel_hi:[1,0]
  v_rcp_f32 v184, v184
  v_rcp_f32 v185, v185
  s_nop 0
  v_pk_mul_f32 v[72:73], v[72:73], v[184:185]
  v_lshlrev_b32 v184, 16, v213
  v_and_b32 v185, 0xffff0000, v213
  v_pk_add_f32 v[74:75], v[74:75], v[184:185]
  v_pk_mul_f32 v[184:185], v[74:75], v[74:75]
  v_pk_fma_f32 v[184:185], v[184:185], v[182:183], v[180:181]
  v_pk_mul_f32 v[184:185], v[184:185], v[74:75]
  v_exp_f32 v184, v184
  v_exp_f32 v185, v185
  s_nop 0
  v_pk_add_f32 v[184:185], v[184:185], 1.0 op_sel_hi:[1,0]
  v_rcp_f32 v184, v184
  v_rcp_f32 v185, v185
  s_nop 0
  v_pk_mul_f32 v[74:75], v[74:75], v[184:185]
  v_lshlrev_b32 v184, 16, v214
  v_and_b32 v185, 0xffff0000, v214
  v_pk_add_f32 v[76:77], v[76:77], v[184:185]
  v_pk_mul_f32 v[184:185], v[76:77], v[76:77]
  v_pk_fma_f32 v[184:185], v[184:185], v[182:183], v[180:181]
  v_pk_mul_f32 v[184:185], v[184:185], v[76:77]
  v_exp_f32 v184, v184
  v_exp_f32 v185, v185
  s_nop 0
  v_pk_add_f32 v[184:185], v[184:185], 1.0 op_sel_hi:[1,0]
  v_rcp_f32 v184, v184
  v_rcp_f32 v185, v185
  s_nop 0
  v_pk_mul_f32 v[76:77], v[76:77], v[184:185]
  v_lshlrev_b32 v184, 16, v215
  v_and_b32 v185, 0xffff0000, v215
  v_pk_add_f32 v[78:79], v[78:79], v[184:185]
  v_pk_mul_f32 v[184:185], v[78:79], v[78:79]
  v_pk_fma_f32 v[184:185], v[184:185], v[182:183], v[180:181]
  v_pk_mul_f32 v[184:185], v[184:185], v[78:79]
  v_exp_f32 v184, v184
  v_exp_f32 v185, v185
  s_nop 0
  v_pk_add_f32 v[184:185], v[184:185], 1.0 op_sel_hi:[1,0]
  v_rcp_f32 v184, v184
  v_rcp_f32 v185, v185
  s_nop 0
  v_pk_mul_f32 v[78:79], v[78:79], v[184:185]
  v_cvt_pk_bf16_f32 v172, v72, v73
  v_cvt_pk_bf16_f32 v173, v74, v75
  v_cvt_pk_bf16_f32 v174, v76, v77
  v_cvt_pk_bf16_f32 v175, v78, v79
  buffer_store_dwordx4 v[172:175], v20, s[4:7], s40 offen sc1
  s_add_u32 s40, s40, 1024
  s_waitcnt vmcnt(0)
  s_barrier
  s_cmp_lg_u32 s34, 0
  s_cbranch_scc1 pub_138
  s_lshl_b32 s40, s54, 7
  s_add_u32 s40, s40, 46080
  v_and_b32 v16, 63, v0
  v_cmp_eq_u32 vcc, 0, v16
  v_mov_b32 v17, 0x7ffffff0
  s_nop 0
  v_cndmask_b32 v16, v17, 0, vcc
  v_mov_b32 v17, 1
  buffer_store_dword v17, v16, s[4:7], s40 offen sc1
pub_138:
L_g2:
  s_lshr_b32 s44, s32, 1
  s_lshl_b32 s44, s44, 3
  s_lshr_b32 s40, s33, 2
  s_add_u32 s44, s44, s40
  s_and_b32 s45, s32, 1
  s_lshl_b32 s45, s45, 2
  s_and_b32 s40, s33, 3
  s_add_u32 s45, s45, s40
  s_mul_i32 s46, s34, 14
  s_cmp_eq_u32 s34, 3
  s_cselect_b32 s40, 1, 0
  s_sub_u32 s46, s46, s40
  s_load_dwordx2 s[16:17], s[0:1], 88
  s_mov_b32 s18, 0x1000
  s_mov_b32 s19, 0x00020000
  s_load_dwordx2 s[20:21], s[0:1], 112
  s_mov_b32 s22, 0x280000
  s_mov_b32 s23, 0x00020000
  s_waitcnt lgkmcnt(0)
  v_and_b32 v13, 63, v0
  v_mov_b32 v20, 0x0
  v_mad_i32_i24 v20, v13, 16, v20
  s_mul_i32 s40, s45, 276480
  s_lshl_b32 s41, s46, 10
  s_add_u32 s40, s40, s41
  s_add_u32 s40, s40, 6815744
  s_add_u32 s48, s40, 0
  s_add_u32 s49, s40, 55296
  s_add_u32 s50, s40, 110592
  s_add_u32 s51, s40, 165888
  s_add_u32 s52, s40, 221184
  v_and_b32 v14, 15, v0
  v_mov_b32 v17, 0x0
  s_mov_b32 s36, 0xa00
  v_mad_i32_i24 v17, v14, s36, v17
  v_bfe_u32 v14, v0, 4, 2
  v_mad_i32_i24 v17, v14, 16, v17
  v_lshrrev_b32 v14, 6, v0
  s_mov_b32 s36, 0xa000
  v_mad_i32_i24 v17, v14, s36, v17
  s_mul_i32 s40, s44, 163840
  s_mul_i32 s41, s45, 320
  s_add_u32 s40, s40, s41
  s_add_u32 s53, s40, 14680064
  v_bfe_u32 v14, v0, 4, 2
  v_mov_b32 v18, 0x0
  v_mad_i32_i24 v18, v14, 16, v18
  s_mul_i32 s40, s45, 320
  s_add_u32 s54, s40, 78336
  v_and_b32 v14, 15, v0
  v_mov_b32 v19, 0x0
  v_mad_i32_i24 v19, v14, 2, v19
  v_lshrrev_b32 v14, 6, v0
  v_mad_i32_i24 v19, v14, 32, v19
  s_lshl_b32 s55, s44, 7
  v_and_b32 v13, 63, v0
  v_min_u32 v13, 63, v13
  v_lshlrev_b32 v13, 7, v13
  v_add_u32 v16, 0xb400, v13
  v_and_b32 v13, 63, v0
  v_min_u32 v13, 25, v13
  v_lshlrev_b32 v13, 7, v13
  v_add_u32 v15, 0xd400, v13
  s_cmp_lg_u32 s80, 0
  s_cbranch_scc1 gate0_139
  s_cmp_lg_u32 s34, 0
  s_cbranch_scc1 pd_141
  v_mov_b32 v13, 32
poll_142:
  buffer_load_dword v14, v13, s[8:11], 0 offen sc1
  s_waitcnt vmcnt(0)
  v_cmp_gt_u32 vcc, 40, v14
  s_cbranch_vccz polled_143
  s_sleep 3
  s_add_u32 s35, s35, 1
  s_cmp_lt_u32 s35, 300000
  s_cbranch_scc1 poll_142
polled_143:
pd_141:
  s_barrier
  s_cmp_lg_u32 s34, 0
  s_cbranch_scc1 pd_144
  v_mov_b32 v13, 160
poll_145:
  buffer_load_dword v14, v13, s[8:11], 0 offen sc1
  s_waitcnt vmcnt(0)
  v_cmp_gt_u32 vcc, 80, v14
  s_cbranch_vccz polled_146
  s_sleep 3
  s_add_u32 s35, s35, 1
  s_cmp_lt_u32 s35, 300000
  s_cbranch_scc1 poll_145
polled_146:
pd_144:
  s_barrier
  s_lshl_b32 s42, s44, 1
  s_add_u32 s42, s42, 6
  s_min_u32 s42, s42, 64
  v_mov_b32 v13, 24576
  s_cmp_lg_u32 s34, 0
  s_cbranch_scc1 pw_147
poll_148:
  buffer_load_dword v14, v13, s[4:7], 0 offen sc1
  s_waitcnt vmcnt(0)
  v_cmp_gt_u32 vcc, s42, v14
  s_cbranch_vccz polled_149
  s_sleep 24
  s_add_u32 s35, s35, 1
  s_cmp_lt_u32 s35, 300000
  s_cbranch_scc1 poll_148
polled_149:
pw_147:
  s_barrier
gate0_139:
  s_cmp_eq_u32 s80, 1
  s_cbranch_scc1 gate1_140
  v_and_b32 v14, 63, v0
  v_min_u32 v14, 31, v14
  v_lshlrev_b32 v14, 7, v14
  v_add_u32 v13, 0xa400, v14
  s_lshl_b32 s42, s44, 1
  s_add_u32 s42, s42, 2
  s_cmp_lg_u32 s34, 0
  s_cbranch_scc1 pw_150
poll_151:
  buffer_load_dword v14, v13, s[4:7], 0 offen sc1
  s_waitcnt vmcnt(0)
  v_cmp_gt_u32 vcc, s42, v14
  s_cbranch_vccz polled_152
  s_sleep 6
  s_add_u32 s35, s35, 1
  s_cmp_lt_u32 s35, 300000
  s_cbranch_scc1 poll_151
polled_152:
pw_150:
  s_barrier
gate1_140:
  buffer_load_dwordx4 v[192:195], v17, s[4:7], s53 offen offset:0 sc1
  buffer_load_dwordx4 v[196:199], v17, s[4:7], s53 offen offset:64 sc1
  buffer_load_dwordx4 v[200:203], v17, s[4:7], s53 offen offset:128 sc1
  buffer_load_dwordx4 v[204:207], v17, s[4:7], s53 offen offset:192 sc1
  buffer_load_dwordx4 v[208:211], v17, s[4:7], s53 offen offset:256 sc1
  buffer_load_dwordx4 v[212:215], v18, s[4:7], s54 offen offset:0 sc1
  buffer_load_dwordx4 v[216:219], v18, s[4:7], s54 offen offset:64 sc1
  buffer_load_dwordx4 v[220:223], v18, s[4:7], s54 offen offset:128 sc1
  buffer_load_dwordx4 v[224:227], v18, s[4:7], s54 offen offset:192 sc1
  buffer_load_dwordx4 v[228:231], v18, s[4:7], s54 offen offset:256 sc1
  buffer_load_ushort v232, v19, s[16:19], s55 offen
  s_cmp_lg_u32 s34, 0
  s_cbranch_scc1 g2w_153
  s_cmp_eq_u32 s80, 1
  s_cbranch_scc1 gate2_154
  v_mov_b32 v13, 24576
poll_155:
  buffer_load_dword v14, v13, s[4:7], 0 offen sc1
  s_waitcnt vmcnt(0)
  v_cmp_gt_u32 vcc, 64, v14
  s_cbranch_vccz polled_156
  s_sleep 12
  s_add_u32 s35, s35, 1
  s_cmp_lt_u32 s35, 300000
  s_cbranch_scc1 poll_155
polled_156:
gate2_154:
g2p_157:
  buffer_load_dword v13, v16, s[4:7], 0 offen sc1
  buffer_load_dword v14, v15, s[4:7], 0 offen sc1
  s_waitcnt vmcnt(0)
  v_min_u32 v13, v13, v14
  v_cmp_gt_u32 vcc, 1, v13
  s_cbranch_vccz g2pd_158
  s_sleep 1
  s_add_u32 s35, s35, 1
  s_cmp_lt_u32 s35, 300000
  s_cbranch_scc1 g2p_157
g2pd_158:
g2w_153:
  s_barrier
  buffer_load_dwordx4 v[112:115], v20, s[4:7], s48 offen offset:0 sc1
  buffer_load_dwordx4 v[116:119], v20, s[4:7], s49 offen offset:0 sc1
  buffer_load_dwordx4 v[120:123], v20, s[4:7], s50 offen offset:0 sc1
  buffer_load_dwordx4 v[124:127], v20, s[4:7], s51 offen offset:0 sc1
  buffer_load_dwordx4 v[128:131], v20, s[4:7], s52 offen offset:0 sc1
  s_waitcnt vmcnt(4)
  v_mfma_f32_16x16x32_bf16 v[32:35], v[112:115], a[0:3], 0
  buffer_load_dwordx4 v[132:135], v20, s[4:7], s48 offen offset:1024 sc1
  v_mfma_f32_16x16x32_bf16 v[36:39], v[112:115], a[56:59], 0
  buffer_load_dwordx4 v[136:139], v20, s[4:7], s49 offen offset:1024 sc1
  v_mfma_f32_16x16x32_bf16 v[40:43], v[112:115], a[112:115], 0
  buffer_load_dwordx4 v[140:143], v20, s[4:7], s50 offen offset:1024 sc1
  v_mfma_f32_16x16x32_bf16 v[44:47], v[112:115], a[168:171], 0
  s_waitcnt vmcnt(6)
  v_mfma_f32_16x16x32_bf16 v[48:51], v[116:119], a[0:3], 0
  buffer_load_dwordx4 v[144:147], v20, s[4:7], s51 offen offset:1024 sc1
  v_mfma_f32_16x16x32_bf16 v[52:55], v[116:119], a[56:59], 0
  buffer_load_dwordx4 v[148:151], v20, s[4:7], s52 offen offset:1024 sc1
  v_mfma_f32_16x16x32_bf16 v[56:59], v[116:119], a[112:115], 0
  buffer_load_dwordx4 v[152:155], v20, s[4:7], s48 offen offset:2048 sc1
  v_mfma_f32_16x16x32_bf16 v[60:63], v[116:119], a[168:171], 0
  s_waitcnt vmcnt(8)
  v_mfma_f32_16x16x32_bf16 v[64:67], v[120:123], a[0:3], 0
  buffer_load_dwordx4 v[156:159], v20, s[4:7], s49 offen offset:2048 sc1
  v_mfma_f32_16x16x32_bf16 v[68:71], v[120:123], a[56:59], 0
  buffer_load_dwordx4 v[160:163], v20, s[4:7], s50 offen offset:2048 sc1
  v_mfma_f32_16x16x32_bf16 v[72:75], v[120:123], a[112:115], 0
  buffer_load_dwordx4 v[164:167], v20, s[4:7], s51 offen offset:2048 sc1
  v_mfma_f32_16x16x32_bf16 v[76:79], v[120:123], a[168:171], 0
  s_waitcnt vmcnt(10)
  v_mfma_f32_16x16x32_bf16 v[80:83], v[124:127], a[0:3], 0
  buffer_load_dwordx4 v[168:171], v20, s[4:7], s52 offen offset:2048 sc1
  v_mfma_f32_16x16x32_bf16 v[84:87], v[124:127], a[56:59], 0
  buffer_load_dwordx4 v[172:175], v20, s[4:7], s48 offen offset:3072 sc1
  s_add_u32 s48, s48, 4096
  v_mfma_f32_16x16x32_bf16 v[88:91], v[124:127], a[112:115], 0
  buffer_load_dwordx4 v[176:179], v20, s[4:7], s49 offen offset:3072 sc1
  s_add_u32 s49, s49, 4096
  v_mfma_f32_16x16x32_bf16 v[92:95], v[124:127], a[168:171], 0
  s_waitcnt vmcnt(12)
  v_mfma_f32_16x16x32_bf16 v[96:99], v[128:131], a[0:3], 0
  buffer_load_dwordx4 v[180:183], v20, s[4:7], s50 offen offset:3072 sc1
  s_add_u32 s50, s50, 4096
  v_mfma_f32_16x16x32_bf16 v[100:103], v[128:131], a[56:59], 0
  buffer_load_dwordx4 v[184:187], v20, s[4:7], s51 offen offset:3072 sc1
  s_add_u32 s51, s51, 4096
  v_mfma_f32_16x16x32_bf16 v[104:107], v[128:131], a[112:115], 0
  buffer_load_dwordx4 v[188:191], v20, s[4:7], s52 offen offset:3072 sc1
  s_add_u32 s52, s52, 4096
  v_mfma_f32_16x16x32_bf16 v[108:111], v[128:131], a[168:171], 0
  s_waitcnt vmcnt(14)
  v_mfma_f32_16x16x32_bf16 v[32:35], v[132:135], a[4:7], v[32:35]
  buffer_load_dwordx4 v[112:115], v20, s[4:7], s48 offen offset:0 sc1
  v_mfma_f32_16x16x32_bf16 v[36:39], v[132:135], a[60:63], v[36:39]
  v_mfma_f32_16x16x32_bf16 v[40:43], v[132:135], a[116:119], v[40:43]
  v_mfma_f32_16x16x32_bf16 v[44:47], v[132:135], a[172:175], v[44:47]
  s_waitcnt vmcnt(14)
  v_mfma_f32_16x16x32_bf16 v[48:51], v[136:139], a[4:7], v[48:51]
  buffer_load_dwordx4 v[116:119], v20, s[4:7], s49 offen offset:0 sc1
  v_mfma_f32_16x16x32_bf16 v[52:55], v[136:139], a[60:63], v[52:55]
  v_mfma_f32_16x16x32_bf16 v[56:59], v[136:139], a[116:119], v[56:59]
  v_mfma_f32_16x16x32_bf16 v[60:63], v[136:139], a[172:175], v[60:63]
  s_waitcnt vmcnt(14)
  v_mfma_f32_16x16x32_bf16 v[64:67], v[140:143], a[4:7], v[64:67]
  buffer_load_dwordx4 v[120:123], v20, s[4:7], s50 offen offset:0 sc1
  v_mfma_f32_16x16x32_bf16 v[68:71], v[140:143], a[60:63], v[68:71]
  v_mfma_f32_16x16x32_bf16 v[72:75], v[140:143], a[116:119], v[72:75]
  v_mfma_f32_16x16x32_bf16 v[76:79], v[140:143], a[172:175], v[76:79]
  s_waitcnt vmcnt(14)
  v_mfma_f32_16x16x32_bf16 v[80:83], v[144:147], a[4:7], v[80:83]
  buffer_load_dwordx4 v[124:127], v20, s[4:7], s51 offen offset:0 sc1
  v_mfma_f32_16x16x32_bf16 v[84:87], v[144:147], a[60:63], v[84:87]
  v_mfma_f32_16x16x32_bf16 v[88:91], v[144:147], a[116:119], v[88:91]
  v_mfma_f32_16x16x32_bf16 v[92:95], v[144:147], a[172:175], v[92:95]
  s_waitcnt vmcnt(14)
  v_mfma_f32_16x16x32_bf16 v[96:99], v[148:151], a[4:7], v[96:99]
  buffer_load_dwordx4 v[128:131], v20, s[4:7], s52 offen offset:0 sc1
  v_mfma_f32_16x16x32_bf16 v[100:103], v[148:151], a[60:63], v[100:103]
  v_mfma_f32_16x16x32_bf16 v[104:107], v[148:151], a[116:119], v[104:107]
  v_mfma_f32_16x16x32_bf16 v[108:111], v[148:151], a[172:175], v[108:111]
  s_waitcnt vmcnt(14)
  v_mfma_f32_16x16x32_bf16 v[32:35], v[152:155], a[8:11], v[32:35]
  buffer_load_dwordx4 v[132:135], v20, s[4:7], s48 offen offset:1024 sc1
  v_mfma_f32_16x16x32_bf16 v[36:39], v[152:155], a[64:67], v[36:39]
  v_mfma_f32_16x16x32_bf16 v[40:43], v[152:155], a[120:123], v[40:43]
  v_mfma_f32_16x16x32_bf16 v[44:47], v[152:155], a[176:179], v[44:47]
  s_waitcnt vmcnt(14)
  v_mfma_f32_16x16x32_bf16 v[48:51], v[156:159], a[8:11], v[48:51]
  buffer_load_dwordx4 v[136:139], v20, s[4:7], s49 offen offset:1024 sc1
  v_mfma_f32_16x16x32_bf16 v[52:55], v[156:159], a[64:67], v[52:55]
  v_mfma_f32_16x16x32_bf16 v[56:59], v[156:159], a[120:123], v[56:59]
  v_mfma_f32_16x16x32_bf16 v[60:63], v[156:159], a[176:179], v[60:63]
  s_waitcnt vmcnt(14)
  v_mfma_f32_16x16x32_bf16 v[64:67], v[160:163], a[8:11], v[64:67]
  buffer_load_dwordx4 v[140:143], v20, s[4:7], s50 offen offset:1024 sc1
  v_mfma_f32_16x16x32_bf16 v[68:71], v[160:163], a[64:67], v[68:71]
  v_mfma_f32_16x16x32_bf16 v[72:75], v[160:163], a[120:123], v[72:75]
  v_mfma_f32_16x16x32_bf16 v[76:79], v[160:163], a[176:179], v[76:79]
  s_waitcnt vmcnt(14)
  v_mfma_f32_16x16x32_bf16 v[80:83], v[164:167], a[8:11], v[80:83]
  buffer_load_dwordx4 v[144:147], v20, s[4:7], s51 offen offset:1024 sc1
  v_mfma_f32_16x16x32_bf16 v[84:87], v[164:167], a[64:67], v[84:87]
  v_mfma_f32_16x16x32_bf16 v[88:91], v[164:167], a[120:123], v[88:91]
  v_mfma_f32_16x16x32_bf16 v[92:95], v[164:167], a[176:179], v[92:95]
  s_waitcnt vmcnt(14)
  v_mfma_f32_16x16x32_bf16 v[96:99], v[168:171], a[8:11], v[96:99]
  buffer_load_dwordx4 v[148:151], v20, s[4:7], s52 offen offset:1024 sc1
  v_mfma_f32_16x16x32_bf16 v[100:103], v[168:171], a[64:67], v[100:103]
  v_mfma_f32_16x16x32_bf16 v[104:107], v[168:171], a[120:123], v[104:107]
  v_mfma_f32_16x16x32_bf16 v[108:111], v[168:171], a[176:179], v[108:111]
  s_waitcnt vmcnt(14)
  v_mfma_f32_16x16x32_bf16 v[32:35], v[172:175], a[12:15], v[32:35]
  buffer_load_dwordx4 v[152:155], v20, s[4:7], s48 offen offset:2048 sc1
  v_mfma_f32_16x16x32_bf16 v[36:39], v[172:175], a[68:71], v[36:39]
  v_mfma_f32_16x16x32_bf16 v[40:43], v[172:175], a[124:127], v[40:43]
  v_mfma_f32_16x16x32_bf16 v[44:47], v[172:175], a[180:183], v[44:47]
  s_waitcnt vmcnt(14)
  v_mfma_f32_16x16x32_bf16 v[48:51], v[176:179], a[12:15], v[48:51]
  buffer_load_dwordx4 v[156:159], v20, s[4:7], s49 offen offset:2048 sc1
  v_mfma_f32_16x16x32_bf16 v[52:55], v[176:179], a[68:71], v[52:55]
  v_mfma_f32_16x16x32_bf16 v[56:59], v[176:179], a[124:127], v[56:59]
  v_mfma_f32_16x16x32_bf16 v[60:63], v[176:179], a[180:183], v[60:63]
  s_waitcnt vmcnt(14)
  v_mfma_f32_16x16x32_bf16 v[64:67], v[180:183], a[12:15], v[64:67]
  buffer_load_dwordx4 v[160:163], v20, s[4:7], s50 offen offset:2048 sc1
  v_mfma_f32_16x16x32_bf16 v[68:71], v[180:183], a[68:71], v[68:71]
  v_mfma_f32_16x16x32_bf16 v[72:75], v[180:183], a[124:127], v[72:75]
  v_mfma_f32_16x16x32_bf16 v[76:79], v[180:183], a[180:183], v[76:79]
  s_waitcnt vmcnt(14)
  v_mfma_f32_16x16x32_bf16 v[80:83], v[184:187], a[12:15], v[80:83]
  buffer_load_dwordx4 v[164:167], v20, s[4:7], s51 offen offset:2048 sc1
  v_mfma_f32_16x16x32_bf16 v[84:87], v[184:187], a[68:71], v[84:87]
  v_mfma_f32_16x16x32_bf16 v[88:91], v[184:187], a[124:127], v[88:91]
  v_mfma_f32_16x16x32_bf16 v[92:95], v[184:187], a[180:183], v[92:95]
  s_waitcnt vmcnt(14)
  v_mfma_f32_16x16x32_bf16 v[96:99], v[188:191], a[12:15], v[96:99]
  buffer_load_dwordx4 v[168:171], v20, s[4:7], s52 offen offset:2048 sc1
  v_mfma_f32_16x16x32_bf16 v[100:103], v[188:191], a[68:71], v[100:103]
  v_mfma_f32_16x16x32_bf16 v[104:107], v[188:191], a[124:127], v[104:107]
  v_mfma_f32_16x16x32_bf16 v[108:111], v[188:191], a[180:183], v[108:111]
  s_waitcnt vmcnt(14)
  v_mfma_f32_16x16x32_bf16 v[32:35], v[112:115], a[16:19], v[32:35]
  buffer_load_dwordx4 v[172:175], v20, s[4:7], s48 offen offset:3072 sc1
  s_add_u32 s48, s48, 4096
  v_mfma_f32_16x16x32_bf16 v[36:39], v[112:115], a[72:75], v[36:39]
  v_mfma_f32_16x16x32_bf16 v[40:43], v[112:115], a[128:131], v[40:43]
  v_mfma_f32_16x16x32_bf16 v[44:47], v[112:115], a[184:187], v[44:47]
  s_waitcnt vmcnt(14)
  v_mfma_f32_16x16x32_bf16 v[48:51], v[116:119], a[16:19], v[48:51]
  buffer_load_dwordx4 v[176:179], v20, s[4:7], s49 offen offset:3072 sc1
  s_add_u32 s49, s49, 4096
  v_mfma_f32_16x16x32_bf16 v[52:55], v[116:119], a[72:75], v[52:55]
  v_mfma_f32_16x16x32_bf16 v[56:59], v[116:119], a[128:131], v[56:59]
  v_mfma_f32_16x16x32_bf16 v[60:63], v[116:119], a[184:187], v[60:63]
  s_waitcnt vmcnt(14)
  v_mfma_f32_16x16x32_bf16 v[64:67], v[120:123], a[16:19], v[64:67]
  buffer_load_dwordx4 v[180:183], v20, s[4:7], s50 offen offset:3072 sc1
  s_add_u32 s50, s50, 4096
  v_mfma_f32_16x16x32_bf16 v[68:71], v[120:123], a[72:75], v[68:71]
  v_mfma_f32_16x16x32_bf16 v[72:75], v[120:123], a[128:131], v[72:75]
  v_mfma_f32_16x16x32_bf16 v[76:79], v[120:123], a[184:187], v[76:79]
  s_waitcnt vmcnt(14)
  v_mfma_f32_16x16x32_bf16 v[80:83], v[124:127], a[16:19], v[80:83]
  buffer_load_dwordx4 v[184:187], v20, s[4:7], s51 offen offset:3072 sc1
  s_add_u32 s51, s51, 4096
  v_mfma_f32_16x16x32_bf16 v[84:87], v[124:127], a[72:75], v[84:87]
  v_mfma_f32_16x16x32_bf16 v[88:91], v[124:127], a[128:131], v[88:91]
  v_mfma_f32_16x16x32_bf16 v[92:95], v[124:127], a[184:187], v[92:95]
  s_waitcnt vmcnt(14)
  v_mfma_f32_16x16x32_bf16 v[96:99], v[128:131], a[16:19], v[96:99]
  buffer_load_dwordx4 v[188:191], v20, s[4:7], s52 offen offset:3072 sc1
  s_add_u32 s52, s52, 4096
  v_mfma_f32_16x16x32_bf16 v[100:103], v[128:131], a[72:75], v[100:103]
  v_mfma_f32_16x16x32_bf16 v[104:107], v[128:131], a[128:131], v[104:107]
  v_mfma_f32_16x16x32_bf16 v[108:111], v[128:131], a[184:187], v[108:111]
  s_waitcnt vmcnt(14)
  v_mfma_f32_16x16x32_bf16 v[32:35], v[132:135], a[20:23], v[32:35]
  buffer_load_dwordx4 v[112:115], v20, s[4:7], s48 offen offset:0 sc1
  v_mfma_f32_16x16x32_bf16 v[36:39], v[132:135], a[76:79], v[36:39]
  v_mfma_f32_16x16x32_bf16 v[40:43], v[132:135], a[132:135], v[40:43]
  v_mfma_f32_16x16x32_bf16 v[44:47], v[132:135], a[188:191], v[44:47]
  s_waitcnt vmcnt(14)
  v_mfma_f32_16x16x32_bf16 v[48:51], v[136:139], a[20:23], v[48:51]
  buffer_load_dwordx4 v[116:119], v20, s[4:7], s49 offen offset:0 sc1
  v_mfma_f32_16x16x32_bf16 v[52:55], v[136:139], a[76:79], v[52:55]
  v_mfma_f32_16x16x32_bf16 v[56:59], v[136:139], a[132:135], v[56:59]
  v_mfma_f32_16x16x32_bf16 v[60:63], v[136:139], a[188:191], v[60:63]
  s_waitcnt vmcnt(14)
  v_mfma_f32_16x16x32_bf16 v[64:67], v[140:143], a[20:23], v[64:67]
  buffer_load_dwordx4 v[120:123], v20, s[4:7], s50 offen offset:0 sc1
  v_mfma_f32_16x16x32_bf16 v[68:71], v[140:143], a[76:79], v[68:71]
  v_mfma_f32_16x16x32_bf16 v[72:75], v[140:143], a[132:135], v[72:75]
  v_mfma_f32_16x16x32_bf16 v[76:79], v[140:143], a[188:191], v[76:79]
  s_waitcnt vmcnt(14)
  v_mfma_f32_16x16x32_bf16 v[80:83], v[144:147], a[20:23], v[80:83]
  buffer_load_dwordx4 v[124:127], v20, s[4:7], s51 offen offset:0 sc1
  v_mfma_f32_16x16x32_bf16 v[84:87], v[144:147], a[76:79], v[84:87]
  v_mfma_f32_16x16x32_bf16 v[88:91], v[144:147], a[132:135], v[88:91]
  v_mfma_f32_16x16x32_bf16 v[92:95], v[144:147], a[188:191], v[92:95]
  s_waitcnt vmcnt(14)
  v_mfma_f32_16x16x32_bf16 v[96:99], v[148:151], a[20:23], v[96:99]
  buffer_load_dwordx4 v[128:131], v20, s[4:7], s52 offen offset:0 sc1
  v_mfma_f32_16x16x32_bf16 v[100:103], v[148:151], a[76:79], v[100:103]
  v_mfma_f32_16x16x32_bf16 v[104:107], v[148:151], a[132:135], v[104:107]
  v_mfma_f32_16x16x32_bf16 v[108:111], v[148:151], a[188:191], v[108:111]
  s_waitcnt vmcnt(14)
  v_mfma_f32_16x16x32_bf16 v[32:35], v[152:155], a[24:27], v[32:35]
  buffer_load_dwordx4 v[132:135], v20, s[4:7], s48 offen offset:1024 sc1
  v_mfma_f32_16x16x32_bf16 v[36:39], v[152:155], a[80:83], v[36:39]
  v_mfma_f32_16x16x32_bf16 v[40:43], v[152:155], a[136:139], v[40:43]
  v_mfma_f32_16x16x32_bf16 v[44:47], v[152:155], a[192:195], v[44:47]
  s_waitcnt vmcnt(14)
  v_mfma_f32_16x16x32_bf16 v[48:51], v[156:159], a[24:27], v[48:51]
  buffer_load_dwordx4 v[136:139], v20, s[4:7], s49 offen offset:1024 sc1
  v_mfma_f32_16x16x32_bf16 v[52:55], v[156:159], a[80:83], v[52:55]
  v_mfma_f32_16x16x32_bf16 v[56:59], v[156:159], a[136:139], v[56:59]
  v_mfma_f32_16x16x32_bf16 v[60:63], v[156:159], a[192:195], v[60:63]
  s_waitcnt vmcnt(14)
  v_mfma_f32_16x16x32_bf16 v[64:67], v[160:163], a[24:27], v[64:67]
  buffer_load_dwordx4 v[140:143], v20, s[4:7], s50 offen offset:1024 sc1
  v_mfma_f32_16x16x32_bf16 v[68:71], v[160:163], a[80:83], v[68:71]
  v_mfma_f32_16x16x32_bf16 v[72:75], v[160:163], a[136:139], v[72:75]
  v_mfma_f32_16x16x32_bf16 v[76:79], v[160:163], a[192:195], v[76:79]
  s_waitcnt vmcnt(14)
  v_mfma_f32_16x16x32_bf16 v[80:83], v[164:167], a[24:27], v[80:83]
  buffer_load_dwordx4 v[144:147], v20, s[4:7], s51 offen offset:1024 sc1
  v_mfma_f32_16x16x32_bf16 v[84:87], v[164:167], a[80:83], v[84:87]
  v_mfma_f32_16x16x32_bf16 v[88:91], v[164:167], a[136:139], v[88:91]
  v_mfma_f32_16x16x32_bf16 v[92:95], v[164:167], a[192:195], v[92:95]
  s_waitcnt vmcnt(14)
  v_mfma_f32_16x16x32_bf16 v[96:99], v[168:171], a[24:27], v[96:99]
  buffer_load_dwordx4 v[148:151], v20, s[4:7], s52 offen offset:1024 sc1
  v_mfma_f32_16x16x32_bf16 v[100:103], v[168:171], a[80:83], v[100:103]
  v_mfma_f32_16x16x32_bf16 v[104:107], v[168:171], a[136:139], v[104:107]
  v_mfma_f32_16x16x32_bf16 v[108:111], v[168:171], a[192:195], v[108:111]
  s_waitcnt vmcnt(14)
  v_mfma_f32_16x16x32_bf16 v[32:35], v[172:175], a[28:31], v[32:35]
  buffer_load_dwordx4 v[152:155], v20, s[4:7], s48 offen offset:2048 sc1
  v_mfma_f32_16x16x32_bf16 v[36:39], v[172:175], a[84:87], v[36:39]
  v_mfma_f32_16x16x32_bf16 v[40:43], v[172:175], a[140:143], v[40:43]
  v_mfma_f32_16x16x32_bf16 v[44:47], v[172:175], a[196:199], v[44:47]
  s_waitcnt vmcnt(14)
  v_mfma_f32_16x16x32_bf16 v[48:51], v[176:179], a[28:31], v[48:51]
  buffer_load_dwordx4 v[156:159], v20, s[4:7], s49 offen offset:2048 sc1
  v_mfma_f32_16x16x32_bf16 v[52:55], v[176:179], a[84:87], v[52:55]
  v_mfma_f32_16x16x32_bf16 v[56:59], v[176:179], a[140:143], v[56:59]
  v_mfma_f32_16x16x32_bf16 v[60:63], v[176:179], a[196:199], v[60:63]
  s_waitcnt vmcnt(14)
  v_mfma_f32_16x16x32_bf16 v[64:67], v[180:183], a[28:31], v[64:67]
  buffer_load_dwordx4 v[160:163], v20, s[4:7], s50 offen offset:2048 sc1
  v_mfma_f32_16x16x32_bf16 v[68:71], v[180:183], a[84:87], v[68:71]
  v_mfma_f32_16x16x32_bf16 v[72:75], v[180:183], a[140:143], v[72:75]
  v_mfma_f32_16x16x32_bf16 v[76:79], v[180:183], a[196:199], v[76:79]
  s_waitcnt vmcnt(14)
  v_mfma_f32_16x16x32_bf16 v[80:83], v[184:187], a[28:31], v[80:83]
  buffer_load_dwordx4 v[164:167], v20, s[4:7], s51 offen offset:2048 sc1
  v_mfma_f32_16x16x32_bf16 v[84:87], v[184:187], a[84:87], v[84:87]
  v_mfma_f32_16x16x32_bf16 v[88:91], v[184:187], a[140:143], v[88:91]
  v_mfma_f32_16x16x32_bf16 v[92:95], v[184:187], a[196:199], v[92:95]
  s_waitcnt vmcnt(14)
  v_mfma_f32_16x16x32_bf16 v[96:99], v[188:191], a[28:31], v[96:99]
  buffer_load_dwordx4 v[168:171], v20, s[4:7], s52 offen offset:2048 sc1
  v_mfma_f32_16x16x32_bf16 v[100:103], v[188:191], a[84:87], v[100:103]
  v_mfma_f32_16x16x32_bf16 v[104:107], v[188:191], a[140:143], v[104:107]
  v_mfma_f32_16x16x32_bf16 v[108:111], v[188:191], a[196:199], v[108:111]
  s_waitcnt vmcnt(14)
  v_mfma_f32_16x16x32_bf16 v[32:35], v[112:115], a[32:35], v[32:35]
  buffer_load_dwordx4 v[172:175], v20, s[4:7], s48 offen offset:3072 sc1
  s_add_u32 s48, s48, 4096
  v_mfma_f32_16x16x32_bf16 v[36:39], v[112:115], a[88:91], v[36:39]
  v_mfma_f32_16x16x32_bf16 v[40:43], v[112:115], a[144:147], v[40:43]
  v_mfma_f32_16x16x32_bf16 v[44:47], v[112:115], a[200:203], v[44:47]
  s_waitcnt vmcnt(14)
  v_mfma_f32_16x16x32_bf16 v[48:51], v[116:119], a[32:35], v[48:51]
  buffer_load_dwordx4 v[176:179], v20, s[4:7], s49 offen offset:3072 sc1
  s_add_u32 s49, s49, 4096
  v_mfma_f32_16x16x32_bf16 v[52:55], v[116:119], a[88:91], v[52:55]
  v_mfma_f32_16x16x32_bf16 v[56:59], v[116:119], a[144:147], v[56:59]
  v_mfma_f32_16x16x32_bf16 v[60:63], v[116:119], a[200:203], v[60:63]
  s_waitcnt vmcnt(14)
  v_mfma_f32_16x16x32_bf16 v[64:67], v[120:123], a[32:35], v[64:67]
  buffer_load_dwordx4 v[180:183], v20, s[4:7], s50 offen offset:3072 sc1
  s_add_u32 s50, s50, 4096
  v_mfma_f32_16x16x32_bf16 v[68:71], v[120:123], a[88:91], v[68:71]
  v_mfma_f32_16x16x32_bf16 v[72:75], v[120:123], a[144:147], v[72:75]
  v_mfma_f32_16x16x32_bf16 v[76:79], v[120:123], a[200:203], v[76:79]
  s_waitcnt vmcnt(14)
  v_mfma_f32_16x16x32_bf16 v[80:83], v[124:127], a[32:35], v[80:83]
  buffer_load_dwordx4 v[184:187], v20, s[4:7], s51 offen offset:3072 sc1
  s_add_u32 s51, s51, 4096
  v_mfma_f32_16x16x32_bf16 v[84:87], v[124:127], a[88:91], v[84:87]
  v_mfma_f32_16x16x32_bf16 v[88:91], v[124:127], a[144:147], v[88:91]
  v_mfma_f32_16x16x32_bf16 v[92:95], v[124:127], a[200:203], v[92:95]
  s_waitcnt vmcnt(14)
  v_mfma_f32_16x16x32_bf16 v[96:99], v[128:131], a[32:35], v[96:99]
  buffer_load_dwordx4 v[188:191], v20, s[4:7], s52 offen offset:3072 sc1
  s_add_u32 s52, s52, 4096
  v_mfma_f32_16x16x32_bf16 v[100:103], v[128:131], a[88:91], v[100:103]
  v_mfma_f32_16x16x32_bf16 v[104:107], v[128:131], a[144:147], v[104:107]
  v_mfma_f32_16x16x32_bf16 v[108:111], v[128:131], a[200:203], v[108:111]
  s_waitcnt vmcnt(14)
  v_mfma_f32_16x16x32_bf16 v[32:35], v[132:135], a[36:39], v[32:35]
  buffer_load_dwordx4 v[112:115], v20, s[4:7], s48 offen offset:0 sc1
  v_mfma_f32_16x16x32_bf16 v[36:39], v[132:135], a[92:95], v[36:39]
  v_mfma_f32_16x16x32_bf16 v[40:43], v[132:135], a[148:151], v[40:43]
  v_mfma_f32_16x16x32_bf16 v[44:47], v[132:135], a[204:207], v[44:47]
  s_waitcnt vmcnt(14)
  v_mfma_f32_16x16x32_bf16 v[48:51], v[136:139], a[36:39], v[48:51]
  buffer_load_dwordx4 v[116:119], v20, s[4:7], s49 offen offset:0 sc1
  v_mfma_f32_16x16x32_bf16 v[52:55], v[136:139], a[92:95], v[52:55]
  v_mfma_f32_16x16x32_bf16 v[56:59], v[136:139], a[148:151], v[56:59]
  v_mfma_f32_16x16x32_bf16 v[60:63], v[136:139], a[204:207], v[60:63]
  s_waitcnt vmcnt(14)
  v_mfma_f32_16x16x32_bf16 v[64:67], v[140:143], a[36:39], v[64:67]
  buffer_load_dwordx4 v[120:123], v20, s[4:7], s50 offen offset:0 sc1
  v_mfma_f32_16x16x32_bf16 v[68:71], v[140:143], a[92:95], v[68:71]
  v_mfma_f32_16x16x32_bf16 v[72:75], v[140:143], a[148:151], v[72:75]
  v_mfma_f32_16x16x32_bf16 v[76:79], v[140:143], a[204:207], v[76:79]
  s_waitcnt vmcnt(14)
  v_mfma_f32_16x16x32_bf16 v[80:83], v[144:147], a[36:39], v[80:83]
  buffer_load_dwordx4 v[124:127], v20, s[4:7], s51 offen offset:0 sc1
  v_mfma_f32_16x16x32_bf16 v[84:87], v[144:147], a[92:95], v[84:87]
  v_mfma_f32_16x16x32_bf16 v[88:91], v[144:147], a[148:151], v[88:91]
  v_mfma_f32_16x16x32_bf16 v[92:95], v[144:147], a[204:207], v[92:95]
  s_waitcnt vmcnt(14)
  v_mfma_f32_16x16x32_bf16 v[96:99], v[148:151], a[36:39], v[96:99]
  buffer_load_dwordx4 v[128:131], v20, s[4:7], s52 offen offset:0 sc1
  v_mfma_f32_16x16x32_bf16 v[100:103], v[148:151], a[92:95], v[100:103]
  v_mfma_f32_16x16x32_bf16 v[104:107], v[148:151], a[148:151], v[104:107]
  v_mfma_f32_16x16x32_bf16 v[108:111], v[148:151], a[204:207], v[108:111]
  s_waitcnt vmcnt(14)
  v_mfma_f32_16x16x32_bf16 v[32:35], v[152:155], a[40:43], v[32:35]
  buffer_load_dwordx4 v[132:135], v20, s[4:7], s48 offen offset:1024 sc1
  v_mfma_f32_16x16x32_bf16 v[36:39], v[152:155], a[96:99], v[36:39]
  v_mfma_f32_16x16x32_bf16 v[40:43], v[152:155], a[152:155], v[40:43]
  v_mfma_f32_16x16x32_bf16 v[44:47], v[152:155], a[208:211], v[44:47]
  s_waitcnt vmcnt(14)
  v_mfma_f32_16x16x32_bf16 v[48:51], v[156:159], a[40:43], v[48:51]
  buffer_load_dwordx4 v[136:139], v20, s[4:7], s49 offen offset:1024 sc1
  v_mfma_f32_16x16x32_bf16 v[52:55], v[156:159], a[96:99], v[52:55]
  v_mfma_f32_16x16x32_bf16 v[56:59], v[156:159], a[152:155], v[56:59]
  v_mfma_f32_16x16x32_bf16 v[60:63], v[156:159], a[208:211], v[60:63]
  s_waitcnt vmcnt(14)
  v_mfma_f32_16x16x32_bf16 v[64:67], v[160:163], a[40:43], v[64:67]
  buffer_load_dwordx4 v[140:143], v20, s[4:7], s50 offen offset:1024 sc1
  v_mfma_f32_16x16x32_bf16 v[68:71], v[160:163], a[96:99], v[68:71]
  v_mfma_f32_16x16x32_bf16 v[72:75], v[160:163], a[152:155], v[72:75]
  v_mfma_f32_16x16x32_bf16 v[76:79], v[160:163], a[208:211], v[76:79]
  s_waitcnt vmcnt(14)
  v_mfma_f32_16x16x32_bf16 v[80:83], v[164:167], a[40:43], v[80:83]
  buffer_load_dwordx4 v[144:147], v20, s[4:7], s51 offen offset:1024 sc1
  v_mfma_f32_16x16x32_bf16 v[84:87], v[164:167], a[96:99], v[84:87]
  v_mfma_f32_16x16x32_bf16 v[88:91], v[164:167], a[152:155], v[88:91]
  v_mfma_f32_16x16x32_bf16 v[92:95], v[164:167], a[208:211], v[92:95]
  s_waitcnt vmcnt(14)
  v_mfma_f32_16x16x32_bf16 v[96:99], v[168:171], a[40:43], v[96:99]
  buffer_load_dwordx4 v[148:151], v20, s[4:7], s52 offen offset:1024 sc1
  v_mfma_f32_16x16x32_bf16 v[100:103], v[168:171], a[96:99], v[100:103]
  v_mfma_f32_16x16x32_bf16 v[104:107], v[168:171], a[152:155], v[104:107]
  v_mfma_f32_16x16x32_bf16 v[108:111], v[168:171], a[208:211], v[108:111]
  s_waitcnt vmcnt(14)
  v_mfma_f32_16x16x32_bf16 v[32:35], v[172:175], a[44:47], v[32:35]
  v_mfma_f32_16x16x32_bf16 v[36:39], v[172:175], a[100:103], v[36:39]
  v_mfma_f32_16x16x32_bf16 v[40:43], v[172:175], a[156:159], v[40:43]
  v_mfma_f32_16x16x32_bf16 v[44:47], v[172:175], a[212:215], v[44:47]
  s_waitcnt vmcnt(13)
  v_mfma_f32_16x16x32_bf16 v[48:51], v[176:179], a[44:47], v[48:51]
  v_mfma_f32_16x16x32_bf16 v[52:55], v[176:179], a[100:103], v[52:55]
  v_mfma_f32_16x16x32_bf16 v[56:59], v[176:179], a[156:159], v[56:59]
  v_mfma_f32_16x16x32_bf16 v[60:63], v[176:179], a[212:215], v[60:63]
  s_waitcnt vmcnt(12)
  v_mfma_f32_16x16x32_bf16 v[64:67], v[180:183], a[44:47], v[64:67]
  v_mfma_f32_16x16x32_bf16 v[68:71], v[180:183], a[100:103], v[68:71]
  v_mfma_f32_16x16x32_bf16 v[72:75], v[180:183], a[156:159], v[72:75]
  v_mfma_f32_16x16x32_bf16 v[76:79], v[180:183], a[212:215], v[76:79]
  s_waitcnt vmcnt(11)
  v_mfma_f32_16x16x32_bf16 v[80:83], v[184:187], a[44:47], v[80:83]
  v_mfma_f32_16x16x32_bf16 v[84:87], v[184:187], a[100:103], v[84:87]
  v_mfma_f32_16x16x32_bf16 v[88:91], v[184:187], a[156:159], v[88:91]
  v_mfma_f32_16x16x32_bf16 v[92:95], v[184:187], a[212:215], v[92:95]
  s_waitcnt vmcnt(10)
  v_mfma_f32_16x16x32_bf16 v[96:99], v[188:191], a[44:47], v[96:99]
  v_mfma_f32_16x16x32_bf16 v[100:103], v[188:191], a[100:103], v[100:103]
  v_mfma_f32_16x16x32_bf16 v[104:107], v[188:191], a[156:159], v[104:107]
  v_mfma_f32_16x16x32_bf16 v[108:111], v[188:191], a[212:215], v[108:111]
  s_waitcnt vmcnt(9)
  v_mfma_f32_16x16x32_bf16 v[32:35], v[112:115], a[48:51], v[32:35]
  v_mfma_f32_16x16x32_bf16 v[36:39], v[112:115], a[104:107], v[36:39]
  v_mfma_f32_16x16x32_bf16 v[40:43], v[112:115], a[160:163], v[40:43]
  v_mfma_f32_16x16x32_bf16 v[44:47], v[112:115], a[216:219], v[44:47]
  s_waitcnt vmcnt(8)
  v_mfma_f32_16x16x32_bf16 v[48:51], v[116:119], a[48:51], v[48:51]
  v_mfma_f32_16x16x32_bf16 v[52:55], v[116:119], a[104:107], v[52:55]
  v_mfma_f32_16x16x32_bf16 v[56:59], v[116:119], a[160:163], v[56:59]
  v_mfma_f32_16x16x32_bf16 v[60:63], v[116:119], a[216:219], v[60:63]
  s_waitcnt vmcnt(7)
  v_mfma_f32_16x16x32_bf16 v[64:67], v[120:123], a[48:51], v[64:67]
  v_mfma_f32_16x16x32_bf16 v[68:71], v[120:123], a[104:107], v[68:71]
  v_mfma_f32_16x16x32_bf16 v[72:75], v[120:123], a[160:163], v[72:75]
  v_mfma_f32_16x16x32_bf16 v[76:79], v[120:123], a[216:219], v[76:79]
  s_waitcnt vmcnt(6)
  v_mfma_f32_16x16x32_bf16 v[80:83], v[124:127], a[48:51], v[80:83]
  v_mfma_f32_16x16x32_bf16 v[84:87], v[124:127], a[104:107], v[84:87]
  v_mfma_f32_16x16x32_bf16 v[88:91], v[124:127], a[160:163], v[88:91]
  v_mfma_f32_16x16x32_bf16 v[92:95], v[124:127], a[216:219], v[92:95]
  s_waitcnt vmcnt(5)
  v_mfma_f32_16x16x32_bf16 v[96:99], v[128:131], a[48:51], v[96:99]
  v_mfma_f32_16x16x32_bf16 v[100:103], v[128:131], a[104:107], v[100:103]
  v_mfma_f32_16x16x32_bf16 v[104:107], v[128:131], a[160:163], v[104:107]
  v_mfma_f32_16x16x32_bf16 v[108:111], v[128:131], a[216:219], v[108:111]
  s_cmp_ge_u32 s34, 2
  s_cbranch_scc1 g2last_159
  s_waitcnt vmcnt(4)
  v_mfma_f32_16x16x32_bf16 v[32:35], v[132:135], a[52:55], v[32:35]
  v_mfma_f32_16x16x32_bf16 v[36:39], v[132:135], a[108:111], v[36:39]
  v_mfma_f32_16x16x32_bf16 v[40:43], v[132:135], a[164:167], v[40:43]
  v_mfma_f32_16x16x32_bf16 v[44:47], v[132:135], a[220:223], v[44:47]
  s_waitcnt vmcnt(3)
  v_mfma_f32_16x16x32_bf16 v[48:51], v[136:139], a[52:55], v[48:51]
  v_mfma_f32_16x16x32_bf16 v[52:55], v[136:139], a[108:111], v[52:55]
  v_mfma_f32_16x16x32_bf16 v[56:59], v[136:139], a[164:167], v[56:59]
  v_mfma_f32_16x16x32_bf16 v[60:63], v[136:139], a[220:223], v[60:63]
  s_waitcnt vmcnt(2)
  v_mfma_f32_16x16x32_bf16 v[64:67], v[140:143], a[52:55], v[64:67]
  v_mfma_f32_16x16x32_bf16 v[68:71], v[140:143], a[108:111], v[68:71]
  v_mfma_f32_16x16x32_bf16 v[72:75], v[140:143], a[164:167], v[72:75]
  v_mfma_f32_16x16x32_bf16 v[76:79], v[140:143], a[220:223], v[76:79]
  s_waitcnt vmcnt(1)
  v_mfma_f32_16x16x32_bf16 v[80:83], v[144:147], a[52:55], v[80:83]
  v_mfma_f32_16x16x32_bf16 v[84:87], v[144:147], a[108:111], v[84:87]
  v_mfma_f32_16x16x32_bf16 v[88:91], v[144:147], a[164:167], v[88:91]
  v_mfma_f32_16x16x32_bf16 v[92:95], v[144:147], a[220:223], v[92:95]
  s_waitcnt vmcnt(0)
  v_mfma_f32_16x16x32_bf16 v[96:99], v[148:151], a[52:55], v[96:99]
  v_mfma_f32_16x16x32_bf16 v[100:103], v[148:151], a[108:111], v[100:103]
  v_mfma_f32_16x16x32_bf16 v[104:107], v[148:151], a[164:167], v[104:107]
  v_mfma_f32_16x16x32_bf16 v[108:111], v[148:151], a[220:223], v[108:111]
g2last_159:
  s_waitcnt vmcnt(0)
  s_barrier
  v_and_b32 v14, 63, v0
  v_mov_b32 v13, 0x0
  v_mad_i32_i24 v13, v14, 16, v13
  v_lshrrev_b32 v14, 6, v0
  s_mov_b32 s36, 0x5000
  v_mad_i32_i24 v13, v14, s36, v13
  ds_write_b128 v13, v[32:35] offset:0
  ds_write_b128 v13, v[36:39] offset:1024
  ds_write_b128 v13, v[40:43] offset:2048
  ds_write_b128 v13, v[44:47] offset:3072
  ds_write_b128 v13, v[48:51] offset:4096
  ds_write_b128 v13, v[52:55] offset:5120
  ds_write_b128 v13, v[56:59] offset:6144
  ds_write_b128 v13, v[60:63] offset:7168
  ds_write_b128 v13, v[64:67] offset:8192
  ds_write_b128 v13, v[68:71] offset:9216
  ds_write_b128 v13, v[72:75] offset:10240
  ds_write_b128 v13, v[76:79] offset:11264
  ds_write_b128 v13, v[80:83] offset:12288
  ds_write_b128 v13, v[84:87] offset:13312
  ds_write_b128 v13, v[88:91] offset:14336
  ds_write_b128 v13, v[92:95] offset:15360
  ds_write_b128 v13, v[96:99] offset:16384
  ds_write_b128 v13, v[100:103] offset:17408
  ds_write_b128 v13, v[104:107] offset:18432
  ds_write_b128 v13, v[108:111] offset:19456
  s_waitcnt lgkmcnt(0)
  s_barrier
  v_lshrrev_b32 v14, 0, v0
  v_mov_b32 v13, 0x0
  v_mad_i32_i24 v13, v14, 16, v13
  v_add_u32 v14, 0, v13
  ds_read_b128 v[112:115], v14 offset:0
  ds_read_b128 v[116:119], v14 offset:4096
  ds_read_b128 v[120:123], v14 offset:8192
  ds_read_b128 v[124:127], v14 offset:12288
  ds_read_b128 v[128:131], v14 offset:16384
  v_add_u32 v14, 20480, v13
  ds_read_b128 v[132:135], v14 offset:0
  ds_read_b128 v[136:139], v14 offset:4096
  ds_read_b128 v[140:143], v14 offset:8192
  ds_read_b128 v[144:147], v14 offset:12288
  ds_read_b128 v[148:151], v14 offset:16384
  v_add_u32 v14, 40960, v13
  ds_read_b128 v[152:155], v14 offset:0
  ds_read_b128 v[156:159], v14 offset:4096
  ds_read_b128 v[160:163], v14 offset:8192
  ds_read_b128 v[164:167], v14 offset:12288
  ds_read_b128 v[168:171], v14 offset:16384
  v_add_u32 v14, 61440, v13
  ds_read_b128 v[172:175], v14 offset:0
  ds_read_b128 v[176:179], v14 offset:4096
  ds_read_b128 v[180:183], v14 offset:8192
  ds_read_b128 v[184:187], v14 offset:12288
  ds_read_b128 v[188:191], v14 offset:16384
  s_waitcnt vmcnt(0) lgkmcnt(0)
  v_lshlrev_b32 v232, 16, v232
  v_mov_b32 v233, v232
  v_pk_add_f32 v[112:113], v[112:113], v[132:133]
  v_pk_add_f32 v[152:153], v[152:153], v[172:173]
  v_pk_add_f32 v[112:113], v[112:113], v[232:233]
  v_pk_add_f32 v[112:113], v[112:113], v[152:153]
  v_pk_fma_f32 v[192:193], v[212:213], v[112:113], v[192:193]
  v_pk_add_f32 v[114:115], v[114:115], v[134:135]
  v_pk_add_f32 v[154:155], v[154:155], v[174:175]
  v_pk_add_f32 v[114:115], v[114:115], v[232:233]
  v_pk_add_f32 v[114:115], v[114:115], v[154:155]
  v_pk_fma_f32 v[194:195], v[214:215], v[114:115], v[194:195]
  v_pk_add_f32 v[116:117], v[116:117], v[136:137]
  v_pk_add_f32 v[156:157], v[156:157], v[176:177]
  v_pk_add_f32 v[116:117], v[116:117], v[232:233]
  v_pk_add_f32 v[116:117], v[116:117], v[156:157]
  v_pk_fma_f32 v[196:197], v[216:217], v[116:117], v[196:197]
  v_pk_add_f32 v[118:119], v[118:119], v[138:139]
  v_pk_add_f32 v[158:159], v[158:159], v[178:179]
  v_pk_add_f32 v[118:119], v[118:119], v[232:233]
  v_pk_add_f32 v[118:119], v[118:119], v[158:159]
  v_pk_fma_f32 v[198:199], v[218:219], v[118:119], v[198:199]
  v_pk_add_f32 v[120:121], v[120:121], v[140:141]
  v_pk_add_f32 v[160:161], v[160:161], v[180:181]
  v_pk_add_f32 v[120:121], v[120:121], v[232:233]
  v_pk_add_f32 v[120:121], v[120:121], v[160:161]
  v_pk_fma_f32 v[200:201], v[220:221], v[120:121], v[200:201]
  v_pk_add_f32 v[122:123], v[122:123], v[142:143]
  v_pk_add_f32 v[162:163], v[162:163], v[182:183]
  v_pk_add_f32 v[122:123], v[122:123], v[232:233]
  v_pk_add_f32 v[122:123], v[122:123], v[162:163]
  v_pk_fma_f32 v[202:203], v[222:223], v[122:123], v[202:203]
  v_pk_add_f32 v[124:125], v[124:125], v[144:145]
  v_pk_add_f32 v[164:165], v[164:165], v[184:185]
  v_pk_add_f32 v[124:125], v[124:125], v[232:233]
  v_pk_add_f32 v[124:125], v[124:125], v[164:165]
  v_pk_fma_f32 v[204:205], v[224:225], v[124:125], v[204:205]
  v_pk_add_f32 v[126:127], v[126:127], v[146:147]
  v_pk_add_f32 v[166:167], v[166:167], v[186:187]
  v_pk_add_f32 v[126:127], v[126:127], v[232:233]
  v_pk_add_f32 v[126:127], v[126:127], v[166:167]
  v_pk_fma_f32 v[206:207], v[226:227], v[126:127], v[206:207]
  v_pk_add_f32 v[128:129], v[128:129], v[148:149]
  v_pk_add_f32 v[168:169], v[168:169], v[188:189]
  v_pk_add_f32 v[128:129], v[128:129], v[232:233]
  v_pk_add_f32 v[128:129], v[128:129], v[168:169]
  v_pk_fma_f32 v[208:209], v[228:229], v[128:129], v[208:209]
  v_pk_add_f32 v[130:131], v[130:131], v[150:151]
  v_pk_add_f32 v[170:171], v[170:171], v[190:191]
  v_pk_add_f32 v[130:131], v[130:131], v[232:233]
  v_pk_add_f32 v[130:131], v[130:131], v[170:171]
  v_pk_fma_f32 v[210:211], v[230:231], v[130:131], v[210:211]
  v_and_b32 v14, 15, v0
  v_mov_b32 v13, 0x0
  s_mov_b32 s36, 0x500
  v_mad_i32_i24 v13, v14, s36, v13
  v_bfe_u32 v14, v0, 4, 2
  v_mad_i32_i24 v13, v14, 8, v13
  v_lshrrev_b32 v14, 6, v0
  s_mov_b32 s36, 0x5000
  v_mad_i32_i24 v13, v14, s36, v13
  s_mul_i32 s40, s44, 81920
  s_mul_i32 s41, s45, 160
  s_add_u32 s40, s40, s41
  v_cvt_pk_bf16_f32 v112, v192, v193
  v_cvt_pk_bf16_f32 v113, v194, v195
  buffer_store_dwordx2 v[112:113], v13, s[20:23], s40 offen offset:0
  v_cvt_pk_bf16_f32 v114, v196, v197
  v_cvt_pk_bf16_f32 v115, v198, v199
  buffer_store_dwordx2 v[114:115], v13, s[20:23], s40 offen offset:32
  v_cvt_pk_bf16_f32 v116, v200, v201
  v_cvt_pk_bf16_f32 v117, v202, v203
  buffer_store_dwordx2 v[116:117], v13, s[20:23], s40 offen offset:64
  v_cvt_pk_bf16_f32 v118, v204, v205
  v_cvt_pk_bf16_f32 v119, v206, v207
  buffer_store_dwordx2 v[118:119], v13, s[20:23], s40 offen offset:96
  v_cvt_pk_bf16_f32 v120, v208, v209
  v_cvt_pk_bf16_f32 v121, v210, v211
  buffer_store_dwordx2 v[120:121], v13, s[20:23], s40 offen offset:128
  s_waitcnt vmcnt(0)
L_end:
  s_endpgm
.section .rodata,"a"
.p2align 6
.amdhsa_kernel adaLN_cond__memory_aug_recurrent_mem_tr__mixer_token_mlp__prompt_kernel
  .amdhsa_next_free_vgpr 512
  .amdhsa_next_free_sgpr 102
  .amdhsa_accum_offset 256
  .amdhsa_group_segment_fixed_size 0
  .amdhsa_kernarg_size 136
  .amdhsa_user_sgpr_count 2
  .amdhsa_user_sgpr_kernarg_segment_ptr 1
  .amdhsa_system_sgpr_workgroup_id_x 1
  .amdhsa_float_denorm_mode_32 3
.end_amdhsa_kernel
```
